```python
import torch

def _softmax(x, axis=-1):
    return torch.softmax(x, dim=axis)
def _gelu(x):
    return torch.nn.functional.gelu(x, approximate="tanh")
def _silu(x):
    return torch.nn.functional.silu(x)
def _sigmoid(x):
    return torch.sigmoid(x)
def _layernorm(x, axis=-1, eps=1e-5):
    m = x.mean(dim=axis, keepdim=True)
    v = x.var(dim=axis, keepdim=True, unbiased=False)
    return (x - m) / torch.sqrt(v + eps)
def _scatter_add(tgt, idx, src, axis=0):
    return tgt.clone().index_add_(axis, idx, src)
def _segment_sum(src, seg, n):
    out = torch.zeros((n,) + src.shape[1:], dtype=src.dtype)
    return out.index_add_(0, seg, src)
def _pad(x, pw):
    flat = tuple(v for pair in reversed(pw) for v in pair)
    return torch.nn.functional.pad(x, flat)

kernel_name = 'parallel_sum__sliding_local_dilated__glu_gated_bilinear__prompt'

def setup_inputs():

    _w = (lambda a: (lambda t: t.to(torch.bfloat16) if t.is_floating_point() else t)(torch.as_tensor(a)))
    def _A_setup():
        B, S, D = 1, 2048, 512
        return {
            "x": _w((lambda *s: torch.randn(*s, dtype=torch.bfloat16) * 0.05)(B, S, D)),
            "wqkv": _w((lambda *s: torch.randn(*s, dtype=torch.bfloat16) * 0.05)(D, 3 * D)),
            "wo": _w((lambda *s: torch.randn(*s, dtype=torch.bfloat16) * 0.05)(D, D)),
        }
    _A_in = _A_setup()

    def _B_setup():
        B, S, D, F = 1, 2048, 512, 1792
        return {
            "x": _w((lambda *s: torch.randn(*s, dtype=torch.bfloat16) * 0.05)(B, S, D)),
            "w_gate": _w((lambda *s: torch.randn(*s, dtype=torch.bfloat16) * 0.8)(D, F) * (D ** -0.5)),
            "w_up": _w((lambda *s: torch.randn(*s, dtype=torch.bfloat16) * 0.8)(D, F) * (D ** -0.5)),
            "w_down": _w((lambda *s: torch.randn(*s, dtype=torch.bfloat16) * 0.8)(F, D) * (F ** -0.5)),
        }
    _B_in = _B_setup()

    return {
        "A_x": _A_in["x"],
        "A_wqkv": _A_in["wqkv"],
        "A_wo": _A_in["wo"],
        "B_x": _B_in["x"],
        "B_w_gate": _B_in["w_gate"],
        "B_w_up": _B_in["w_up"],
        "B_w_down": _B_in["w_down"],
    }

def reference(A_x, A_wqkv, A_wo, B_x, B_w_gate, B_w_up, B_w_down):
    def _A_ref(x, wqkv, wo):
        B, S, D = x.shape
        H = 32; Dh = D // H
        W, dil = 8, 2
        qkv = (lambda x, *d: x.permute(*d))((x @ wqkv).reshape(B, S, 3, H, Dh), 2, 0, 3, 1, 4)
        q, k, v = qkv[0], qkv[1], qkv[2]
        scale = Dh ** -0.5
        pos = torch.arange(S)
        off = torch.arange(W) * dil
        idx = pos[:, None] - off[None, :]
        mask = idx >= 0
        idx_c = torch.where(mask, idx, 0).reshape(-1)
        kg = k[:, :, idx_c, :].reshape(B, H, S, W, Dh)
        vg = v[:, :, idx_c, :].reshape(B, H, S, W, Dh)
        logits = torch.einsum("bhsd,bhswd->bhsw", q, kg) * scale
        logits = torch.where(mask[None, None, :, :], logits, -1e9)
        attn = _softmax(logits, axis=-1)
        o = torch.einsum("bhsw,bhswd->bhsd", attn, vg)
        return (lambda x, *d: x.permute(*d))(o, 0, 2, 1, 3).reshape(B, S, D) @ wo

    def _B_ref(x, w_gate, w_up, w_down):
        g = torch.einsum("bsd,df->bsf", x, w_gate)
        u = torch.einsum("bsd,df->bsf", x, w_up)
        h = g * u
        return torch.einsum("bsf,fd->bsd", h, w_down)

    x = A_x
    xn = _layernorm(x, axis=-1)
    return x + _A_ref(xn, A_wqkv, A_wo) + _B_ref(xn, B_w_gate, B_w_up, B_w_down)
```

```asm
; @launch grid=(256,1,1) block=(512,1,1) lds=163840
.amdgcn_target "amdgcn-amd-amdhsa--gfx950"
.text
.globl parallel_sum__sliding_local_dilated__glu_gated_bilinear__prompt_kernel
.p2align 8
.type parallel_sum__sliding_local_dilated__glu_gated_bilinear__prompt_kernel,@function
parallel_sum__sliding_local_dilated__glu_gated_bilinear__prompt_kernel:
    s_cmp_ge_u32 s2, 256
    s_cbranch_scc1 K_END
    s_load_dwordx2 s[4:5], s[0:1], 0
    s_load_dwordx2 s[6:7], s[0:1], 8
    s_load_dwordx2 s[8:9], s[0:1], 32
    s_load_dwordx2 s[10:11], s[0:1], 40
    s_load_dwordx2 s[12:13], s[0:1], 72
    s_load_dwordx2 s[14:15], s[0:1], 16
    s_load_dwordx2 s[44:45], s[0:1], 48
    s_load_dwordx2 s[46:47], s[0:1], 56
    v_and_b32 v1, 63, v0
    v_lshrrev_b32 v2, 6, v0
    s_nop 0
    v_readfirstlane_b32 s50, v2
    s_and_b32 s3, s2, 7
    s_lshr_b32 s64, s2, 3
    s_and_b32 s48, s3, 1
    s_lshl_b32 s48, s48, 3
    s_and_b32 s65, s64, 7
    s_add_u32 s48, s48, s65
    s_lshr_b32 s79, s64, 3
    s_lshr_b32 s3, s3, 1
    s_lshl_b32 s3, s3, 1
    s_and_b32 s65, s79, 1
    s_add_u32 s49, s3, s65
    s_lshr_b32 s66, s79, 1
    s_lshl_b32 s54, s66, 3
    s_add_u32 s54, s54, s49
    s_and_b32 s53, s50, 3
    s_lshr_b32 s51, s53, 1
    s_and_b32 s52, s53, 1
    s_cmp_lt_u32 s50, 4
    s_cselect_b32 s67, 0, 1
    s_lshl_b32 s66, s66, 1
    s_add_u32 s66, s66, s67
    s_cmp_eq_u32 s66, 1
    s_cbranch_scc1 RattB
    s_cmp_eq_u32 s66, 2
    s_cbranch_scc1 RffnA
    s_cmp_eq_u32 s66, 3
    s_cbranch_scc1 RffnB
RattA:
    s_mov_b32 s3, 0
    v_lshrrev_b32 v40, 3, v1
    v_and_b32 v41, 7, v1
    v_lshrrev_b32 v42, 4, v1
    v_xor_b32 v43, v41, v42
    v_lshlrev_b32 v43, 4, v43
    v_lshlrev_b32 v44, 11, v40
    v_add_u32 v21, v44, v43
    v_xor_b32 v22, 64, v21
    s_lshl_b32 s61, s48, 17
    s_lshr_b32 s64, s53, 1
    s_lshl_b32 s64, s64, 16
    s_add_u32 s61, s61, s64
    s_and_b32 s64, s53, 1
    s_lshl_b32 s64, s64, 10
    s_add_u32 s61, s61, s64
    s_lshl_b32 s58, s53, 12
    s_add_u32 s58, s58, 103040
    s_lshr_b32 s64, s48, 3
    s_xor_b32 s65, s64, 1
    s_lshl_b32 s64, s64, 9
    s_add_u32 s62, s61, s64
    s_lshl_b32 s65, s65, 9
    s_add_u32 s63, s61, s65
    v_lshrrev_b32 v40, 5, v1
    v_lshlrev_b32 v40, 10, v40
    v_and_b32 v41, 31, v1
    v_lshlrev_b32 v41, 4, v41
    v_add_u32 v40, v40, v41
    s_lshl_b32 s66, s48, 7
    s_lshl_b32 s64, s54, 3
    s_add_u32 s66, s66, s64
    s_lshl_b32 s64, s53, 1
    s_add_u32 s66, s66, s64
    s_lshl_b32 s67, s66, 10
    v_lshrrev_b32 v42, 4, v1
    s_lshl_b32 s64, s53, 2
    v_add_u32 v42, s64, v42
    v_and_b32 v43, 7, v42
    v_lshlrev_b32 v43, 1, v43
    v_lshrrev_b32 v44, 3, v42
    v_add_u32 v43, v43, v44
    s_lshl_b32 s64, s48, 7
    s_sub_u32 s64, s64, 16
    s_max_i32 s64, s64, 0
    v_add_u32 v43, s64, v43
    v_lshlrev_b32 v43, 10, v43
    v_and_b32 v44, 15, v1
    v_lshlrev_b32 v44, 4, v44
    v_add_u32 v43, v43, v44
    s_waitcnt lgkmcnt(0)
    s_mov_b32 s16, s4
    s_mov_b32 s17, s5
    s_mov_b32 s18, 0x200000
    s_mov_b32 s19, 0x00020000
    s_mov_b32 s32, s12
    s_mov_b32 s33, s13
    s_mov_b32 s34, 0x1000000
    s_mov_b32 s35, 0x00020000
    s_add_u32 m0, s58, 0
    s_nop 0
    buffer_load_dwordx4 v21, s[16:19], s62 offen lds
    s_add_u32 m0, s58, 1024
    s_add_u32 s64, s62, 16384
    buffer_load_dwordx4 v22, s[16:19], s64 offen lds
    s_add_u32 m0, s58, 2048
    s_add_u32 s64, s62, 32768
    buffer_load_dwordx4 v21, s[16:19], s64 offen lds
    s_add_u32 m0, s58, 3072
    s_add_u32 s64, s62, 49152
    buffer_load_dwordx4 v22, s[16:19], s64 offen lds
    s_lshl_b32 s64, s48, 7
    s_add_u32 s64, s64, 0x998000
    s_lshl_b32 s65, s54, 7
    s_add_u32 s65, s65, 0x999000
    buffer_load_dword v62, off, s[32:35], s64 sc1
    buffer_load_dword v63, off, s[32:35], s65 sc1
    buffer_load_dwordx4 v[160:163], v40, s[16:19], s67 offen
    buffer_load_dwordx4 v[164:167], v40, s[16:19], s67 offen offset:512
    buffer_load_dwordx4 v[168:171], v43, s[16:19], 0 offen offset:0
    buffer_load_dwordx4 v[172:175], v43, s[16:19], 0 offen offset:256
    buffer_load_dwordx4 v[176:179], v43, s[16:19], 0 offen offset:512
    buffer_load_dwordx4 v[180:183], v43, s[16:19], 0 offen offset:768
    s_add_u32 m0, s58, 18432
    s_add_u32 s64, s62, 128
    buffer_load_dwordx4 v21, s[16:19], s64 offen lds
    s_add_u32 m0, s58, 19456
    s_add_u32 s64, s62, 16512
    buffer_load_dwordx4 v22, s[16:19], s64 offen lds
    s_add_u32 m0, s58, 20480
    s_add_u32 s64, s62, 32896
    buffer_load_dwordx4 v21, s[16:19], s64 offen lds
    s_add_u32 m0, s58, 21504
    s_add_u32 s64, s62, 49280
    buffer_load_dwordx4 v22, s[16:19], s64 offen lds
    v_mov_b32 v32, -1
    v_mov_b32 v33, -1
    v_mov_b32 v34, -1
    v_mov_b32 v35, -1
    v_lshlrev_b32 v36, 4, v1
    s_lshl_b32 s64, s48, 1
    s_add_u32 s64, s64, s51
    s_mul_i32 s64, s64, 294912
    s_lshl_b32 s65, s49, 1
    s_add_u32 s65, s65, s52
    s_lshl_b32 s65, s65, 11
    s_add_u32 s75, s64, s65
    s_add_u32 m0, s58, 36864
    s_add_u32 s64, s62, 256
    buffer_load_dwordx4 v21, s[16:19], s64 offen lds
    s_add_u32 m0, s58, 37888
    s_add_u32 s64, s62, 16640
    buffer_load_dwordx4 v22, s[16:19], s64 offen lds
    s_add_u32 m0, s58, 38912
    s_add_u32 s64, s62, 33024
    buffer_load_dwordx4 v21, s[16:19], s64 offen lds
    s_add_u32 m0, s58, 39936
    s_add_u32 s64, s62, 49408
    buffer_load_dwordx4 v22, s[16:19], s64 offen lds
    s_lshl_b32 s59, s66, 4
    s_add_u32 s59, s59, 0x900000
    s_mov_b32 s36, s14
    s_mov_b32 s37, s15
    s_mov_b32 s38, 0x80000
    s_mov_b32 s39, 0x00020000
    s_mov_b32 s40, s44
    s_mov_b32 s41, s45
    s_mov_b32 s42, 0x1c0000
    s_mov_b32 s43, 0x00020000
    s_mov_b32 s44, s46
    s_mov_b32 s45, s47
    s_mov_b32 s46, 0x200000
    s_mov_b32 s47, 0x00020000
    v_lshrrev_b32 v46, 4, v1
    v_bfe_u32 v47, v1, 2, 2
    v_and_b32 v48, 3, v1
    v_lshrrev_b32 v49, 1, v46
    v_and_b32 v50, 1, v46
    v_lshlrev_b32 v51, 3, v49
    v_add_u32 v51, v51, v47
    v_lshrrev_b32 v52, 1, v47
    v_xor_b32 v53, s52, v52
    v_lshlrev_b32 v53, 6, v53
    v_lshlrev_b32 v54, 7, v51
    v_add_u32 v54, v54, v53
    v_lshlrev_b32 v55, 3, v48
    v_add_u32 v54, v54, v55
    v_lshlrev_b32 v55, 5, v50
    v_add_u32 v2, v54, v55
    v_add_u32 v3, 61824, v2
    v_and_b32 v53, 31, v1
    v_lshrrev_b32 v54, 5, v1
    v_bfe_u32 v55, v1, 1, 3
    v_xor_b32 v55, v55, v54
    v_lshlrev_b32 v55, 4, v55
    v_lshlrev_b32 v53, 7, v53
    v_add_u32 v53, v53, v55
    s_lshl_b32 s64, s51, 13
    s_add_u32 s64, s64, 103040
    v_add_u32 v8, s64, v53
    v_xor_b32 v9, 32, v8
    v_xor_b32 v10, 64, v8
    v_xor_b32 v11, 96, v8
    v_lshrrev_b32 v53, 3, v1
    v_and_b32 v54, 3, v53
    v_lshrrev_b32 v55, 2, v53
    v_lshlrev_b32 v55, 3, v55
    v_add_u32 v54, v54, v55
    v_lshlrev_b32 v54, 10, v54
    v_bfe_u32 v55, v53, 1, 1
    v_lshlrev_b32 v55, 2, v55
    v_and_b32 v56, 7, v1
    v_xor_b32 v55, v55, v56
    v_lshlrev_b32 v55, 4, v55
    v_add_u32 v14, v54, v55
    s_and_b32 s64, s2, 7
    s_lshr_b32 s64, s64, 1
    s_and_b32 s65, s64, 1
    s_lshl_b32 s69, s48, 1
    s_add_u32 s69, s69, s65
    s_lshr_b32 s64, s64, 1
    s_lshl_b32 s64, s64, 2
    s_add_u32 s70, s64, s79
    s_lshl_b32 s71, s53, 17
    s_lshl_b32 s78, s53, 12
    s_lshl_b32 s64, s70, 7
    s_add_u32 s71, s71, s64
    s_lshl_b32 s74, s50, 11
    s_mul_i32 s72, s69, 294912
    s_and_b32 s68, s48, 7
    s_cmp_eq_u32 s51, 0
    s_cselect_b32 s68, s68, 99
    v_mov_b32 v53, 158336
    v_mov_b32 v54, 0
    ds_write_b32 v53, v54
    s_waitcnt vmcnt(12)
    v_readfirstlane_b32 s55, v62
    v_readfirstlane_b32 s56, v63
    s_mul_i32 s55, s55, 0x9e3779b1
    s_add_u32 s55, s55, 0x7f4a7c15
    s_mul_i32 s56, s56, 0x9e3779b1
    s_add_u32 s56, s56, 0x7f4a7c15
    v_lshlrev_b32 v208, 16, v160
    v_and_b32 v209, 0xffff0000, v160
    v_lshlrev_b32 v210, 16, v161
    v_and_b32 v211, 0xffff0000, v161
    v_lshlrev_b32 v212, 16, v162
    v_and_b32 v213, 0xffff0000, v162
    v_lshlrev_b32 v214, 16, v163
    v_and_b32 v215, 0xffff0000, v163
    v_lshlrev_b32 v216, 16, v164
    v_and_b32 v217, 0xffff0000, v164
    v_lshlrev_b32 v218, 16, v165
    v_and_b32 v219, 0xffff0000, v165
    v_lshlrev_b32 v220, 16, v166
    v_and_b32 v221, 0xffff0000, v166
    v_lshlrev_b32 v222, 16, v167
    v_and_b32 v223, 0xffff0000, v167
    v_pk_add_f32 v[202:203], v[208:209], v[210:211]
    v_pk_add_f32 v[202:203], v[202:203], v[212:213]
    v_pk_add_f32 v[202:203], v[202:203], v[214:215]
    v_pk_add_f32 v[202:203], v[202:203], v[216:217]
    v_pk_add_f32 v[202:203], v[202:203], v[218:219]
    v_pk_add_f32 v[202:203], v[202:203], v[220:221]
    v_pk_add_f32 v[202:203], v[202:203], v[222:223]
    v_add_f32 v200, v202, v203
    s_nop 1
    v_add_f32_dpp v200, v200, v200 row_ror:8 row_mask:0xf bank_mask:0xf
    s_nop 1
    v_add_f32_dpp v200, v200, v200 row_ror:4 row_mask:0xf bank_mask:0xf
    s_nop 1
    v_add_f32_dpp v200, v200, v200 row_ror:2 row_mask:0xf bank_mask:0xf
    s_nop 1
    v_add_f32_dpp v200, v200, v200 row_ror:1 row_mask:0xf bank_mask:0xf
    v_mov_b32 v202, v200
    s_nop 1
    v_permlane16_swap_b32 v200, v202
    v_add_f32 v200, v200, v202
    v_mul_f32 v200, 0x3b000000, v200
    v_pk_add_f32 v[208:209], v[208:209], v[200:201] op_sel_hi:[1,0] neg_lo:[0,1] neg_hi:[0,1]
    v_pk_add_f32 v[210:211], v[210:211], v[200:201] op_sel_hi:[1,0] neg_lo:[0,1] neg_hi:[0,1]
    v_pk_add_f32 v[212:213], v[212:213], v[200:201] op_sel_hi:[1,0] neg_lo:[0,1] neg_hi:[0,1]
    v_pk_add_f32 v[214:215], v[214:215], v[200:201] op_sel_hi:[1,0] neg_lo:[0,1] neg_hi:[0,1]
    v_pk_add_f32 v[216:217], v[216:217], v[200:201] op_sel_hi:[1,0] neg_lo:[0,1] neg_hi:[0,1]
    v_pk_add_f32 v[218:219], v[218:219], v[200:201] op_sel_hi:[1,0] neg_lo:[0,1] neg_hi:[0,1]
    v_pk_add_f32 v[220:221], v[220:221], v[200:201] op_sel_hi:[1,0] neg_lo:[0,1] neg_hi:[0,1]
    v_pk_add_f32 v[222:223], v[222:223], v[200:201] op_sel_hi:[1,0] neg_lo:[0,1] neg_hi:[0,1]
    v_pk_mul_f32 v[202:203], v[208:209], v[208:209]
    v_pk_fma_f32 v[202:203], v[210:211], v[210:211], v[202:203]
    v_pk_fma_f32 v[202:203], v[212:213], v[212:213], v[202:203]
    v_pk_fma_f32 v[202:203], v[214:215], v[214:215], v[202:203]
    v_pk_fma_f32 v[202:203], v[216:217], v[216:217], v[202:203]
    v_pk_fma_f32 v[202:203], v[218:219], v[218:219], v[202:203]
    v_pk_fma_f32 v[202:203], v[220:221], v[220:221], v[202:203]
    v_pk_fma_f32 v[202:203], v[222:223], v[222:223], v[202:203]
    v_add_f32 v201, v202, v203
    s_nop 1
    v_add_f32_dpp v201, v201, v201 row_ror:8 row_mask:0xf bank_mask:0xf
    s_nop 1
    v_add_f32_dpp v201, v201, v201 row_ror:4 row_mask:0xf bank_mask:0xf
    s_nop 1
    v_add_f32_dpp v201, v201, v201 row_ror:2 row_mask:0xf bank_mask:0xf
    s_nop 1
    v_add_f32_dpp v201, v201, v201 row_ror:1 row_mask:0xf bank_mask:0xf
    v_mov_b32 v202, v201
    s_nop 1
    v_permlane16_swap_b32 v201, v202
    v_add_f32 v201, v201, v202
    v_mov_b32 v202, 0x3727c5ac
    v_fmac_f32 v202, 0x3b000000, v201
    v_rsq_f32 v201, v202
    v_mov_b32 v202, s55
    v_mov_b32 v203, s55
    v_lshrrev_b32 v53, 5, v1
    v_lshlrev_b32 v53, 4, v53
    s_mov_b32 exec_lo, 1
    s_mov_b32 exec_hi, 1
    buffer_store_dwordx4 v[200:203], v53, s[32:35], s59 offen sc1
    s_mov_b64 exec, -1
    s_waitcnt vmcnt(9)
    v_lshlrev_b32 v208, 16, v168
    v_and_b32 v209, 0xffff0000, v168
    v_lshlrev_b32 v210, 16, v169
    v_and_b32 v211, 0xffff0000, v169
    v_lshlrev_b32 v212, 16, v170
    v_and_b32 v213, 0xffff0000, v170
    v_lshlrev_b32 v214, 16, v171
    v_and_b32 v215, 0xffff0000, v171
    v_lshlrev_b32 v216, 16, v172
    v_and_b32 v217, 0xffff0000, v172
    v_lshlrev_b32 v218, 16, v173
    v_and_b32 v219, 0xffff0000, v173
    v_lshlrev_b32 v220, 16, v174
    v_and_b32 v221, 0xffff0000, v174
    v_lshlrev_b32 v222, 16, v175
    v_and_b32 v223, 0xffff0000, v175
    v_lshlrev_b32 v224, 16, v176
    v_and_b32 v225, 0xffff0000, v176
    v_lshlrev_b32 v226, 16, v177
    v_and_b32 v227, 0xffff0000, v177
    v_lshlrev_b32 v228, 16, v178
    v_and_b32 v229, 0xffff0000, v178
    v_lshlrev_b32 v230, 16, v179
    v_and_b32 v231, 0xffff0000, v179
    v_lshlrev_b32 v232, 16, v180
    v_and_b32 v233, 0xffff0000, v180
    v_lshlrev_b32 v234, 16, v181
    v_and_b32 v235, 0xffff0000, v181
    v_lshlrev_b32 v236, 16, v182
    v_and_b32 v237, 0xffff0000, v182
    v_lshlrev_b32 v238, 16, v183
    v_and_b32 v239, 0xffff0000, v183
    v_pk_add_f32 v[206:207], v[208:209], v[210:211]
    v_pk_add_f32 v[206:207], v[206:207], v[212:213]
    v_pk_add_f32 v[206:207], v[206:207], v[214:215]
    v_pk_add_f32 v[206:207], v[206:207], v[216:217]
    v_pk_add_f32 v[206:207], v[206:207], v[218:219]
    v_pk_add_f32 v[206:207], v[206:207], v[220:221]
    v_pk_add_f32 v[206:207], v[206:207], v[222:223]
    v_pk_add_f32 v[206:207], v[206:207], v[224:225]
    v_pk_add_f32 v[206:207], v[206:207], v[226:227]
    v_pk_add_f32 v[206:207], v[206:207], v[228:229]
    v_pk_add_f32 v[206:207], v[206:207], v[230:231]
    v_pk_add_f32 v[206:207], v[206:207], v[232:233]
    v_pk_add_f32 v[206:207], v[206:207], v[234:235]
    v_pk_add_f32 v[206:207], v[206:207], v[236:237]
    v_pk_add_f32 v[206:207], v[206:207], v[238:239]
    v_add_f32 v204, v206, v207
    s_nop 1
    v_add_f32_dpp v204, v204, v204 row_ror:8 row_mask:0xf bank_mask:0xf
    s_nop 1
    v_add_f32_dpp v204, v204, v204 row_ror:4 row_mask:0xf bank_mask:0xf
    s_nop 1
    v_add_f32_dpp v204, v204, v204 row_ror:2 row_mask:0xf bank_mask:0xf
    s_nop 1
    v_add_f32_dpp v204, v204, v204 row_ror:1 row_mask:0xf bank_mask:0xf
    v_mul_f32 v204, 0x3b000000, v204
    v_pk_add_f32 v[208:209], v[208:209], v[204:205] op_sel_hi:[1,0] neg_lo:[0,1] neg_hi:[0,1]
    v_pk_add_f32 v[210:211], v[210:211], v[204:205] op_sel_hi:[1,0] neg_lo:[0,1] neg_hi:[0,1]
    v_pk_add_f32 v[212:213], v[212:213], v[204:205] op_sel_hi:[1,0] neg_lo:[0,1] neg_hi:[0,1]
    v_pk_add_f32 v[214:215], v[214:215], v[204:205] op_sel_hi:[1,0] neg_lo:[0,1] neg_hi:[0,1]
    v_pk_add_f32 v[216:217], v[216:217], v[204:205] op_sel_hi:[1,0] neg_lo:[0,1] neg_hi:[0,1]
    v_pk_add_f32 v[218:219], v[218:219], v[204:205] op_sel_hi:[1,0] neg_lo:[0,1] neg_hi:[0,1]
    v_pk_add_f32 v[220:221], v[220:221], v[204:205] op_sel_hi:[1,0] neg_lo:[0,1] neg_hi:[0,1]
    v_pk_add_f32 v[222:223], v[222:223], v[204:205] op_sel_hi:[1,0] neg_lo:[0,1] neg_hi:[0,1]
    v_pk_add_f32 v[224:225], v[224:225], v[204:205] op_sel_hi:[1,0] neg_lo:[0,1] neg_hi:[0,1]
    v_pk_add_f32 v[226:227], v[226:227], v[204:205] op_sel_hi:[1,0] neg_lo:[0,1] neg_hi:[0,1]
    v_pk_add_f32 v[228:229], v[228:229], v[204:205] op_sel_hi:[1,0] neg_lo:[0,1] neg_hi:[0,1]
    v_pk_add_f32 v[230:231], v[230:231], v[204:205] op_sel_hi:[1,0] neg_lo:[0,1] neg_hi:[0,1]
    v_pk_add_f32 v[232:233], v[232:233], v[204:205] op_sel_hi:[1,0] neg_lo:[0,1] neg_hi:[0,1]
    v_pk_add_f32 v[234:235], v[234:235], v[204:205] op_sel_hi:[1,0] neg_lo:[0,1] neg_hi:[0,1]
    v_pk_add_f32 v[236:237], v[236:237], v[204:205] op_sel_hi:[1,0] neg_lo:[0,1] neg_hi:[0,1]
    v_pk_add_f32 v[238:239], v[238:239], v[204:205] op_sel_hi:[1,0] neg_lo:[0,1] neg_hi:[0,1]
    v_pk_mul_f32 v[206:207], v[208:209], v[208:209]
    v_pk_fma_f32 v[206:207], v[210:211], v[210:211], v[206:207]
    v_pk_fma_f32 v[206:207], v[212:213], v[212:213], v[206:207]
    v_pk_fma_f32 v[206:207], v[214:215], v[214:215], v[206:207]
    v_pk_fma_f32 v[206:207], v[216:217], v[216:217], v[206:207]
    v_pk_fma_f32 v[206:207], v[218:219], v[218:219], v[206:207]
    v_pk_fma_f32 v[206:207], v[220:221], v[220:221], v[206:207]
    v_pk_fma_f32 v[206:207], v[222:223], v[222:223], v[206:207]
    v_pk_fma_f32 v[206:207], v[224:225], v[224:225], v[206:207]
    v_pk_fma_f32 v[206:207], v[226:227], v[226:227], v[206:207]
    v_pk_fma_f32 v[206:207], v[228:229], v[228:229], v[206:207]
    v_pk_fma_f32 v[206:207], v[230:231], v[230:231], v[206:207]
    v_pk_fma_f32 v[206:207], v[232:233], v[232:233], v[206:207]
    v_pk_fma_f32 v[206:207], v[234:235], v[234:235], v[206:207]
    v_pk_fma_f32 v[206:207], v[236:237], v[236:237], v[206:207]
    v_pk_fma_f32 v[206:207], v[238:239], v[238:239], v[206:207]
    v_add_f32 v205, v206, v207
    s_nop 1
    v_add_f32_dpp v205, v205, v205 row_ror:8 row_mask:0xf bank_mask:0xf
    s_nop 1
    v_add_f32_dpp v205, v205, v205 row_ror:4 row_mask:0xf bank_mask:0xf
    s_nop 1
    v_add_f32_dpp v205, v205, v205 row_ror:2 row_mask:0xf bank_mask:0xf
    s_nop 1
    v_add_f32_dpp v205, v205, v205 row_ror:1 row_mask:0xf bank_mask:0xf
    v_mov_b32 v206, 0x3727c5ac
    v_fmac_f32 v206, 0x3b000000, v205
    v_rsq_f32 v205, v206
    v_lshrrev_b32 v53, 4, v1
    v_lshlrev_b32 v53, 3, v53
    s_lshl_b32 s64, s53, 5
    s_add_u32 s64, s64, 158400
    v_add_u32 v53, s64, v53
    s_mov_b32 exec_lo, 0x00010001
    s_mov_b32 exec_hi, 0x00010001
    ds_write_b64 v53, v[204:205]
    s_mov_b64 exec, -1
    s_waitcnt lgkmcnt(0)
    s_barrier
    ds_read_b128 v[160:163], v8 offset:0
    ds_read_b128 v[164:167], v8 offset:4096
    ds_read_b64_tr_b16 v[176:177], v2 offset:0
    ds_read_b64_tr_b16 v[178:179], v2 offset:512
    ds_read_b64_tr_b16 v[180:181], v2 offset:4096
    ds_read_b64_tr_b16 v[182:183], v2 offset:4608
    ds_read_b64_tr_b16 v[184:185], v2 offset:8192
    ds_read_b64_tr_b16 v[186:187], v2 offset:8704
    ds_read_b128 v[168:171], v9 offset:0
    ds_read_b128 v[172:175], v9 offset:4096
    ds_read_b64_tr_b16 v[188:189], v2 offset:2048
    ds_read_b64_tr_b16 v[190:191], v2 offset:2560
    ds_read_b64_tr_b16 v[192:193], v2 offset:6144
    ds_read_b64_tr_b16 v[194:195], v2 offset:6656
    ds_read_b64_tr_b16 v[196:197], v2 offset:10240
    ds_read_b64_tr_b16 v[198:199], v2 offset:10752
    s_waitcnt lgkmcnt(0)
    s_barrier
    v_mfma_f32_32x32x16_bf16 v[64:79], v[176:179], v[160:163], 0
    ds_read_b128 v[200:203], v10 offset:0
    ds_read_b128 v[204:207], v10 offset:4096
    v_mfma_f32_32x32x16_bf16 v[80:95], v[176:179], v[164:167], 0
    ds_read_b64_tr_b16 v[216:217], v2 offset:20608
    v_mfma_f32_32x32x16_bf16 v[96:111], v[180:183], v[160:163], 0
    ds_read_b64_tr_b16 v[218:219], v2 offset:21120
    ds_read_b64_tr_b16 v[220:221], v2 offset:24704
    v_mfma_f32_32x32x16_bf16 v[112:127], v[180:183], v[164:167], 0
    ds_read_b64_tr_b16 v[222:223], v2 offset:25216
    v_mfma_f32_32x32x16_bf16 v[128:143], v[184:187], v[160:163], 0
    ds_read_b64_tr_b16 v[224:225], v2 offset:28800
    ds_read_b64_tr_b16 v[226:227], v2 offset:29312
    v_mfma_f32_32x32x16_bf16 v[144:159], v[184:187], v[164:167], 0
    ds_read_b128 v[208:211], v11 offset:0
    v_mfma_f32_32x32x16_bf16 v[64:79], v[188:191], v[168:171], v[64:79]
    ds_read_b128 v[212:215], v11 offset:4096
    ds_read_b64_tr_b16 v[228:229], v2 offset:22656
    v_mfma_f32_32x32x16_bf16 v[80:95], v[188:191], v[172:175], v[80:95]
    ds_read_b64_tr_b16 v[230:231], v2 offset:23168
    v_mfma_f32_32x32x16_bf16 v[96:111], v[192:195], v[168:171], v[96:111]
    ds_read_b64_tr_b16 v[232:233], v2 offset:26752
    ds_read_b64_tr_b16 v[234:235], v2 offset:27264
    v_mfma_f32_32x32x16_bf16 v[112:127], v[192:195], v[172:175], v[112:127]
    ds_read_b64_tr_b16 v[236:237], v2 offset:30848
    v_mfma_f32_32x32x16_bf16 v[128:143], v[196:199], v[168:171], v[128:143]
    ds_read_b64_tr_b16 v[238:239], v2 offset:31360
    v_mfma_f32_32x32x16_bf16 v[144:159], v[196:199], v[172:175], v[144:159]
    s_cmp_lg_u32 s68, 0
    s_cbranch_scc1 RattA_nocs_1
    v_bfe_u32 v40, v1, 4, 1
    v_and_b32 v41, 1, v1
    v_cmp_eq_u32 vcc, v40, v41
    v_mov_b32 v42, 0x3f803f80
    s_nop 0
    v_cndmask_b32 v40, 0, v42, vcc
    v_mov_b32 v41, v40
    v_mov_b32 v42, v40
    v_mov_b32 v43, v40
    s_nop 1
    v_mfma_f32_16x16x32_bf16 v[44:47], v[40:43], v[176:179], 0
    v_mfma_f32_16x16x32_bf16 v[48:51], v[40:43], v[180:183], 0
    v_mfma_f32_16x16x32_bf16 v[52:55], v[40:43], v[184:187], 0
    v_mfma_f32_16x16x32_bf16 v[44:47], v[40:43], v[188:191], v[44:47]
    v_mfma_f32_16x16x32_bf16 v[48:51], v[40:43], v[192:195], v[48:51]
    v_mfma_f32_16x16x32_bf16 v[52:55], v[40:43], v[196:199], v[52:55]
    v_bfe_u32 v28, v1, 4, 1
    v_cmp_eq_u32 vcc, 1, v28
    s_nop 3
    v_cndmask_b32 v24, v44, v45, vcc
    v_cndmask_b32 v25, v48, v49, vcc
    v_cndmask_b32 v26, v52, v53, vcc
    v_mov_b32 v27, s56
    s_lshl_b32 s64, s54, 2
    s_add_u32 s64, s64, s52
    s_add_u32 s64, s64, 0
    s_lshl_b32 s64, s64, 4
    s_add_u32 s64, s64, s48
    s_lshl_b32 s64, s64, 9
    s_add_u32 s64, s64, 0x910000
    v_lshlrev_b32 v28, 4, v1
    s_mov_b32 exec_hi, 0
    buffer_store_dwordx4 v[24:27], v28, s[32:35], s64 offen sc1
    s_mov_b32 exec_hi, -1
RattA_nocs_1:
    s_waitcnt vmcnt(5) lgkmcnt(0)
    s_barrier
    v_mfma_f32_32x32x16_bf16 v[64:79], v[216:219], v[200:203], v[64:79]
    ds_read_b128 v[160:163], v8 offset:18432
    ds_read_b128 v[164:167], v8 offset:22528
    v_mfma_f32_32x32x16_bf16 v[80:95], v[216:219], v[204:207], v[80:95]
    ds_read_b64_tr_b16 v[176:177], v2 offset:41216
    v_mfma_f32_32x32x16_bf16 v[96:111], v[220:223], v[200:203], v[96:111]
    ds_read_b64_tr_b16 v[178:179], v2 offset:41728
    ds_read_b64_tr_b16 v[180:181], v2 offset:45312
    v_mfma_f32_32x32x16_bf16 v[112:127], v[220:223], v[204:207], v[112:127]
    ds_read_b64_tr_b16 v[182:183], v2 offset:45824
    v_mfma_f32_32x32x16_bf16 v[128:143], v[224:227], v[200:203], v[128:143]
    ds_read_b64_tr_b16 v[184:185], v2 offset:49408
    ds_read_b64_tr_b16 v[186:187], v2 offset:49920
    v_mfma_f32_32x32x16_bf16 v[144:159], v[224:227], v[204:207], v[144:159]
    ds_read_b128 v[168:171], v9 offset:18432
    v_mfma_f32_32x32x16_bf16 v[64:79], v[228:231], v[208:211], v[64:79]
    ds_read_b128 v[172:175], v9 offset:22528
    ds_read_b64_tr_b16 v[188:189], v2 offset:43264
    v_mfma_f32_32x32x16_bf16 v[80:95], v[228:231], v[212:215], v[80:95]
    ds_read_b64_tr_b16 v[190:191], v2 offset:43776
    v_mfma_f32_32x32x16_bf16 v[96:111], v[232:235], v[208:211], v[96:111]
    ds_read_b64_tr_b16 v[192:193], v2 offset:47360
    ds_read_b64_tr_b16 v[194:195], v2 offset:47872
    v_mfma_f32_32x32x16_bf16 v[112:127], v[232:235], v[212:215], v[112:127]
    ds_read_b64_tr_b16 v[196:197], v2 offset:51456
    v_mfma_f32_32x32x16_bf16 v[128:143], v[236:239], v[208:211], v[128:143]
    ds_read_b64_tr_b16 v[198:199], v2 offset:51968
    v_mfma_f32_32x32x16_bf16 v[144:159], v[236:239], v[212:215], v[144:159]
    s_add_u32 m0, s58, 0
    s_add_u32 s64, s62, 384
    buffer_load_dwordx4 v21, s[16:19], s64 offen lds
    s_add_u32 m0, s58, 1024
    s_add_u32 s64, s62, 16768
    buffer_load_dwordx4 v22, s[16:19], s64 offen lds
    s_add_u32 m0, s58, 2048
    s_add_u32 s64, s62, 33152
    buffer_load_dwordx4 v21, s[16:19], s64 offen lds
    s_add_u32 m0, s58, 3072
    s_add_u32 s64, s62, 49536
    buffer_load_dwordx4 v22, s[16:19], s64 offen lds
    buffer_store_dwordx4 v[32:35], v36, s[32:35], s75 offen offset:0 sc1
    s_cmp_lg_u32 s68, 1
    s_cbranch_scc1 RattA_nocs_2
    v_bfe_u32 v40, v1, 4, 1
    v_and_b32 v41, 1, v1
    v_cmp_eq_u32 vcc, v40, v41
    v_mov_b32 v42, 0x3f803f80
    s_nop 0
    v_cndmask_b32 v40, 0, v42, vcc
    v_mov_b32 v41, v40
    v_mov_b32 v42, v40
    v_mov_b32 v43, v40
    s_nop 1
    v_mfma_f32_16x16x32_bf16 v[44:47], v[40:43], v[216:219], 0
    v_mfma_f32_16x16x32_bf16 v[48:51], v[40:43], v[220:223], 0
    v_mfma_f32_16x16x32_bf16 v[52:55], v[40:43], v[224:227], 0
    v_mfma_f32_16x16x32_bf16 v[44:47], v[40:43], v[228:231], v[44:47]
    v_mfma_f32_16x16x32_bf16 v[48:51], v[40:43], v[232:235], v[48:51]
    v_mfma_f32_16x16x32_bf16 v[52:55], v[40:43], v[236:239], v[52:55]
    v_bfe_u32 v28, v1, 4, 1
    v_cmp_eq_u32 vcc, 1, v28
    s_nop 3
    v_cndmask_b32 v24, v44, v45, vcc
    v_cndmask_b32 v25, v48, v49, vcc
    v_cndmask_b32 v26, v52, v53, vcc
    v_mov_b32 v27, s56
    s_lshl_b32 s64, s54, 2
    s_add_u32 s64, s64, s52
    s_add_u32 s64, s64, 0
    s_lshl_b32 s64, s64, 4
    s_add_u32 s64, s64, s48
    s_lshl_b32 s64, s64, 9
    s_add_u32 s64, s64, 0x910000
    v_lshlrev_b32 v28, 4, v1
    s_mov_b32 exec_hi, 0
    buffer_store_dwordx4 v[24:27], v28, s[32:35], s64 offen sc1
    s_mov_b32 exec_hi, -1
RattA_nocs_2:
    s_waitcnt lgkmcnt(0)
    s_barrier
    v_mfma_f32_32x32x16_bf16 v[64:79], v[176:179], v[160:163], v[64:79]
    ds_read_b128 v[200:203], v10 offset:18432
    ds_read_b128 v[204:207], v10 offset:22528
    v_mfma_f32_32x32x16_bf16 v[80:95], v[176:179], v[164:167], v[80:95]
    ds_read_b64_tr_b16 v[216:217], v3 offset:0
    v_mfma_f32_32x32x16_bf16 v[96:111], v[180:183], v[160:163], v[96:111]
    ds_read_b64_tr_b16 v[218:219], v3 offset:512
    ds_read_b64_tr_b16 v[220:221], v3 offset:4096
    v_mfma_f32_32x32x16_bf16 v[112:127], v[180:183], v[164:167], v[112:127]
    ds_read_b64_tr_b16 v[222:223], v3 offset:4608
    v_mfma_f32_32x32x16_bf16 v[128:143], v[184:187], v[160:163], v[128:143]
    ds_read_b64_tr_b16 v[224:225], v3 offset:8192
    ds_read_b64_tr_b16 v[226:227], v3 offset:8704
    v_mfma_f32_32x32x16_bf16 v[144:159], v[184:187], v[164:167], v[144:159]
    ds_read_b128 v[208:211], v11 offset:18432
    v_mfma_f32_32x32x16_bf16 v[64:79], v[188:191], v[168:171], v[64:79]
    ds_read_b128 v[212:215], v11 offset:22528
    ds_read_b64_tr_b16 v[228:229], v3 offset:2048
    v_mfma_f32_32x32x16_bf16 v[80:95], v[188:191], v[172:175], v[80:95]
    ds_read_b64_tr_b16 v[230:231], v3 offset:2560
    v_mfma_f32_32x32x16_bf16 v[96:111], v[192:195], v[168:171], v[96:111]
    ds_read_b64_tr_b16 v[232:233], v3 offset:6144
    ds_read_b64_tr_b16 v[234:235], v3 offset:6656
    v_mfma_f32_32x32x16_bf16 v[112:127], v[192:195], v[172:175], v[112:127]
    ds_read_b64_tr_b16 v[236:237], v3 offset:10240
    v_mfma_f32_32x32x16_bf16 v[128:143], v[196:199], v[168:171], v[128:143]
    ds_read_b64_tr_b16 v[238:239], v3 offset:10752
    v_mfma_f32_32x32x16_bf16 v[144:159], v[196:199], v[172:175], v[144:159]
    buffer_store_dwordx4 v[32:35], v36, s[32:35], s75 offen offset:1024 sc1
    s_cmp_lg_u32 s68, 2
    s_cbranch_scc1 RattA_nocs_3
    v_bfe_u32 v40, v1, 4, 1
    v_and_b32 v41, 1, v1
    v_cmp_eq_u32 vcc, v40, v41
    v_mov_b32 v42, 0x3f803f80
    s_nop 0
    v_cndmask_b32 v40, 0, v42, vcc
    v_mov_b32 v41, v40
    v_mov_b32 v42, v40
    v_mov_b32 v43, v40
    s_nop 1
    v_mfma_f32_16x16x32_bf16 v[44:47], v[40:43], v[176:179], 0
    v_mfma_f32_16x16x32_bf16 v[48:51], v[40:43], v[180:183], 0
    v_mfma_f32_16x16x32_bf16 v[52:55], v[40:43], v[184:187], 0
    v_mfma_f32_16x16x32_bf16 v[44:47], v[40:43], v[188:191], v[44:47]
    v_mfma_f32_16x16x32_bf16 v[48:51], v[40:43], v[192:195], v[48:51]
    v_mfma_f32_16x16x32_bf16 v[52:55], v[40:43], v[196:199], v[52:55]
    v_bfe_u32 v28, v1, 4, 1
    v_cmp_eq_u32 vcc, 1, v28
    s_nop 3
    v_cndmask_b32 v24, v44, v45, vcc
    v_cndmask_b32 v25, v48, v49, vcc
    v_cndmask_b32 v26, v52, v53, vcc
    v_mov_b32 v27, s56
    s_lshl_b32 s64, s54, 2
    s_add_u32 s64, s64, s52
    s_add_u32 s64, s64, 0
    s_lshl_b32 s64, s64, 4
    s_add_u32 s64, s64, s48
    s_lshl_b32 s64, s64, 9
    s_add_u32 s64, s64, 0x910000
    v_lshlrev_b32 v28, 4, v1
    s_mov_b32 exec_hi, 0
    buffer_store_dwordx4 v[24:27], v28, s[32:35], s64 offen sc1
    s_mov_b32 exec_hi, -1
RattA_nocs_3:
    s_waitcnt vmcnt(7) lgkmcnt(0)
    s_barrier
    v_mfma_f32_32x32x16_bf16 v[64:79], v[216:219], v[200:203], v[64:79]
    ds_read_b128 v[160:163], v8 offset:36864
    ds_read_b128 v[164:167], v8 offset:40960
    v_mfma_f32_32x32x16_bf16 v[80:95], v[216:219], v[204:207], v[80:95]
    ds_read_b64_tr_b16 v[176:177], v3 offset:20608
    v_mfma_f32_32x32x16_bf16 v[96:111], v[220:223], v[200:203], v[96:111]
    ds_read_b64_tr_b16 v[178:179], v3 offset:21120
    ds_read_b64_tr_b16 v[180:181], v3 offset:24704
    v_mfma_f32_32x32x16_bf16 v[112:127], v[220:223], v[204:207], v[112:127]
    ds_read_b64_tr_b16 v[182:183], v3 offset:25216
    v_mfma_f32_32x32x16_bf16 v[128:143], v[224:227], v[200:203], v[128:143]
    ds_read_b64_tr_b16 v[184:185], v3 offset:28800
    ds_read_b64_tr_b16 v[186:187], v3 offset:29312
    v_mfma_f32_32x32x16_bf16 v[144:159], v[224:227], v[204:207], v[144:159]
    ds_read_b128 v[168:171], v9 offset:36864
    v_mfma_f32_32x32x16_bf16 v[64:79], v[228:231], v[208:211], v[64:79]
    ds_read_b128 v[172:175], v9 offset:40960
    ds_read_b64_tr_b16 v[188:189], v3 offset:22656
    v_mfma_f32_32x32x16_bf16 v[80:95], v[228:231], v[212:215], v[80:95]
    ds_read_b64_tr_b16 v[190:191], v3 offset:23168
    v_mfma_f32_32x32x16_bf16 v[96:111], v[232:235], v[208:211], v[96:111]
    ds_read_b64_tr_b16 v[192:193], v3 offset:26752
    ds_read_b64_tr_b16 v[194:195], v3 offset:27264
    v_mfma_f32_32x32x16_bf16 v[112:127], v[232:235], v[212:215], v[112:127]
    ds_read_b64_tr_b16 v[196:197], v3 offset:30848
    v_mfma_f32_32x32x16_bf16 v[128:143], v[236:239], v[208:211], v[128:143]
    ds_read_b64_tr_b16 v[198:199], v3 offset:31360
    v_mfma_f32_32x32x16_bf16 v[144:159], v[236:239], v[212:215], v[144:159]
    s_add_u32 m0, s58, 18432
    s_nop 0
    buffer_load_dwordx4 v21, s[16:19], s63 offen lds
    s_add_u32 m0, s58, 19456
    s_add_u32 s64, s63, 16384
    buffer_load_dwordx4 v22, s[16:19], s64 offen lds
    s_add_u32 m0, s58, 20480
    s_add_u32 s64, s63, 32768
    buffer_load_dwordx4 v21, s[16:19], s64 offen lds
    s_add_u32 m0, s58, 21504
    s_add_u32 s64, s63, 49152
    buffer_load_dwordx4 v22, s[16:19], s64 offen lds
    s_add_u32 s65, s75, 147456
    buffer_store_dwordx4 v[32:35], v36, s[32:35], s65 offen offset:0 sc1
    s_cmp_lg_u32 s68, 3
    s_cbranch_scc1 RattA_nocs_4
    v_bfe_u32 v40, v1, 4, 1
    v_and_b32 v41, 1, v1
    v_cmp_eq_u32 vcc, v40, v41
    v_mov_b32 v42, 0x3f803f80
    s_nop 0
    v_cndmask_b32 v40, 0, v42, vcc
    v_mov_b32 v41, v40
    v_mov_b32 v42, v40
    v_mov_b32 v43, v40
    s_nop 1
    v_mfma_f32_16x16x32_bf16 v[44:47], v[40:43], v[216:219], 0
    v_mfma_f32_16x16x32_bf16 v[48:51], v[40:43], v[220:223], 0
    v_mfma_f32_16x16x32_bf16 v[52:55], v[40:43], v[224:227], 0
    v_mfma_f32_16x16x32_bf16 v[44:47], v[40:43], v[228:231], v[44:47]
    v_mfma_f32_16x16x32_bf16 v[48:51], v[40:43], v[232:235], v[48:51]
    v_mfma_f32_16x16x32_bf16 v[52:55], v[40:43], v[236:239], v[52:55]
    v_bfe_u32 v28, v1, 4, 1
    v_cmp_eq_u32 vcc, 1, v28
    s_nop 3
    v_cndmask_b32 v24, v44, v45, vcc
    v_cndmask_b32 v25, v48, v49, vcc
    v_cndmask_b32 v26, v52, v53, vcc
    v_mov_b32 v27, s56
    s_lshl_b32 s64, s54, 2
    s_add_u32 s64, s64, s52
    s_add_u32 s64, s64, 0
    s_lshl_b32 s64, s64, 4
    s_add_u32 s64, s64, s48
    s_lshl_b32 s64, s64, 9
    s_add_u32 s64, s64, 0x910000
    v_lshlrev_b32 v28, 4, v1
    s_mov_b32 exec_hi, 0
    buffer_store_dwordx4 v[24:27], v28, s[32:35], s64 offen sc1
    s_mov_b32 exec_hi, -1
RattA_nocs_4:
    s_waitcnt lgkmcnt(0)
    s_barrier
    v_mfma_f32_32x32x16_bf16 v[64:79], v[176:179], v[160:163], v[64:79]
    ds_read_b128 v[200:203], v10 offset:36864
    ds_read_b128 v[204:207], v10 offset:40960
    v_mfma_f32_32x32x16_bf16 v[80:95], v[176:179], v[164:167], v[80:95]
    ds_read_b64_tr_b16 v[216:217], v2 offset:0
    v_mfma_f32_32x32x16_bf16 v[96:111], v[180:183], v[160:163], v[96:111]
    ds_read_b64_tr_b16 v[218:219], v2 offset:512
    ds_read_b64_tr_b16 v[220:221], v2 offset:4096
    v_mfma_f32_32x32x16_bf16 v[112:127], v[180:183], v[164:167], v[112:127]
    ds_read_b64_tr_b16 v[222:223], v2 offset:4608
    v_mfma_f32_32x32x16_bf16 v[128:143], v[184:187], v[160:163], v[128:143]
    ds_read_b64_tr_b16 v[224:225], v2 offset:8192
    ds_read_b64_tr_b16 v[226:227], v2 offset:8704
    v_mfma_f32_32x32x16_bf16 v[144:159], v[184:187], v[164:167], v[144:159]
    ds_read_b128 v[208:211], v11 offset:36864
    v_mfma_f32_32x32x16_bf16 v[64:79], v[188:191], v[168:171], v[64:79]
    ds_read_b128 v[212:215], v11 offset:40960
    ds_read_b64_tr_b16 v[228:229], v2 offset:2048
    v_mfma_f32_32x32x16_bf16 v[80:95], v[188:191], v[172:175], v[80:95]
    ds_read_b64_tr_b16 v[230:231], v2 offset:2560
    v_mfma_f32_32x32x16_bf16 v[96:111], v[192:195], v[168:171], v[96:111]
    ds_read_b64_tr_b16 v[232:233], v2 offset:6144
    ds_read_b64_tr_b16 v[234:235], v2 offset:6656
    v_mfma_f32_32x32x16_bf16 v[112:127], v[192:195], v[172:175], v[112:127]
    ds_read_b64_tr_b16 v[236:237], v2 offset:10240
    v_mfma_f32_32x32x16_bf16 v[128:143], v[196:199], v[168:171], v[128:143]
    ds_read_b64_tr_b16 v[238:239], v2 offset:10752
    v_mfma_f32_32x32x16_bf16 v[144:159], v[196:199], v[172:175], v[144:159]
    s_add_u32 s65, s75, 147456
    buffer_store_dwordx4 v[32:35], v36, s[32:35], s65 offen offset:1024 sc1
    s_cmp_lg_u32 s68, 4
    s_cbranch_scc1 RattA_nocs_5
    v_bfe_u32 v40, v1, 4, 1
    v_and_b32 v41, 1, v1
    v_cmp_eq_u32 vcc, v40, v41
    v_mov_b32 v42, 0x3f803f80
    s_nop 0
    v_cndmask_b32 v40, 0, v42, vcc
    v_mov_b32 v41, v40
    v_mov_b32 v42, v40
    v_mov_b32 v43, v40
    s_nop 1
    v_mfma_f32_16x16x32_bf16 v[44:47], v[40:43], v[176:179], 0
    v_mfma_f32_16x16x32_bf16 v[48:51], v[40:43], v[180:183], 0
    v_mfma_f32_16x16x32_bf16 v[52:55], v[40:43], v[184:187], 0
    v_mfma_f32_16x16x32_bf16 v[44:47], v[40:43], v[188:191], v[44:47]
    v_mfma_f32_16x16x32_bf16 v[48:51], v[40:43], v[192:195], v[48:51]
    v_mfma_f32_16x16x32_bf16 v[52:55], v[40:43], v[196:199], v[52:55]
    v_bfe_u32 v28, v1, 4, 1
    v_cmp_eq_u32 vcc, 1, v28
    s_nop 3
    v_cndmask_b32 v24, v44, v45, vcc
    v_cndmask_b32 v25, v48, v49, vcc
    v_cndmask_b32 v26, v52, v53, vcc
    v_mov_b32 v27, s56
    s_lshl_b32 s64, s54, 2
    s_add_u32 s64, s64, s52
    s_add_u32 s64, s64, 0
    s_lshl_b32 s64, s64, 4
    s_add_u32 s64, s64, s48
    s_lshl_b32 s64, s64, 9
    s_add_u32 s64, s64, 0x910000
    v_lshlrev_b32 v28, 4, v1
    s_mov_b32 exec_hi, 0
    buffer_store_dwordx4 v[24:27], v28, s[32:35], s64 offen sc1
    s_mov_b32 exec_hi, -1
RattA_nocs_5:
    s_waitcnt vmcnt(8) lgkmcnt(0)
    s_barrier
    v_mfma_f32_32x32x16_bf16 v[64:79], v[216:219], v[200:203], v[64:79]
    ds_read_b128 v[160:163], v8 offset:0
    ds_read_b128 v[164:167], v8 offset:4096
    v_mfma_f32_32x32x16_bf16 v[80:95], v[216:219], v[204:207], v[80:95]
    ds_read_b64_tr_b16 v[176:177], v2 offset:20608
    v_mfma_f32_32x32x16_bf16 v[96:111], v[220:223], v[200:203], v[96:111]
    ds_read_b64_tr_b16 v[178:179], v2 offset:21120
    ds_read_b64_tr_b16 v[180:181], v2 offset:24704
    v_mfma_f32_32x32x16_bf16 v[112:127], v[220:223], v[204:207], v[112:127]
    ds_read_b64_tr_b16 v[182:183], v2 offset:25216
    v_mfma_f32_32x32x16_bf16 v[128:143], v[224:227], v[200:203], v[128:143]
    ds_read_b64_tr_b16 v[184:185], v2 offset:28800
    ds_read_b64_tr_b16 v[186:187], v2 offset:29312
    v_mfma_f32_32x32x16_bf16 v[144:159], v[224:227], v[204:207], v[144:159]
    ds_read_b128 v[168:171], v9 offset:0
    v_mfma_f32_32x32x16_bf16 v[64:79], v[228:231], v[208:211], v[64:79]
    ds_read_b128 v[172:175], v9 offset:4096
    ds_read_b64_tr_b16 v[188:189], v2 offset:22656
    v_mfma_f32_32x32x16_bf16 v[80:95], v[228:231], v[212:215], v[80:95]
    ds_read_b64_tr_b16 v[190:191], v2 offset:23168
    v_mfma_f32_32x32x16_bf16 v[96:111], v[232:235], v[208:211], v[96:111]
    ds_read_b64_tr_b16 v[192:193], v2 offset:26752
    ds_read_b64_tr_b16 v[194:195], v2 offset:27264
    v_mfma_f32_32x32x16_bf16 v[112:127], v[232:235], v[212:215], v[112:127]
    ds_read_b64_tr_b16 v[196:197], v2 offset:30848
    v_mfma_f32_32x32x16_bf16 v[128:143], v[236:239], v[208:211], v[128:143]
    ds_read_b64_tr_b16 v[198:199], v2 offset:31360
    v_mfma_f32_32x32x16_bf16 v[144:159], v[236:239], v[212:215], v[144:159]
    s_add_u32 m0, s58, 36864
    s_add_u32 s64, s63, 128
    buffer_load_dwordx4 v21, s[16:19], s64 offen lds
    s_add_u32 m0, s58, 37888
    s_add_u32 s64, s63, 16512
    buffer_load_dwordx4 v22, s[16:19], s64 offen lds
    s_add_u32 m0, s58, 38912
    s_add_u32 s64, s63, 32896
    buffer_load_dwordx4 v21, s[16:19], s64 offen lds
    s_add_u32 m0, s58, 39936
    s_add_u32 s64, s63, 49280
    buffer_load_dwordx4 v22, s[16:19], s64 offen lds
    s_cmp_lg_u32 s68, 5
    s_cbranch_scc1 RattA_nocs_6
    v_bfe_u32 v40, v1, 4, 1
    v_and_b32 v41, 1, v1
    v_cmp_eq_u32 vcc, v40, v41
    v_mov_b32 v42, 0x3f803f80
    s_nop 0
    v_cndmask_b32 v40, 0, v42, vcc
    v_mov_b32 v41, v40
    v_mov_b32 v42, v40
    v_mov_b32 v43, v40
    s_nop 1
    v_mfma_f32_16x16x32_bf16 v[44:47], v[40:43], v[216:219], 0
    v_mfma_f32_16x16x32_bf16 v[48:51], v[40:43], v[220:223], 0
    v_mfma_f32_16x16x32_bf16 v[52:55], v[40:43], v[224:227], 0
    v_mfma_f32_16x16x32_bf16 v[44:47], v[40:43], v[228:231], v[44:47]
    v_mfma_f32_16x16x32_bf16 v[48:51], v[40:43], v[232:235], v[48:51]
    v_mfma_f32_16x16x32_bf16 v[52:55], v[40:43], v[236:239], v[52:55]
    v_bfe_u32 v28, v1, 4, 1
    v_cmp_eq_u32 vcc, 1, v28
    s_nop 3
    v_cndmask_b32 v24, v44, v45, vcc
    v_cndmask_b32 v25, v48, v49, vcc
    v_cndmask_b32 v26, v52, v53, vcc
    v_mov_b32 v27, s56
    s_lshl_b32 s64, s54, 2
    s_add_u32 s64, s64, s52
    s_add_u32 s64, s64, 0
    s_lshl_b32 s64, s64, 4
    s_add_u32 s64, s64, s48
    s_lshl_b32 s64, s64, 9
    s_add_u32 s64, s64, 0x910000
    v_lshlrev_b32 v28, 4, v1
    s_mov_b32 exec_hi, 0
    buffer_store_dwordx4 v[24:27], v28, s[32:35], s64 offen sc1
    s_mov_b32 exec_hi, -1
RattA_nocs_6:
    s_waitcnt lgkmcnt(0)
    s_barrier
    v_mfma_f32_32x32x16_bf16 v[64:79], v[176:179], v[160:163], v[64:79]
    ds_read_b128 v[200:203], v10 offset:0
    ds_read_b128 v[204:207], v10 offset:4096
    v_mfma_f32_32x32x16_bf16 v[80:95], v[176:179], v[164:167], v[80:95]
    ds_read_b64_tr_b16 v[216:217], v2 offset:41216
    v_mfma_f32_32x32x16_bf16 v[96:111], v[180:183], v[160:163], v[96:111]
    ds_read_b64_tr_b16 v[218:219], v2 offset:41728
    ds_read_b64_tr_b16 v[220:221], v2 offset:45312
    v_mfma_f32_32x32x16_bf16 v[112:127], v[180:183], v[164:167], v[112:127]
    ds_read_b64_tr_b16 v[222:223], v2 offset:45824
    v_mfma_f32_32x32x16_bf16 v[128:143], v[184:187], v[160:163], v[128:143]
    ds_read_b64_tr_b16 v[224:225], v2 offset:49408
    ds_read_b64_tr_b16 v[226:227], v2 offset:49920
    v_mfma_f32_32x32x16_bf16 v[144:159], v[184:187], v[164:167], v[144:159]
    ds_read_b128 v[208:211], v11 offset:0
    v_mfma_f32_32x32x16_bf16 v[64:79], v[188:191], v[168:171], v[64:79]
    ds_read_b128 v[212:215], v11 offset:4096
    ds_read_b64_tr_b16 v[228:229], v2 offset:43264
    v_mfma_f32_32x32x16_bf16 v[80:95], v[188:191], v[172:175], v[80:95]
    ds_read_b64_tr_b16 v[230:231], v2 offset:43776
    v_mfma_f32_32x32x16_bf16 v[96:111], v[192:195], v[168:171], v[96:111]
    ds_read_b64_tr_b16 v[232:233], v2 offset:47360
    ds_read_b64_tr_b16 v[234:235], v2 offset:47872
    v_mfma_f32_32x32x16_bf16 v[112:127], v[192:195], v[172:175], v[112:127]
    ds_read_b64_tr_b16 v[236:237], v2 offset:51456
    v_mfma_f32_32x32x16_bf16 v[128:143], v[196:199], v[168:171], v[128:143]
    ds_read_b64_tr_b16 v[238:239], v2 offset:51968
    v_mfma_f32_32x32x16_bf16 v[144:159], v[196:199], v[172:175], v[144:159]
    v_lshrrev_b32 v63, 2, v1
    v_lshlrev_b32 v63, 10, v63
    v_and_b32 v62, 3, v1
    v_lshlrev_b32 v62, 7, v62
    v_add_u32 v63, v63, v62
    s_and_b32 s64, s2, 4
    s_lshl_b32 s64, s64, 7
    v_add_u32 v63, s64, v63
    s_lshr_b32 s64, s2, 3
    s_lshl_b32 s64, s64, 2
    s_add_u32 s64, s64, s53
    s_lshl_b32 s64, s64, 14
    s_mov_b32 exec_lo, 0xff
    s_mov_b32 exec_hi, 0x0
    buffer_load_dword v62, v63, s[40:43], s64 offen
    s_mov_b64 exec, -1
    s_cmp_lg_u32 s68, 6
    s_cbranch_scc1 RattA_nocs_7
    v_bfe_u32 v40, v1, 4, 1
    v_and_b32 v41, 1, v1
    v_cmp_eq_u32 vcc, v40, v41
    v_mov_b32 v42, 0x3f803f80
    s_nop 0
    v_cndmask_b32 v40, 0, v42, vcc
    v_mov_b32 v41, v40
    v_mov_b32 v42, v40
    v_mov_b32 v43, v40
    s_nop 1
    v_mfma_f32_16x16x32_bf16 v[44:47], v[40:43], v[176:179], 0
    v_mfma_f32_16x16x32_bf16 v[48:51], v[40:43], v[180:183], 0
    v_mfma_f32_16x16x32_bf16 v[52:55], v[40:43], v[184:187], 0
    v_mfma_f32_16x16x32_bf16 v[44:47], v[40:43], v[188:191], v[44:47]
    v_mfma_f32_16x16x32_bf16 v[48:51], v[40:43], v[192:195], v[48:51]
    v_mfma_f32_16x16x32_bf16 v[52:55], v[40:43], v[196:199], v[52:55]
    v_bfe_u32 v28, v1, 4, 1
    v_cmp_eq_u32 vcc, 1, v28
    s_nop 3
    v_cndmask_b32 v24, v44, v45, vcc
    v_cndmask_b32 v25, v48, v49, vcc
    v_cndmask_b32 v26, v52, v53, vcc
    v_mov_b32 v27, s56
    s_lshl_b32 s64, s54, 2
    s_add_u32 s64, s64, s52
    s_add_u32 s64, s64, 0
    s_lshl_b32 s64, s64, 4
    s_add_u32 s64, s64, s48
    s_lshl_b32 s64, s64, 9
    s_add_u32 s64, s64, 0x910000
    v_lshlrev_b32 v28, 4, v1
    s_mov_b32 exec_hi, 0
    buffer_store_dwordx4 v[24:27], v28, s[32:35], s64 offen sc1
    s_mov_b32 exec_hi, -1
RattA_nocs_7:
    s_waitcnt vmcnt(7) lgkmcnt(0)
    s_barrier
    v_mfma_f32_32x32x16_bf16 v[64:79], v[216:219], v[200:203], v[64:79]
    ds_read_b128 v[160:163], v8 offset:18432
    ds_read_b128 v[164:167], v8 offset:22528
    v_mfma_f32_32x32x16_bf16 v[80:95], v[216:219], v[204:207], v[80:95]
    ds_read_b64_tr_b16 v[176:177], v3 offset:0
    v_mfma_f32_32x32x16_bf16 v[96:111], v[220:223], v[200:203], v[96:111]
    ds_read_b64_tr_b16 v[178:179], v3 offset:512
    ds_read_b64_tr_b16 v[180:181], v3 offset:4096
    v_mfma_f32_32x32x16_bf16 v[112:127], v[220:223], v[204:207], v[112:127]
    ds_read_b64_tr_b16 v[182:183], v3 offset:4608
    v_mfma_f32_32x32x16_bf16 v[128:143], v[224:227], v[200:203], v[128:143]
    ds_read_b64_tr_b16 v[184:185], v3 offset:8192
    ds_read_b64_tr_b16 v[186:187], v3 offset:8704
    v_mfma_f32_32x32x16_bf16 v[144:159], v[224:227], v[204:207], v[144:159]
    ds_read_b128 v[168:171], v9 offset:18432
    v_mfma_f32_32x32x16_bf16 v[64:79], v[228:231], v[208:211], v[64:79]
    ds_read_b128 v[172:175], v9 offset:22528
    ds_read_b64_tr_b16 v[188:189], v3 offset:2048
    v_mfma_f32_32x32x16_bf16 v[80:95], v[228:231], v[212:215], v[80:95]
    ds_read_b64_tr_b16 v[190:191], v3 offset:2560
    v_mfma_f32_32x32x16_bf16 v[96:111], v[232:235], v[208:211], v[96:111]
    ds_read_b64_tr_b16 v[192:193], v3 offset:6144
    ds_read_b64_tr_b16 v[194:195], v3 offset:6656
    v_mfma_f32_32x32x16_bf16 v[112:127], v[232:235], v[212:215], v[112:127]
    ds_read_b64_tr_b16 v[196:197], v3 offset:10240
    v_mfma_f32_32x32x16_bf16 v[128:143], v[236:239], v[208:211], v[128:143]
    ds_read_b64_tr_b16 v[198:199], v3 offset:10752
    v_mfma_f32_32x32x16_bf16 v[144:159], v[236:239], v[212:215], v[144:159]
    s_add_u32 m0, s58, 0
    s_add_u32 s64, s63, 256
    buffer_load_dwordx4 v21, s[16:19], s64 offen lds
    s_add_u32 m0, s58, 1024
    s_add_u32 s64, s63, 16640
    buffer_load_dwordx4 v22, s[16:19], s64 offen lds
    s_add_u32 m0, s58, 2048
    s_add_u32 s64, s63, 33024
    buffer_load_dwordx4 v21, s[16:19], s64 offen lds
    s_add_u32 m0, s58, 3072
    s_add_u32 s64, s63, 49408
    buffer_load_dwordx4 v22, s[16:19], s64 offen lds
    s_lshr_b32 s64, s2, 3
    s_lshl_b32 s64, s64, 2
    s_add_u32 s64, s64, s53
    s_lshl_b32 s64, s64, 14
    s_mov_b32 exec_lo, 0xff00
    s_mov_b32 exec_hi, 0x0
    buffer_load_dword v62, v63, s[40:43], s64 offen
    s_mov_b64 exec, -1
    s_cmp_lg_u32 s68, 7
    s_cbranch_scc1 RattA_nocs_8
    v_bfe_u32 v40, v1, 4, 1
    v_and_b32 v41, 1, v1
    v_cmp_eq_u32 vcc, v40, v41
    v_mov_b32 v42, 0x3f803f80
    s_nop 0
    v_cndmask_b32 v40, 0, v42, vcc
    v_mov_b32 v41, v40
    v_mov_b32 v42, v40
    v_mov_b32 v43, v40
    s_nop 1
    v_mfma_f32_16x16x32_bf16 v[44:47], v[40:43], v[216:219], 0
    v_mfma_f32_16x16x32_bf16 v[48:51], v[40:43], v[220:223], 0
    v_mfma_f32_16x16x32_bf16 v[52:55], v[40:43], v[224:227], 0
    v_mfma_f32_16x16x32_bf16 v[44:47], v[40:43], v[228:231], v[44:47]
    v_mfma_f32_16x16x32_bf16 v[48:51], v[40:43], v[232:235], v[48:51]
    v_mfma_f32_16x16x32_bf16 v[52:55], v[40:43], v[236:239], v[52:55]
    v_bfe_u32 v28, v1, 4, 1
    v_cmp_eq_u32 vcc, 1, v28
    s_nop 3
    v_cndmask_b32 v24, v44, v45, vcc
    v_cndmask_b32 v25, v48, v49, vcc
    v_cndmask_b32 v26, v52, v53, vcc
    v_mov_b32 v27, s56
    s_lshl_b32 s64, s54, 2
    s_add_u32 s64, s64, s52
    s_add_u32 s64, s64, 0
    s_lshl_b32 s64, s64, 4
    s_add_u32 s64, s64, s48
    s_lshl_b32 s64, s64, 9
    s_add_u32 s64, s64, 0x910000
    v_lshlrev_b32 v28, 4, v1
    s_mov_b32 exec_hi, 0
    buffer_store_dwordx4 v[24:27], v28, s[32:35], s64 offen sc1
    s_mov_b32 exec_hi, -1
RattA_nocs_8:
    s_waitcnt lgkmcnt(0)
    s_barrier
    v_mfma_f32_32x32x16_bf16 v[64:79], v[176:179], v[160:163], v[64:79]
    ds_read_b128 v[200:203], v10 offset:18432
    ds_read_b128 v[204:207], v10 offset:22528
    v_mfma_f32_32x32x16_bf16 v[80:95], v[176:179], v[164:167], v[80:95]
    ds_read_b64_tr_b16 v[216:217], v3 offset:20608
    v_mfma_f32_32x32x16_bf16 v[96:111], v[180:183], v[160:163], v[96:111]
    ds_read_b64_tr_b16 v[218:219], v3 offset:21120
    ds_read_b64_tr_b16 v[220:221], v3 offset:24704
    v_mfma_f32_32x32x16_bf16 v[112:127], v[180:183], v[164:167], v[112:127]
    ds_read_b64_tr_b16 v[222:223], v3 offset:25216
    v_mfma_f32_32x32x16_bf16 v[128:143], v[184:187], v[160:163], v[128:143]
    ds_read_b64_tr_b16 v[224:225], v3 offset:28800
    ds_read_b64_tr_b16 v[226:227], v3 offset:29312
    v_mfma_f32_32x32x16_bf16 v[144:159], v[184:187], v[164:167], v[144:159]
    ds_read_b128 v[208:211], v11 offset:18432
    v_mfma_f32_32x32x16_bf16 v[64:79], v[188:191], v[168:171], v[64:79]
    ds_read_b128 v[212:215], v11 offset:22528
    ds_read_b64_tr_b16 v[228:229], v3 offset:22656
    v_mfma_f32_32x32x16_bf16 v[80:95], v[188:191], v[172:175], v[80:95]
    ds_read_b64_tr_b16 v[230:231], v3 offset:23168
    v_mfma_f32_32x32x16_bf16 v[96:111], v[192:195], v[168:171], v[96:111]
    ds_read_b64_tr_b16 v[232:233], v3 offset:26752
    ds_read_b64_tr_b16 v[234:235], v3 offset:27264
    v_mfma_f32_32x32x16_bf16 v[112:127], v[192:195], v[172:175], v[112:127]
    ds_read_b64_tr_b16 v[236:237], v3 offset:30848
    v_mfma_f32_32x32x16_bf16 v[128:143], v[196:199], v[168:171], v[128:143]
    ds_read_b64_tr_b16 v[238:239], v3 offset:31360
    v_mfma_f32_32x32x16_bf16 v[144:159], v[196:199], v[172:175], v[144:159]
    s_lshr_b32 s64, s2, 3
    s_lshl_b32 s64, s64, 2
    s_add_u32 s64, s64, s53
    s_lshl_b32 s64, s64, 14
    s_mov_b32 exec_lo, 0xff0000
    s_mov_b32 exec_hi, 0x0
    buffer_load_dword v62, v63, s[40:43], s64 offen
    s_mov_b64 exec, -1
    s_waitcnt vmcnt(11)
    s_lshl_b32 s64, s48, 1
    s_add_u32 s64, s64, s51
    s_lshl_b32 s64, s64, 3
    s_add_u32 s64, s64, s49
    s_lshl_b32 s64, s64, 5
    s_add_u32 s64, s64, s52
    s_lshl_b32 s64, s64, 2
    s_add_u32 s64, s64, 0x990010
    v_mov_b32 v15, s55
    s_mov_b64 exec, 1
    buffer_store_dword v15, off, s[32:35], s64 sc1
    s_mov_b64 exec, -1
    s_waitcnt vmcnt(8) lgkmcnt(0)
    s_barrier
    v_mfma_f32_32x32x16_bf16 v[64:79], v[216:219], v[200:203], v[64:79]
    ds_read_b128 v[160:163], v8 offset:36864
    ds_read_b128 v[164:167], v8 offset:40960
    v_mfma_f32_32x32x16_bf16 v[80:95], v[216:219], v[204:207], v[80:95]
    ds_read_b64_tr_b16 v[176:177], v2 offset:0
    ds_read_b64_tr_b16 v[178:179], v2 offset:512
    v_mfma_f32_32x32x16_bf16 v[96:111], v[220:223], v[200:203], v[96:111]
    ds_read_b64_tr_b16 v[180:181], v2 offset:4096
    ds_read_b64_tr_b16 v[182:183], v2 offset:4608
    v_mfma_f32_32x32x16_bf16 v[112:127], v[220:223], v[204:207], v[112:127]
    ds_read_b64_tr_b16 v[184:185], v2 offset:8192
    ds_read_b64_tr_b16 v[186:187], v2 offset:8704
    v_mfma_f32_32x32x16_bf16 v[128:143], v[224:227], v[200:203], v[128:143]
    ds_read_b128 v[168:171], v9 offset:36864
    ds_read_b128 v[172:175], v9 offset:40960
    v_mfma_f32_32x32x16_bf16 v[144:159], v[224:227], v[204:207], v[144:159]
    ds_read_b64_tr_b16 v[188:189], v2 offset:2048
    v_mfma_f32_32x32x16_bf16 v[64:79], v[228:231], v[208:211], v[64:79]
    ds_read_b64_tr_b16 v[190:191], v2 offset:2560
    ds_read_b64_tr_b16 v[192:193], v2 offset:6144
    v_mfma_f32_32x32x16_bf16 v[80:95], v[228:231], v[212:215], v[80:95]
    ds_read_b64_tr_b16 v[194:195], v2 offset:6656
    ds_read_b64_tr_b16 v[196:197], v2 offset:10240
    v_mfma_f32_32x32x16_bf16 v[96:111], v[232:235], v[208:211], v[96:111]
    ds_read_b64_tr_b16 v[198:199], v2 offset:10752
    v_and_b32 v15, 31, v1
    v_lshlrev_b32 v15, 4, v15
    v_lshrrev_b32 v60, 5, v1
    v_lshlrev_b32 v61, 11, v60
    v_add_u32 v15, v15, v61
    v_mfma_f32_32x32x16_bf16 v[112:127], v[232:235], v[212:215], v[112:127]
    s_lshl_b32 s12, s54, 2
    s_add_u32 s12, s12, s52
    s_add_u32 s12, s12, 0
    s_lshl_b32 s12, s12, 1
    s_add_u32 s12, s12, s51
    s_lshl_b32 s12, s12, 12
    s_add_u32 s12, s12, 0x910000
    v_and_b32 v61, 31, v1
    v_lshlrev_b32 v61, 5, v61
    v_lshlrev_b32 v60, 4, v60
    v_add_u32 v60, v60, v61
    v_mfma_f32_32x32x16_bf16 v[128:143], v[236:239], v[208:211], v[128:143]
    s_lshl_b32 s14, s48, 11
    s_lshl_b32 s13, s51, 10
    s_add_u32 s14, s14, s13
    s_add_u32 s14, s14, 0x900000
    v_mfma_f32_32x32x16_bf16 v[144:159], v[236:239], v[212:215], v[144:159]
    s_add_u32 m0, s58, 18432
    s_add_u32 s64, s63, 384
    buffer_load_dwordx4 v21, s[16:19], s64 offen lds
    s_add_u32 m0, s58, 19456
    s_add_u32 s64, s63, 16768
    buffer_load_dwordx4 v22, s[16:19], s64 offen lds
    s_add_u32 m0, s58, 20480
    s_add_u32 s64, s63, 33152
    buffer_load_dwordx4 v21, s[16:19], s64 offen lds
    s_add_u32 m0, s58, 21504
    s_add_u32 s64, s63, 49536
    buffer_load_dwordx4 v22, s[16:19], s64 offen lds
    s_lshr_b32 s64, s2, 3
    s_lshl_b32 s64, s64, 2
    s_add_u32 s64, s64, s53
    s_lshl_b32 s64, s64, 14
    s_mov_b32 exec_lo, 0xff000000
    s_mov_b32 exec_hi, 0x0
    buffer_load_dword v62, v63, s[40:43], s64 offen
    s_mov_b64 exec, -1
    s_waitcnt lgkmcnt(0)
    s_barrier
    v_mfma_f32_32x32x16_bf16 v[64:79], v[176:179], v[160:163], v[64:79]
    ds_read_b128 v[200:203], v10 offset:36864
    ds_read_b128 v[204:207], v10 offset:40960
    v_mfma_f32_32x32x16_bf16 v[80:95], v[176:179], v[164:167], v[80:95]
    ds_read_b64_tr_b16 v[216:217], v2 offset:20608
    v_mfma_f32_32x32x16_bf16 v[96:111], v[180:183], v[160:163], v[96:111]
    ds_read_b64_tr_b16 v[218:219], v2 offset:21120
    ds_read_b64_tr_b16 v[220:221], v2 offset:24704
    v_mfma_f32_32x32x16_bf16 v[112:127], v[180:183], v[164:167], v[112:127]
    ds_read_b64_tr_b16 v[222:223], v2 offset:25216
    v_mfma_f32_32x32x16_bf16 v[128:143], v[184:187], v[160:163], v[128:143]
    ds_read_b64_tr_b16 v[224:225], v2 offset:28800
    ds_read_b64_tr_b16 v[226:227], v2 offset:29312
    v_mfma_f32_32x32x16_bf16 v[144:159], v[184:187], v[164:167], v[144:159]
    ds_read_b128 v[208:211], v11 offset:36864
    v_mfma_f32_32x32x16_bf16 v[64:79], v[188:191], v[168:171], v[64:79]
    ds_read_b128 v[212:215], v11 offset:40960
    ds_read_b64_tr_b16 v[228:229], v2 offset:22656
    v_mfma_f32_32x32x16_bf16 v[80:95], v[188:191], v[172:175], v[80:95]
    ds_read_b64_tr_b16 v[230:231], v2 offset:23168
    v_mfma_f32_32x32x16_bf16 v[96:111], v[192:195], v[168:171], v[96:111]
    ds_read_b64_tr_b16 v[232:233], v2 offset:26752
    ds_read_b64_tr_b16 v[234:235], v2 offset:27264
    v_mfma_f32_32x32x16_bf16 v[112:127], v[192:195], v[172:175], v[112:127]
    ds_read_b64_tr_b16 v[236:237], v2 offset:30848
    v_mfma_f32_32x32x16_bf16 v[128:143], v[196:199], v[168:171], v[128:143]
    ds_read_b64_tr_b16 v[238:239], v2 offset:31360
    v_mfma_f32_32x32x16_bf16 v[144:159], v[196:199], v[172:175], v[144:159]
    buffer_load_dwordx4 v[24:27], v15, s[32:35], s12 offen offset:0 sc1
    buffer_load_dwordx4 v[28:31], v15, s[32:35], s12 offen offset:512 sc1
    buffer_load_dwordx4 v[32:35], v15, s[32:35], s12 offen offset:1024 sc1
    buffer_load_dwordx4 v[36:39], v15, s[32:35], s12 offen offset:1536 sc1
    buffer_load_dwordx4 v[56:59], v60, s[32:35], s14 offen sc1
    s_lshr_b32 s64, s2, 3
    s_lshl_b32 s64, s64, 2
    s_add_u32 s64, s64, s53
    s_lshl_b32 s64, s64, 14
    s_mov_b32 exec_lo, 0x0
    s_mov_b32 exec_hi, 0xff
    buffer_load_dword v62, v63, s[40:43], s64 offen
    s_mov_b64 exec, -1
    s_waitcnt vmcnt(14) lgkmcnt(0)
    s_barrier
    v_mfma_f32_32x32x16_bf16 v[64:79], v[216:219], v[200:203], v[64:79]
    ds_read_b128 v[160:163], v8 offset:0
    ds_read_b128 v[164:167], v8 offset:4096
    v_mfma_f32_32x32x16_bf16 v[80:95], v[216:219], v[204:207], v[80:95]
    ds_read_b64_tr_b16 v[176:177], v2 offset:41216
    v_mfma_f32_32x32x16_bf16 v[96:111], v[220:223], v[200:203], v[96:111]
    ds_read_b64_tr_b16 v[178:179], v2 offset:41728
    ds_read_b64_tr_b16 v[180:181], v2 offset:45312
    v_mfma_f32_32x32x16_bf16 v[112:127], v[220:223], v[204:207], v[112:127]
    ds_read_b64_tr_b16 v[182:183], v2 offset:45824
    v_mfma_f32_32x32x16_bf16 v[128:143], v[224:227], v[200:203], v[128:143]
    ds_read_b64_tr_b16 v[184:185], v2 offset:49408
    ds_read_b64_tr_b16 v[186:187], v2 offset:49920
    v_mfma_f32_32x32x16_bf16 v[144:159], v[224:227], v[204:207], v[144:159]
    ds_read_b128 v[168:171], v9 offset:0
    v_mfma_f32_32x32x16_bf16 v[64:79], v[228:231], v[208:211], v[64:79]
    ds_read_b128 v[172:175], v9 offset:4096
    ds_read_b64_tr_b16 v[188:189], v2 offset:43264
    v_mfma_f32_32x32x16_bf16 v[80:95], v[228:231], v[212:215], v[80:95]
    ds_read_b64_tr_b16 v[190:191], v2 offset:43776
    v_mfma_f32_32x32x16_bf16 v[96:111], v[232:235], v[208:211], v[96:111]
    ds_read_b64_tr_b16 v[192:193], v2 offset:47360
    ds_read_b64_tr_b16 v[194:195], v2 offset:47872
    v_mfma_f32_32x32x16_bf16 v[112:127], v[232:235], v[212:215], v[112:127]
    ds_read_b64_tr_b16 v[196:197], v2 offset:51456
    v_mfma_f32_32x32x16_bf16 v[128:143], v[236:239], v[208:211], v[128:143]
    ds_read_b64_tr_b16 v[198:199], v2 offset:51968
    v_mfma_f32_32x32x16_bf16 v[144:159], v[236:239], v[212:215], v[144:159]
    s_add_u32 m0, s74, 20608
    s_add_u32 s64, s71, 0
    buffer_load_dwordx4 v14, s[36:39], s64 offen lds
    s_add_u32 m0, s74, 21632
    s_add_u32 s64, s71, 4096
    buffer_load_dwordx4 v14, s[36:39], s64 offen lds
    s_add_u32 m0, s74, 139904
    s_add_u32 s64, s71, 16384
    buffer_load_dwordx4 v14, s[36:39], s64 offen lds
    s_add_u32 m0, s74, 140928
    s_add_u32 s64, s71, 20480
    buffer_load_dwordx4 v14, s[36:39], s64 offen lds
    s_lshr_b32 s64, s2, 3
    s_lshl_b32 s64, s64, 2
    s_add_u32 s64, s64, s53
    s_lshl_b32 s64, s64, 14
    s_mov_b32 exec_lo, 0x0
    s_mov_b32 exec_hi, 0xff00
    buffer_load_dword v62, v63, s[40:43], s64 offen
    s_mov_b64 exec, -1
    s_waitcnt lgkmcnt(0)
    s_barrier
    v_mfma_f32_32x32x16_bf16 v[64:79], v[176:179], v[160:163], v[64:79]
    ds_read_b128 v[200:203], v10 offset:0
    ds_read_b128 v[204:207], v10 offset:4096
    v_mfma_f32_32x32x16_bf16 v[80:95], v[176:179], v[164:167], v[80:95]
    ds_read_b64_tr_b16 v[216:217], v3 offset:0
    v_mfma_f32_32x32x16_bf16 v[96:111], v[180:183], v[160:163], v[96:111]
    ds_read_b64_tr_b16 v[218:219], v3 offset:512
    ds_read_b64_tr_b16 v[220:221], v3 offset:4096
    v_mfma_f32_32x32x16_bf16 v[112:127], v[180:183], v[164:167], v[112:127]
    ds_read_b64_tr_b16 v[222:223], v3 offset:4608
    v_mfma_f32_32x32x16_bf16 v[128:143], v[184:187], v[160:163], v[128:143]
    ds_read_b64_tr_b16 v[224:225], v3 offset:8192
    ds_read_b64_tr_b16 v[226:227], v3 offset:8704
    v_mfma_f32_32x32x16_bf16 v[144:159], v[184:187], v[164:167], v[144:159]
    ds_read_b128 v[208:211], v11 offset:0
    v_mfma_f32_32x32x16_bf16 v[64:79], v[188:191], v[168:171], v[64:79]
    ds_read_b128 v[212:215], v11 offset:4096
    ds_read_b64_tr_b16 v[228:229], v3 offset:2048
    v_mfma_f32_32x32x16_bf16 v[80:95], v[188:191], v[172:175], v[80:95]
    ds_read_b64_tr_b16 v[230:231], v3 offset:2560
    v_mfma_f32_32x32x16_bf16 v[96:111], v[192:195], v[168:171], v[96:111]
    ds_read_b64_tr_b16 v[232:233], v3 offset:6144
    ds_read_b64_tr_b16 v[234:235], v3 offset:6656
    v_mfma_f32_32x32x16_bf16 v[112:127], v[192:195], v[172:175], v[112:127]
    ds_read_b64_tr_b16 v[236:237], v3 offset:10240
    v_mfma_f32_32x32x16_bf16 v[128:143], v[196:199], v[168:171], v[128:143]
    ds_read_b64_tr_b16 v[238:239], v3 offset:10752
    v_mfma_f32_32x32x16_bf16 v[144:159], v[196:199], v[172:175], v[144:159]
    s_add_u32 m0, s74, 36992
    s_add_u32 s64, s71, 32768
    buffer_load_dwordx4 v14, s[36:39], s64 offen lds
    s_add_u32 m0, s74, 38016
    s_add_u32 s64, s71, 36864
    buffer_load_dwordx4 v14, s[36:39], s64 offen lds
    s_lshr_b32 s64, s2, 3
    s_lshl_b32 s64, s64, 2
    s_add_u32 s64, s64, s53
    s_lshl_b32 s64, s64, 14
    s_mov_b32 exec_lo, 0x0
    s_mov_b32 exec_hi, 0xff0000
    buffer_load_dword v62, v63, s[40:43], s64 offen
    s_mov_b64 exec, -1
    s_waitcnt vmcnt(15) lgkmcnt(0)
    s_barrier
    v_mfma_f32_32x32x16_bf16 v[64:79], v[216:219], v[200:203], v[64:79]
    ds_read_b128 v[160:163], v8 offset:18432
    ds_read_b128 v[164:167], v8 offset:22528
    ds_read_b64_tr_b16 v[176:177], v3 offset:20608
    v_mfma_f32_32x32x16_bf16 v[80:95], v[216:219], v[204:207], v[80:95]
    ds_read_b64_tr_b16 v[178:179], v3 offset:21120
    ds_read_b64_tr_b16 v[180:181], v3 offset:24704
    v_mfma_f32_32x32x16_bf16 v[96:111], v[220:223], v[200:203], v[96:111]
    ds_read_b64_tr_b16 v[182:183], v3 offset:25216
    ds_read_b64_tr_b16 v[184:185], v3 offset:28800
    ds_read_b64_tr_b16 v[186:187], v3 offset:29312
    v_mfma_f32_32x32x16_bf16 v[112:127], v[220:223], v[204:207], v[112:127]
    ds_read_b128 v[168:171], v9 offset:18432
    ds_read_b128 v[172:175], v9 offset:22528
    v_mfma_f32_32x32x16_bf16 v[128:143], v[224:227], v[200:203], v[128:143]
    ds_read_b64_tr_b16 v[188:189], v3 offset:22656
    ds_read_b64_tr_b16 v[190:191], v3 offset:23168
    v_mfma_f32_32x32x16_bf16 v[144:159], v[224:227], v[204:207], v[144:159]
    ds_read_b64_tr_b16 v[192:193], v3 offset:26752
    ds_read_b64_tr_b16 v[194:195], v3 offset:27264
    ds_read_b64_tr_b16 v[196:197], v3 offset:30848
    v_mfma_f32_32x32x16_bf16 v[64:79], v[228:231], v[208:211], v[64:79]
    ds_read_b64_tr_b16 v[198:199], v3 offset:31360
    s_waitcnt vmcnt(9)
    v_cmp_ne_u32 s[10:11], s56, v27
    v_cmp_ne_u32 vcc, s56, v31
    s_or_b64 s[10:11], s[10:11], vcc
    v_cmp_ne_u32 vcc, s56, v35
    s_or_b64 s[10:11], s[10:11], vcc
    v_cmp_ne_u32 vcc, s56, v39
    s_or_b64 s[10:11], s[10:11], vcc
    v_cmp_ne_u32 vcc, s55, v59
    s_or_b64 s[10:11], s[10:11], vcc
    s_cmp_lg_u64 s[10:11], 0
    s_cbranch_scc1 RattA_retry
RattA_recok:
    v_mfma_f32_32x32x16_bf16 v[80:95], v[228:231], v[212:215], v[80:95]
    v_add_f32 v24, v24, v28
    v_add_f32 v32, v32, v36
    v_add_f32 v25, v25, v29
    v_add_f32 v33, v33, v37
    v_add_f32 v26, v26, v30
    v_add_f32 v34, v34, v38
    v_mfma_f32_32x32x16_bf16 v[96:111], v[232:235], v[208:211], v[96:111]
    v_add_f32 v24, v24, v32
    v_add_f32 v25, v25, v33
    v_add_f32 v26, v26, v34
    v_mov_b32 v28, v24
    v_mov_b32 v29, v25
    v_mov_b32 v30, v26
    s_add_u32 s66, s52, 0
    s_lshl_b32 s66, s66, 10
    s_lshl_b32 s67, s51, 9
    s_add_u32 s67, s67, s66
    s_add_u32 s67, s67, 158592
    v_permlane32_swap_b32 v24, v28
    v_permlane32_swap_b32 v25, v29
    v_permlane32_swap_b32 v26, v30
    v_and_b32 v40, 31, v1
    v_lshlrev_b32 v40, 4, v40
    v_mfma_f32_32x32x16_bf16 v[112:127], v[232:235], v[212:215], v[112:127]
    v_add_f32 v24, v24, v28
    v_add_f32 v25, v25, v29
    v_add_f32 v26, v26, v30
    v_add_u32 v41, s67, v40
    ds_write_b128 v41, v[24:27]
    v_lshrrev_b32 v42, 5, v1
    v_lshlrev_b32 v42, 9, v42
    v_add_u32 v42, v42, v40
    s_add_u32 s66, s66, 158592
    v_add_u32 v42, s66, v42
    v_mfma_f32_32x32x16_bf16 v[128:143], v[236:239], v[208:211], v[128:143]
    v_mov_b32 v28, v56
    v_mov_b32 v29, v57
    v_mov_b32 v30, v56
    v_mov_b32 v31, v57
    s_nop 0
    v_permlane32_swap_b32 v28, v30
    v_permlane32_swap_b32 v29, v31
    v_mfma_f32_32x32x16_bf16 v[144:159], v[236:239], v[212:215], v[144:159]
    s_add_u32 m0, s74, 53376
    s_add_u32 s64, s71, 49152
    buffer_load_dwordx4 v14, s[36:39], s64 offen lds
    s_add_u32 m0, s74, 54400
    s_add_u32 s64, s71, 53248
    buffer_load_dwordx4 v14, s[36:39], s64 offen lds
    s_lshr_b32 s64, s2, 3
    s_lshl_b32 s64, s64, 2
    s_add_u32 s64, s64, s53
    s_lshl_b32 s64, s64, 14
    s_mov_b32 exec_lo, 0x0
    s_mov_b32 exec_hi, 0xff000000
    buffer_load_dword v62, v63, s[40:43], s64 offen
    s_mov_b64 exec, -1
    s_waitcnt lgkmcnt(0)
    s_barrier
    v_mfma_f32_32x32x16_bf16 v[64:79], v[176:179], v[160:163], v[64:79]
    ds_read_b128 v[200:203], v10 offset:18432
    ds_read_b128 v[204:207], v10 offset:22528
    v_mfma_f32_32x32x16_bf16 v[80:95], v[176:179], v[164:167], v[80:95]
    ds_read_b64_tr_b16 v[216:217], v2 offset:0
    ds_read_b64_tr_b16 v[218:219], v2 offset:512
    v_mfma_f32_32x32x16_bf16 v[96:111], v[180:183], v[160:163], v[96:111]
    ds_read_b64_tr_b16 v[220:221], v2 offset:4096
    v_mfma_f32_32x32x16_bf16 v[112:127], v[180:183], v[164:167], v[112:127]
    ds_read_b64_tr_b16 v[222:223], v2 offset:4608
    ds_read_b64_tr_b16 v[224:225], v2 offset:8192
    v_mfma_f32_32x32x16_bf16 v[128:143], v[184:187], v[160:163], v[128:143]
    ds_read_b64_tr_b16 v[226:227], v2 offset:8704
    v_mfma_f32_32x32x16_bf16 v[144:159], v[184:187], v[164:167], v[144:159]
    ds_read_b128 v[208:211], v11 offset:18432
    ds_read_b128 v[212:215], v11 offset:22528
    v_mfma_f32_32x32x16_bf16 v[64:79], v[188:191], v[168:171], v[64:79]
    ds_read_b64_tr_b16 v[228:229], v2 offset:2048
    v_mfma_f32_32x32x16_bf16 v[80:95], v[188:191], v[172:175], v[80:95]
    ds_read_b64_tr_b16 v[230:231], v2 offset:2560
    ds_read_b64_tr_b16 v[232:233], v2 offset:6144
    v_mfma_f32_32x32x16_bf16 v[96:111], v[192:195], v[168:171], v[96:111]
    ds_read_b64_tr_b16 v[234:235], v2 offset:6656
    v_mfma_f32_32x32x16_bf16 v[112:127], v[192:195], v[172:175], v[112:127]
    ds_read_b64_tr_b16 v[236:237], v2 offset:10240
    ds_read_b64_tr_b16 v[238:239], v2 offset:10752
    v_mfma_f32_32x32x16_bf16 v[128:143], v[196:199], v[168:171], v[128:143]
    ds_read_b128 v[24:27], v42
    v_mfma_f32_32x32x16_bf16 v[144:159], v[196:199], v[172:175], v[144:159]
    s_add_u32 m0, s74, 69760
    s_add_u32 s64, s71, 65536
    buffer_load_dwordx4 v14, s[36:39], s64 offen lds
    s_add_u32 m0, s74, 70784
    s_add_u32 s64, s71, 69632
    buffer_load_dwordx4 v14, s[36:39], s64 offen lds
    s_add_u32 m0, s74, 86144
    s_add_u32 s64, s71, 81920
    buffer_load_dwordx4 v14, s[36:39], s64 offen lds
    s_add_u32 m0, s74, 87168
    s_add_u32 s64, s71, 86016
    buffer_load_dwordx4 v14, s[36:39], s64 offen lds
    s_lshr_b32 s64, s2, 3
    s_lshl_b32 s64, s64, 14
    s_lshl_b32 s65, s53, 4
    s_lshl_b64 exec, 0xffff, s65
    buffer_load_dword v62, v63, s[36:39], s64 offen
    s_mov_b64 exec, -1
    s_or_b32 s64, s48, s50
    s_cmp_lg_u32 s64, 0
    s_cbranch_scc1 RattA_nobump_9
    s_lshl_b32 s64, s54, 7
    s_add_u32 s64, s64, 0x999000
    v_mov_b32 v15, s56
    s_mov_b64 exec, 1
    buffer_store_dword v15, off, s[32:35], s64 sc1
    s_mov_b64 exec, -1
RattA_nobump_9:
    s_waitcnt lgkmcnt(0)
    s_barrier
    v_mfma_f32_32x32x16_bf16 v[64:79], v[216:219], v[200:203], v[64:79]
    v_sub_f32 v41, 0, v28
    v_cvt_pk_bf16_f32 v40, v41, v41
    v_and_b32 v40, 0xffff0000, v40
    v_sub_f32 v40, v41, v40
    v_cvt_pk_bf16_f32 v160, v41, v40
    v_mov_b32 v161, v160
    v_mov_b32 v162, 0
    v_mov_b32 v163, 0
    v_mfma_f32_32x32x16_bf16 v[80:95], v[216:219], v[204:207], v[80:95]
    v_mfma_f32_32x32x16_bf16 v[96:111], v[220:223], v[200:203], v[96:111]
    v_sub_f32 v41, 0, v30
    v_cvt_pk_bf16_f32 v40, v41, v41
    v_and_b32 v40, 0xffff0000, v40
    v_sub_f32 v40, v41, v40
    v_cvt_pk_bf16_f32 v164, v41, v40
    v_mov_b32 v165, v164
    v_mov_b32 v166, 0
    v_mov_b32 v167, 0
    v_mfma_f32_32x32x16_bf16 v[112:127], v[220:223], v[204:207], v[112:127]
    v_mfma_f32_32x32x16_bf16 v[128:143], v[224:227], v[200:203], v[128:143]
    v_cvt_pk_bf16_f32 v176, v24, v24
    v_and_b32 v40, 0xffff0000, v176
    v_sub_f32 v40, v24, v40
    v_cvt_pk_bf16_f32 v177, v40, v40
    v_mov_b32 v178, 0
    v_mov_b32 v179, 0
    v_mfma_f32_32x32x16_bf16 v[144:159], v[224:227], v[204:207], v[144:159]
    v_mfma_f32_32x32x16_bf16 v[64:79], v[228:231], v[208:211], v[64:79]
    v_cvt_pk_bf16_f32 v180, v25, v25
    v_and_b32 v40, 0xffff0000, v180
    v_sub_f32 v40, v25, v40
    v_cvt_pk_bf16_f32 v181, v40, v40
    v_mov_b32 v182, 0
    v_mov_b32 v183, 0
    v_mfma_f32_32x32x16_bf16 v[80:95], v[228:231], v[212:215], v[80:95]
    v_mfma_f32_32x32x16_bf16 v[96:111], v[232:235], v[208:211], v[96:111]
    v_cvt_pk_bf16_f32 v184, v26, v26
    v_and_b32 v40, 0xffff0000, v184
    v_sub_f32 v40, v26, v40
    v_cvt_pk_bf16_f32 v185, v40, v40
    v_mov_b32 v186, 0
    v_mov_b32 v187, 0
    v_mfma_f32_32x32x16_bf16 v[112:127], v[232:235], v[212:215], v[112:127]
    v_mfma_f32_32x32x16_bf16 v[128:143], v[236:239], v[208:211], v[128:143]
    v_mfma_f32_32x32x16_bf16 v[144:159], v[236:239], v[212:215], v[144:159]
    s_add_u32 m0, s78, 102528
    s_add_u32 s64, s71, 98304
    buffer_load_dwordx4 v14, s[36:39], s64 offen lds
    s_add_u32 m0, s78, 103552
    s_add_u32 s64, s71, 102400
    buffer_load_dwordx4 v14, s[36:39], s64 offen lds
    s_add_u32 m0, s78, 104576
    s_add_u32 s64, s71, 114688
    buffer_load_dwordx4 v14, s[36:39], s64 offen lds
    s_add_u32 m0, s78, 105600
    s_add_u32 s64, s71, 118784
    buffer_load_dwordx4 v14, s[36:39], s64 offen lds
    s_setprio 3
    v_mfma_f32_32x32x16_bf16 v[64:79], v[176:179], v[160:163], v[64:79]
    v_mfma_f32_32x32x16_bf16 v[80:95], v[176:179], v[164:167], v[80:95]
    v_mfma_f32_32x32x16_bf16 v[96:111], v[180:183], v[160:163], v[96:111]
    v_mfma_f32_32x32x16_bf16 v[112:127], v[180:183], v[164:167], v[112:127]
    v_mfma_f32_32x32x16_bf16 v[128:143], v[184:187], v[160:163], v[128:143]
    v_mfma_f32_32x32x16_bf16 v[144:159], v[184:187], v[164:167], v[144:159]
    v_lshrrev_b32 v16, 4, v1
    v_bfe_u32 v17, v1, 2, 2
    v_and_b32 v18, 3, v1
    v_lshrrev_b32 v5, 1, v16
    v_lshlrev_b32 v5, 3, v5
    v_add_u32 v5, v5, v17
    v_lshlrev_b32 v5, 7, v5
    v_lshrrev_b32 v17, 1, v17
    v_lshlrev_b32 v17, 6, v17
    v_add_u32 v5, v5, v17
    v_and_b32 v16, 1, v16
    v_lshlrev_b32 v16, 5, v16
    v_add_u32 v5, v5, v16
    v_lshlrev_b32 v18, 3, v18
    v_add_u32 v5, v5, v18
    v_add_u32 v2, s74, v5
    v_lshlrev_b32 v3, 4, v1
    s_lshl_b32 s64, s53, 17
    s_lshl_b32 s65, s70, 7
    s_add_u32 s75, s64, s65
    s_lshl_b32 s64, s53, 13
    s_add_u32 s76, s72, s64
    s_lshl_b32 s77, s69, 10
    s_add_u32 s77, s77, 0x990000
    s_lshl_b32 s64, s53, 8
    s_add_u32 s77, s77, s64
    v_and_b32 v12, 7, v1
    v_lshlrev_b32 v12, 2, v12
    v_bfe_u32 v13, v1, 3, 1
    v_lshlrev_b32 v13, 7, v13
    v_add_u32 v12, v12, v13
    s_mov_b64 exec, 0xffff
    buffer_load_dword v13, v12, s[32:35], s77 offen sc1
    s_mov_b64 exec, -1
    s_lshl_b32 s65, s48, 2
    s_lshl_b32 s66, s51, 1
    s_add_u32 s65, s65, s66
    s_mul_i32 s65, s65, 147456
    v_mul_f32 v40, 0x3eb8aa3b, v29
    v_mul_f32 v42, 0x3eb8aa3b, v31
    v_pk_mul_f32 v[96:97], v[96:97], v[28:29] op_sel:[0,1] op_sel_hi:[1,1]
    v_pk_mul_f32 v[98:99], v[98:99], v[28:29] op_sel:[0,1] op_sel_hi:[1,1]
    v_pk_mul_f32 v[100:101], v[100:101], v[28:29] op_sel:[0,1] op_sel_hi:[1,1]
    v_pk_mul_f32 v[102:103], v[102:103], v[28:29] op_sel:[0,1] op_sel_hi:[1,1]
    v_pk_mul_f32 v[104:105], v[104:105], v[28:29] op_sel:[0,1] op_sel_hi:[1,1]
    v_pk_mul_f32 v[106:107], v[106:107], v[28:29] op_sel:[0,1] op_sel_hi:[1,1]
    v_pk_mul_f32 v[108:109], v[108:109], v[28:29] op_sel:[0,1] op_sel_hi:[1,1]
    v_pk_mul_f32 v[110:111], v[110:111], v[28:29] op_sel:[0,1] op_sel_hi:[1,1]
    v_cvt_pk_bf16_f32 v96, v96, v97
    v_cvt_pk_bf16_f32 v97, v98, v99
    v_cvt_pk_bf16_f32 v98, v100, v101
    v_cvt_pk_bf16_f32 v99, v102, v103
    v_cvt_pk_bf16_f32 v100, v104, v105
    v_cvt_pk_bf16_f32 v101, v106, v107
    v_cvt_pk_bf16_f32 v102, v108, v109
    v_cvt_pk_bf16_f32 v103, v110, v111
    v_permlane32_swap_b32 v96, v100
    v_permlane32_swap_b32 v97, v101
    v_permlane32_swap_b32 v98, v102
    v_permlane32_swap_b32 v99, v103
    v_pk_mul_f32 v[112:113], v[112:113], v[30:31] op_sel:[0,1] op_sel_hi:[1,1]
    v_pk_mul_f32 v[114:115], v[114:115], v[30:31] op_sel:[0,1] op_sel_hi:[1,1]
    v_pk_mul_f32 v[116:117], v[116:117], v[30:31] op_sel:[0,1] op_sel_hi:[1,1]
    v_pk_mul_f32 v[118:119], v[118:119], v[30:31] op_sel:[0,1] op_sel_hi:[1,1]
    v_pk_mul_f32 v[120:121], v[120:121], v[30:31] op_sel:[0,1] op_sel_hi:[1,1]
    v_pk_mul_f32 v[122:123], v[122:123], v[30:31] op_sel:[0,1] op_sel_hi:[1,1]
    v_pk_mul_f32 v[124:125], v[124:125], v[30:31] op_sel:[0,1] op_sel_hi:[1,1]
    v_pk_mul_f32 v[126:127], v[126:127], v[30:31] op_sel:[0,1] op_sel_hi:[1,1]
    v_cvt_pk_bf16_f32 v112, v112, v113
    v_cvt_pk_bf16_f32 v113, v114, v115
    v_cvt_pk_bf16_f32 v114, v116, v117
    v_cvt_pk_bf16_f32 v115, v118, v119
    v_cvt_pk_bf16_f32 v116, v120, v121
    v_cvt_pk_bf16_f32 v117, v122, v123
    v_cvt_pk_bf16_f32 v118, v124, v125
    v_cvt_pk_bf16_f32 v119, v126, v127
    v_permlane32_swap_b32 v112, v116
    v_permlane32_swap_b32 v113, v117
    v_permlane32_swap_b32 v114, v118
    v_permlane32_swap_b32 v115, v119
    v_and_b32 v45, 31, v1
    v_lshrrev_b32 v46, 5, v1
    s_lshl_b32 s64, s51, 5
    s_add_u32 s64, s64, 8
    v_add_u32 v45, s64, v45
    s_mul_i32 s64, s52, 9216
    s_add_u32 s64, s64, 0
    v_mul_u32_u24 v44, 2304, v46
    v_lshlrev_b32 v47, 4, v45
    v_add_u32 v44, v44, v47
    v_add_u32 v44, s64, v44
    ds_write_b128 v44, v[96:99] offset:0
    ds_write_b128 v44, v[100:103] offset:1152
    ds_write_b128 v44, v[112:115] offset:4608
    ds_write_b128 v44, v[116:119] offset:5760
    v_pk_mul_f32 v[128:129], v[128:129], v[28:29] op_sel:[0,1] op_sel_hi:[1,1]
    v_pk_mul_f32 v[130:131], v[130:131], v[28:29] op_sel:[0,1] op_sel_hi:[1,1]
    v_pk_mul_f32 v[132:133], v[132:133], v[28:29] op_sel:[0,1] op_sel_hi:[1,1]
    v_pk_mul_f32 v[134:135], v[134:135], v[28:29] op_sel:[0,1] op_sel_hi:[1,1]
    v_pk_mul_f32 v[136:137], v[136:137], v[28:29] op_sel:[0,1] op_sel_hi:[1,1]
    v_pk_mul_f32 v[138:139], v[138:139], v[28:29] op_sel:[0,1] op_sel_hi:[1,1]
    v_pk_mul_f32 v[140:141], v[140:141], v[28:29] op_sel:[0,1] op_sel_hi:[1,1]
    v_pk_mul_f32 v[142:143], v[142:143], v[28:29] op_sel:[0,1] op_sel_hi:[1,1]
    v_cvt_pk_bf16_f32 v128, v128, v129
    v_cvt_pk_bf16_f32 v129, v130, v131
    v_cvt_pk_bf16_f32 v130, v132, v133
    v_cvt_pk_bf16_f32 v131, v134, v135
    v_cvt_pk_bf16_f32 v132, v136, v137
    v_cvt_pk_bf16_f32 v133, v138, v139
    v_cvt_pk_bf16_f32 v134, v140, v141
    v_cvt_pk_bf16_f32 v135, v142, v143
    v_pk_mul_f32 v[144:145], v[144:145], v[30:31] op_sel:[0,1] op_sel_hi:[1,1]
    v_pk_mul_f32 v[146:147], v[146:147], v[30:31] op_sel:[0,1] op_sel_hi:[1,1]
    v_pk_mul_f32 v[148:149], v[148:149], v[30:31] op_sel:[0,1] op_sel_hi:[1,1]
    v_pk_mul_f32 v[150:151], v[150:151], v[30:31] op_sel:[0,1] op_sel_hi:[1,1]
    v_pk_mul_f32 v[152:153], v[152:153], v[30:31] op_sel:[0,1] op_sel_hi:[1,1]
    v_pk_mul_f32 v[154:155], v[154:155], v[30:31] op_sel:[0,1] op_sel_hi:[1,1]
    v_pk_mul_f32 v[156:157], v[156:157], v[30:31] op_sel:[0,1] op_sel_hi:[1,1]
    v_pk_mul_f32 v[158:159], v[158:159], v[30:31] op_sel:[0,1] op_sel_hi:[1,1]
    v_cvt_pk_bf16_f32 v144, v144, v145
    v_cvt_pk_bf16_f32 v145, v146, v147
    v_cvt_pk_bf16_f32 v146, v148, v149
    v_cvt_pk_bf16_f32 v147, v150, v151
    v_cvt_pk_bf16_f32 v148, v152, v153
    v_cvt_pk_bf16_f32 v149, v154, v155
    v_cvt_pk_bf16_f32 v150, v156, v157
    v_cvt_pk_bf16_f32 v151, v158, v159
    s_mul_i32 s66, s52, 9216
    s_add_u32 s66, s66, 121472
    v_mul_u32_u24 v47, 576, v46
    v_lshlrev_b32 v48, 3, v45
    v_add_u32 v47, v47, v48
    v_add_u32 v47, s66, v47
    ds_write_b64 v47, v[128:129] offset:0
    ds_write_b64 v47, v[130:131] offset:1152
    ds_write_b64 v47, v[132:133] offset:2304
    ds_write_b64 v47, v[134:135] offset:3456
    ds_write_b64 v47, v[144:145] offset:4608
    ds_write_b64 v47, v[146:147] offset:5760
    ds_write_b64 v47, v[148:149] offset:6912
    ds_write_b64 v47, v[150:151] offset:8064
    v_pk_mul_f32 v[64:65], v[64:65], v[40:41] op_sel_hi:[1,0]
    v_pk_mul_f32 v[66:67], v[66:67], v[40:41] op_sel_hi:[1,0]
    v_pk_mul_f32 v[68:69], v[68:69], v[40:41] op_sel_hi:[1,0]
    v_pk_mul_f32 v[70:71], v[70:71], v[40:41] op_sel_hi:[1,0]
    v_pk_mul_f32 v[72:73], v[72:73], v[40:41] op_sel_hi:[1,0]
    v_pk_mul_f32 v[74:75], v[74:75], v[40:41] op_sel_hi:[1,0]
    v_pk_mul_f32 v[76:77], v[76:77], v[40:41] op_sel_hi:[1,0]
    v_pk_mul_f32 v[78:79], v[78:79], v[40:41] op_sel_hi:[1,0]
    v_cvt_pk_bf16_f32 v64, v64, v65
    v_cvt_pk_bf16_f32 v65, v66, v67
    v_cvt_pk_bf16_f32 v66, v68, v69
    v_cvt_pk_bf16_f32 v67, v70, v71
    v_cvt_pk_bf16_f32 v68, v72, v73
    v_cvt_pk_bf16_f32 v69, v74, v75
    v_cvt_pk_bf16_f32 v70, v76, v77
    v_cvt_pk_bf16_f32 v71, v78, v79
    v_permlane32_swap_b32 v64, v68
    v_permlane32_swap_b32 v65, v69
    v_permlane32_swap_b32 v66, v70
    v_permlane32_swap_b32 v67, v71
    v_pk_mul_f32 v[80:81], v[80:81], v[42:43] op_sel_hi:[1,0]
    v_pk_mul_f32 v[82:83], v[82:83], v[42:43] op_sel_hi:[1,0]
    v_pk_mul_f32 v[84:85], v[84:85], v[42:43] op_sel_hi:[1,0]
    v_pk_mul_f32 v[86:87], v[86:87], v[42:43] op_sel_hi:[1,0]
    v_pk_mul_f32 v[88:89], v[88:89], v[42:43] op_sel_hi:[1,0]
    v_pk_mul_f32 v[90:91], v[90:91], v[42:43] op_sel_hi:[1,0]
    v_pk_mul_f32 v[92:93], v[92:93], v[42:43] op_sel_hi:[1,0]
    v_pk_mul_f32 v[94:95], v[94:95], v[42:43] op_sel_hi:[1,0]
    v_cvt_pk_bf16_f32 v80, v80, v81
    v_cvt_pk_bf16_f32 v81, v82, v83
    v_cvt_pk_bf16_f32 v82, v84, v85
    v_cvt_pk_bf16_f32 v83, v86, v87
    v_cvt_pk_bf16_f32 v84, v88, v89
    v_cvt_pk_bf16_f32 v85, v90, v91
    v_cvt_pk_bf16_f32 v86, v92, v93
    v_cvt_pk_bf16_f32 v87, v94, v95
    v_permlane32_swap_b32 v80, v84
    v_permlane32_swap_b32 v81, v85
    v_permlane32_swap_b32 v82, v86
    v_permlane32_swap_b32 v83, v87
    s_waitcnt lgkmcnt(0)
    s_barrier
    v_subrev_u32 v44, 128, v44
    ds_read_b128 v[160:163], v44 offset:64
    ds_read_b128 v[164:167], v44 offset:1216
    ds_read_b128 v[168:171], v44 offset:0
    ds_read_b128 v[172:175], v44 offset:1152
    ds_read_b128 v[176:179], v44 offset:4672
    ds_read_b128 v[180:183], v44 offset:5824
    ds_read_b128 v[184:187], v44 offset:4608
    ds_read_b128 v[188:191], v44 offset:5760
    v_lshrrev_b32 v46, 4, v1
    v_bfe_u32 v47, v1, 2, 2
    v_and_b32 v48, 3, v1
    v_and_b32 v49, 1, v46
    v_lshlrev_b32 v49, 4, v49
    v_lshlrev_b32 v48, 2, v48
    v_add_u32 v49, v49, v48
    v_add_u32 v49, v49, v47
    s_lshl_b32 s67, s51, 5
    v_add_u32 v49, s67, v49
    v_lshlrev_b32 v49, 3, v49
    v_lshrrev_b32 v46, 1, v46
    v_mul_u32_u24 v46, 2304, v46
    v_add_u32 v49, v49, v46
    v_add_u32 v49, s66, v49
    s_or_b32 s66, s48, s51
    s_cmp_eq_u32 s66, 0
    s_cselect_b32 s66, 0xce6e6b28, 0
    v_and_b32 v50, 31, v1
    v_mov_b32 v51, s66
    v_cmp_gt_u32 vcc, 4, v50
    s_nop 1
    v_cndmask_b32 v52, 0, v51, vcc
    v_cmp_gt_u32 vcc, 8, v50
    s_nop 1
    v_cndmask_b32 v53, 0, v51, vcc
    v_mov_b32 v128, 0
    v_mov_b32 v132, v52
    v_mov_b32 v136, v53
    v_mov_b32 v129, 0
    v_mov_b32 v133, v52
    v_mov_b32 v137, v53
    v_mov_b32 v130, 0
    v_mov_b32 v134, v52
    v_mov_b32 v138, v53
    v_mov_b32 v131, 0
    v_mov_b32 v135, v52
    v_mov_b32 v139, v53
    v_mov_b32 v140, 0
    v_mov_b32 v144, v52
    v_mov_b32 v148, v53
    v_mov_b32 v141, 0
    v_mov_b32 v145, v52
    v_mov_b32 v149, v53
    v_mov_b32 v142, 0
    v_mov_b32 v146, v52
    v_mov_b32 v150, v53
    v_mov_b32 v143, 0
    v_mov_b32 v147, v52
    v_mov_b32 v151, v53
    s_waitcnt lgkmcnt(0)
    ds_read_b64_tr_b16 v[192:193], v49 offset:64
    ds_read_b64_tr_b16 v[194:195], v49 offset:640
    ds_read_b64_tr_b16 v[196:197], v49 offset:1216
    ds_read_b64_tr_b16 v[198:199], v49 offset:1792
    ds_read_b64_tr_b16 v[200:201], v49 offset:32
    ds_read_b64_tr_b16 v[202:203], v49 offset:608
    ds_read_b64_tr_b16 v[204:205], v49 offset:1184
    ds_read_b64_tr_b16 v[206:207], v49 offset:1760
    ds_read_b64_tr_b16 v[208:209], v49 offset:0
    ds_read_b64_tr_b16 v[210:211], v49 offset:576
    ds_read_b64_tr_b16 v[212:213], v49 offset:1152
    ds_read_b64_tr_b16 v[214:215], v49 offset:1728
    ds_read_b64_tr_b16 v[216:217], v49 offset:4672
    ds_read_b64_tr_b16 v[218:219], v49 offset:5248
    ds_read_b64_tr_b16 v[220:221], v49 offset:5824
    ds_read_b64_tr_b16 v[222:223], v49 offset:6400
    ds_read_b64_tr_b16 v[224:225], v49 offset:4640
    ds_read_b64_tr_b16 v[226:227], v49 offset:5216
    ds_read_b64_tr_b16 v[228:229], v49 offset:5792
    ds_read_b64_tr_b16 v[230:231], v49 offset:6368
    ds_read_b64_tr_b16 v[232:233], v49 offset:4608
    ds_read_b64_tr_b16 v[234:235], v49 offset:5184
    ds_read_b64_tr_b16 v[236:237], v49 offset:5760
    ds_read_b64_tr_b16 v[238:239], v49 offset:6336
    v_mfma_f32_4x4x4_16b_bf16 v[128:131], v[96:97], v[64:65], v[128:131]
    v_mfma_f32_4x4x4_16b_bf16 v[132:135], v[160:161], v[64:65], v[132:135]
    v_mfma_f32_4x4x4_16b_bf16 v[136:139], v[168:169], v[64:65], v[136:139]
    v_mfma_f32_4x4x4_16b_bf16 v[140:143], v[112:113], v[80:81], v[140:143]
    v_mfma_f32_4x4x4_16b_bf16 v[144:147], v[176:177], v[80:81], v[144:147]
    v_mfma_f32_4x4x4_16b_bf16 v[148:151], v[184:185], v[80:81], v[148:151]
    v_mfma_f32_4x4x4_16b_bf16 v[128:131], v[98:99], v[66:67], v[128:131]
    v_mfma_f32_4x4x4_16b_bf16 v[132:135], v[162:163], v[66:67], v[132:135]
    v_mfma_f32_4x4x4_16b_bf16 v[136:139], v[170:171], v[66:67], v[136:139]
    v_mfma_f32_4x4x4_16b_bf16 v[140:143], v[114:115], v[82:83], v[140:143]
    v_mfma_f32_4x4x4_16b_bf16 v[144:147], v[178:179], v[82:83], v[144:147]
    v_mfma_f32_4x4x4_16b_bf16 v[148:151], v[186:187], v[82:83], v[148:151]
    v_mfma_f32_4x4x4_16b_bf16 v[128:131], v[100:101], v[68:69], v[128:131]
    v_mfma_f32_4x4x4_16b_bf16 v[132:135], v[164:165], v[68:69], v[132:135]
    v_mfma_f32_4x4x4_16b_bf16 v[136:139], v[172:173], v[68:69], v[136:139]
    v_mfma_f32_4x4x4_16b_bf16 v[140:143], v[116:117], v[84:85], v[140:143]
    v_mfma_f32_4x4x4_16b_bf16 v[144:147], v[180:181], v[84:85], v[144:147]
    v_mfma_f32_4x4x4_16b_bf16 v[148:151], v[188:189], v[84:85], v[148:151]
    v_mfma_f32_4x4x4_16b_bf16 v[128:131], v[102:103], v[70:71], v[128:131]
    v_mfma_f32_4x4x4_16b_bf16 v[132:135], v[166:167], v[70:71], v[132:135]
    v_mfma_f32_4x4x4_16b_bf16 v[136:139], v[174:175], v[70:71], v[136:139]
    v_mfma_f32_4x4x4_16b_bf16 v[140:143], v[118:119], v[86:87], v[140:143]
    v_mfma_f32_4x4x4_16b_bf16 v[144:147], v[182:183], v[86:87], v[144:147]
    v_mfma_f32_4x4x4_16b_bf16 v[148:151], v[190:191], v[86:87], v[148:151]
    s_mov_b32 s4, 0xeeeeeeee
    s_mov_b32 s5, 0xeeeeeeee
    s_mov_b32 s6, 0xcccccccc
    s_mov_b32 s7, 0xcccccccc
    s_mov_b32 s8, 0x88888888
    s_mov_b32 s9, 0x88888888
    v_mov_b32 v54, 0xffff
    v_mov_b32 v58, 0xffffffff
    v_cndmask_b32 v54, v54, v58, s[4:5]
    v_mov_b32 v55, 0
    v_mov_b32 v59, 0xffff
    v_cndmask_b32 v55, v55, v59, s[6:7]
    v_cndmask_b32 v55, v55, v58, s[8:9]
    v_not_b32 v56, v54
    v_not_b32 v57, v55
    v_cndmask_b32 v129, v137, v129, s[4:5]
    v_cndmask_b32 v130, v138, v130, s[6:7]
    v_cndmask_b32 v131, v139, v131, s[8:9]
    v_max3_f32 v104, v128, v129, v130
    v_max3_f32 v105, v131, v132, v133
    v_max3_f32 v104, v134, v135, v104
    v_max_f32 v104, v104, v105
    v_sub_f32 v128, v128, v104
    v_sub_f32 v129, v129, v104
    v_sub_f32 v130, v130, v104
    v_sub_f32 v131, v131, v104
    v_sub_f32 v132, v132, v104
    v_sub_f32 v133, v133, v104
    v_sub_f32 v134, v134, v104
    v_sub_f32 v135, v135, v104
    v_exp_f32 v128, v128
    v_exp_f32 v129, v129
    v_exp_f32 v130, v130
    v_exp_f32 v131, v131
    v_exp_f32 v132, v132
    v_exp_f32 v133, v133
    v_exp_f32 v134, v134
    v_exp_f32 v135, v135
    v_add_f32 v104, v128, v129
    v_add_f32 v105, v130, v131
    v_add_f32 v106, v132, v133
    v_add_f32 v107, v134, v135
    v_add_f32 v104, v104, v105
    v_add_f32 v106, v106, v107
    v_add_f32 v104, v104, v106
    v_rcp_f32 v104, v104
    s_nop 0
    v_mul_f32 v128, v128, v104
    v_mul_f32 v129, v129, v104
    v_mul_f32 v130, v130, v104
    v_mul_f32 v131, v131, v104
    v_mul_f32 v132, v132, v104
    v_mul_f32 v133, v133, v104
    v_mul_f32 v134, v134, v104
    v_mul_f32 v135, v135, v104
    v_cvt_pk_bf16_f32 v78, v128, v129
    v_cvt_pk_bf16_f32 v79, v130, v131
    v_cvt_pk_bf16_f32 v74, v132, v133
    v_cvt_pk_bf16_f32 v75, v134, v135
    v_and_b32 v72, v78, v54
    v_and_b32 v73, v79, v55
    v_and_b32 v76, v78, v56
    v_and_b32 v77, v79, v57
    v_cndmask_b32 v141, v149, v141, s[4:5]
    v_cndmask_b32 v142, v150, v142, s[6:7]
    v_cndmask_b32 v143, v151, v143, s[8:9]
    v_max3_f32 v120, v140, v141, v142
    v_max3_f32 v121, v143, v144, v145
    v_max3_f32 v120, v146, v147, v120
    v_max_f32 v120, v120, v121
    v_sub_f32 v140, v140, v120
    v_sub_f32 v141, v141, v120
    v_sub_f32 v142, v142, v120
    v_sub_f32 v143, v143, v120
    v_sub_f32 v144, v144, v120
    v_sub_f32 v145, v145, v120
    v_sub_f32 v146, v146, v120
    v_sub_f32 v147, v147, v120
    v_exp_f32 v140, v140
    v_exp_f32 v141, v141
    v_exp_f32 v142, v142
    v_exp_f32 v143, v143
    v_exp_f32 v144, v144
    v_exp_f32 v145, v145
    v_exp_f32 v146, v146
    v_exp_f32 v147, v147
    v_add_f32 v120, v140, v141
    v_add_f32 v121, v142, v143
    v_add_f32 v122, v144, v145
    v_add_f32 v123, v146, v147
    v_add_f32 v120, v120, v121
    v_add_f32 v122, v122, v123
    v_add_f32 v120, v120, v122
    v_rcp_f32 v120, v120
    s_nop 0
    v_mul_f32 v140, v140, v120
    v_mul_f32 v141, v141, v120
    v_mul_f32 v142, v142, v120
    v_mul_f32 v143, v143, v120
    v_mul_f32 v144, v144, v120
    v_mul_f32 v145, v145, v120
    v_mul_f32 v146, v146, v120
    v_mul_f32 v147, v147, v120
    v_cvt_pk_bf16_f32 v94, v140, v141
    v_cvt_pk_bf16_f32 v95, v142, v143
    v_cvt_pk_bf16_f32 v90, v144, v145
    v_cvt_pk_bf16_f32 v91, v146, v147
    v_and_b32 v88, v94, v54
    v_and_b32 v89, v95, v55
    v_and_b32 v92, v94, v56
    v_and_b32 v93, v95, v57
    s_waitcnt lgkmcnt(0)
    v_mfma_f32_4x4x4_16b_bf16 v[160:163], v[192:193], v[72:73], 0
    v_mfma_f32_4x4x4_16b_bf16 v[164:167], v[194:195], v[72:73], 0
    v_mfma_f32_4x4x4_16b_bf16 v[168:171], v[196:197], v[72:73], 0
    v_mfma_f32_4x4x4_16b_bf16 v[172:175], v[198:199], v[72:73], 0
    v_mfma_f32_4x4x4_16b_bf16 v[176:179], v[216:217], v[88:89], 0
    v_mfma_f32_4x4x4_16b_bf16 v[180:183], v[218:219], v[88:89], 0
    v_mfma_f32_4x4x4_16b_bf16 v[184:187], v[220:221], v[88:89], 0
    v_mfma_f32_4x4x4_16b_bf16 v[188:191], v[222:223], v[88:89], 0
    v_mfma_f32_4x4x4_16b_bf16 v[160:163], v[200:201], v[74:75], v[160:163]
    v_mfma_f32_4x4x4_16b_bf16 v[164:167], v[202:203], v[74:75], v[164:167]
    v_mfma_f32_4x4x4_16b_bf16 v[168:171], v[204:205], v[74:75], v[168:171]
    v_mfma_f32_4x4x4_16b_bf16 v[172:175], v[206:207], v[74:75], v[172:175]
    v_mfma_f32_4x4x4_16b_bf16 v[176:179], v[224:225], v[90:91], v[176:179]
    v_mfma_f32_4x4x4_16b_bf16 v[180:183], v[226:227], v[90:91], v[180:183]
    v_mfma_f32_4x4x4_16b_bf16 v[184:187], v[228:229], v[90:91], v[184:187]
    v_mfma_f32_4x4x4_16b_bf16 v[188:191], v[230:231], v[90:91], v[188:191]
    v_mfma_f32_4x4x4_16b_bf16 v[160:163], v[208:209], v[76:77], v[160:163]
    v_mfma_f32_4x4x4_16b_bf16 v[164:167], v[210:211], v[76:77], v[164:167]
    v_mfma_f32_4x4x4_16b_bf16 v[168:171], v[212:213], v[76:77], v[168:171]
    v_mfma_f32_4x4x4_16b_bf16 v[172:175], v[214:215], v[76:77], v[172:175]
    v_mfma_f32_4x4x4_16b_bf16 v[176:179], v[232:233], v[92:93], v[176:179]
    v_mfma_f32_4x4x4_16b_bf16 v[180:183], v[234:235], v[92:93], v[180:183]
    v_mfma_f32_4x4x4_16b_bf16 v[184:187], v[236:237], v[92:93], v[184:187]
    v_mfma_f32_4x4x4_16b_bf16 v[188:191], v[238:239], v[92:93], v[188:191]
    v_and_b32 v40, 31, v1
    v_lshlrev_b32 v40, 4, v40
    v_lshrrev_b32 v41, 5, v1
    v_lshlrev_b32 v41, 10, v41
    v_add_u32 v40, v40, v41
    s_lshl_b32 s66, s49, 2
    s_lshl_b32 s67, s52, 1
    s_add_u32 s66, s66, s67
    s_lshl_b32 s66, s66, 10
    s_add_u32 s67, s65, s66
    v_cvt_pk_bf16_f32 v128, v160, v161
    v_cvt_pk_bf16_f32 v129, v162, v163
    v_cvt_pk_bf16_f32 v130, v168, v169
    v_cvt_pk_bf16_f32 v131, v170, v171
    v_cvt_pk_bf16_f32 v132, v164, v165
    v_cvt_pk_bf16_f32 v133, v166, v167
    v_cvt_pk_bf16_f32 v134, v172, v173
    v_cvt_pk_bf16_f32 v135, v174, v175
    v_min_u32 v128, -2, v128
    v_min_u32 v129, -2, v129
    v_min_u32 v130, -2, v130
    v_min_u32 v131, -2, v131
    v_min_u32 v132, -2, v132
    v_min_u32 v133, -2, v133
    v_min_u32 v134, -2, v134
    v_min_u32 v135, -2, v135
    s_add_u32 s64, s67, 0
    buffer_store_dwordx4 v[128:131], v40, s[32:35], s64 offen sc1
    buffer_store_dwordx4 v[132:135], v40, s[32:35], s64 offen offset:512 sc1
    v_cvt_pk_bf16_f32 v144, v176, v177
    v_cvt_pk_bf16_f32 v145, v178, v179
    v_cvt_pk_bf16_f32 v146, v184, v185
    v_cvt_pk_bf16_f32 v147, v186, v187
    v_cvt_pk_bf16_f32 v148, v180, v181
    v_cvt_pk_bf16_f32 v149, v182, v183
    v_cvt_pk_bf16_f32 v150, v188, v189
    v_cvt_pk_bf16_f32 v151, v190, v191
    v_min_u32 v144, -2, v144
    v_min_u32 v145, -2, v145
    v_min_u32 v146, -2, v146
    v_min_u32 v147, -2, v147
    v_min_u32 v148, -2, v148
    v_min_u32 v149, -2, v149
    v_min_u32 v150, -2, v150
    v_min_u32 v151, -2, v151
    s_add_u32 s64, s67, 147456
    buffer_store_dwordx4 v[144:147], v40, s[32:35], s64 offen sc1
    buffer_store_dwordx4 v[148:151], v40, s[32:35], s64 offen offset:512 sc1
    s_setprio 0
    s_waitcnt vmcnt(5)
    v_add_u32 v6, 20608, v2
    v_xor_b32 v7, 64, v6
    ds_read_b64_tr_b16 v[80:81], v6 offset:0
    ds_read_b64_tr_b16 v[82:83], v6 offset:512
    ds_read_b64_tr_b16 v[84:85], v7 offset:0
    ds_read_b64_tr_b16 v[86:87], v7 offset:512
    v_add_u32 v6, 139904, v2
    v_xor_b32 v7, 64, v6
    ds_read_b64_tr_b16 v[88:89], v6 offset:0
    ds_read_b64_tr_b16 v[90:91], v6 offset:512
    ds_read_b64_tr_b16 v[92:93], v7 offset:0
    ds_read_b64_tr_b16 v[94:95], v7 offset:512
    v_add_u32 v6, 36992, v2
    v_xor_b32 v7, 64, v6
    ds_read_b64_tr_b16 v[96:97], v6 offset:0
    ds_read_b64_tr_b16 v[98:99], v6 offset:512
    ds_read_b64_tr_b16 v[100:101], v7 offset:0
    ds_read_b64_tr_b16 v[102:103], v7 offset:512
    v_add_u32 v6, 53376, v2
    v_xor_b32 v7, 64, v6
    ds_read_b64_tr_b16 v[104:105], v6 offset:0
    ds_read_b64_tr_b16 v[106:107], v6 offset:512
    ds_read_b64_tr_b16 v[108:109], v7 offset:0
    ds_read_b64_tr_b16 v[110:111], v7 offset:512
    v_add_u32 v6, 69760, v2
    v_xor_b32 v7, 64, v6
    ds_read_b64_tr_b16 v[112:113], v6 offset:0
    ds_read_b64_tr_b16 v[114:115], v6 offset:512
    ds_read_b64_tr_b16 v[116:117], v7 offset:0
    ds_read_b64_tr_b16 v[118:119], v7 offset:512
    v_add_u32 v6, 86144, v2
    v_xor_b32 v7, 64, v6
    ds_read_b64_tr_b16 v[120:121], v6 offset:0
    ds_read_b64_tr_b16 v[122:123], v6 offset:512
    ds_read_b64_tr_b16 v[124:125], v7 offset:0
    ds_read_b64_tr_b16 v[126:127], v7 offset:512
    v_add_u32 v6, 102528, v2
    v_add_u32 v6, s74, v6
    v_xor_b32 v7, 64, v6
    ds_read_b64_tr_b16 v[128:129], v6 offset:0
    ds_read_b64_tr_b16 v[130:131], v6 offset:512
    ds_read_b64_tr_b16 v[132:133], v7 offset:0
    ds_read_b64_tr_b16 v[134:135], v7 offset:512
    v_add_u32 v6, 104576, v2
    v_add_u32 v6, s74, v6
    v_xor_b32 v7, 64, v6
    ds_read_b64_tr_b16 v[136:137], v6 offset:0
    ds_read_b64_tr_b16 v[138:139], v6 offset:512
    ds_read_b64_tr_b16 v[140:141], v7 offset:0
    ds_read_b64_tr_b16 v[142:143], v7 offset:512
    v_and_b32 v4, 31, v1
    v_lshlrev_b32 v4, 11, v4
    v_lshrrev_b32 v5, 5, v1
    v_lshlrev_b32 v5, 4, v5
    v_add_u32 v4, v4, v5
    s_lshl_b32 s73, s69, 16
    s_and_b32 s64, s50, 1
    s_lshl_b32 s64, s64, 10
    s_add_u32 s73, s73, s64
    s_lshl_b32 s64, s70, 7
    s_add_u32 s73, s73, s64
    s_lshr_b32 s64, s50, 1
    s_lshl_b32 s64, s64, 5
    s_add_u32 s73, s73, s64
    buffer_load_dwordx4 v[8:11], v4, s[16:19], s73 offen
    v_lshlrev_b32 v0, 11, v1
    v_add_u32 v0, 149488, v0
    s_waitcnt vmcnt(5)
    v_cmp_eq_u32 vcc, s55, v13
    s_and_b32 s64, vcc_lo, 0x3030
    s_cmp_lg_u32 s64, 0x3030
    s_cbranch_scc1 RattA_psp_11
RattA_pok_10:
    s_mov_b64 exec, 0xf
    buffer_load_dword v13, v0, s[32:35], s76 offen sc1
    s_mov_b64 exec, -1
    s_waitcnt vmcnt(0)
    v_cmp_ne_u32 vcc, -1, v13
    s_and_b32 s64, vcc_lo, 0xf
    s_cmp_lg_u32 s64, 0xf
    s_cbranch_scc1 RattA_gsp_13
RattA_gok_12:
    s_add_u32 s64, s76, 0
    buffer_load_dwordx4 v[160:163], v3, s[32:35], s64 offen sc1
    s_add_u32 s64, s76, 147456
    buffer_load_dwordx4 v[164:167], v3, s[32:35], s64 offen sc1
    s_add_u32 s64, s76, 1024
    buffer_load_dwordx4 v[168:171], v3, s[32:35], s64 offen sc1
    s_add_u32 s64, s76, 148480
    buffer_load_dwordx4 v[172:175], v3, s[32:35], s64 offen sc1
    s_add_u32 s64, s76, 2048
    buffer_load_dwordx4 v[176:179], v3, s[32:35], s64 offen sc1
    s_add_u32 s64, s76, 149504
    buffer_load_dwordx4 v[180:183], v3, s[32:35], s64 offen sc1
    s_add_u32 s64, s76, 3072
    buffer_load_dwordx4 v[184:187], v3, s[32:35], s64 offen sc1
    s_add_u32 s64, s76, 150528
    buffer_load_dwordx4 v[188:191], v3, s[32:35], s64 offen sc1
    s_add_u32 s64, s76, 4096
    buffer_load_dwordx4 v[192:195], v3, s[32:35], s64 offen sc1
    s_add_u32 s64, s76, 151552
    buffer_load_dwordx4 v[196:199], v3, s[32:35], s64 offen sc1
    s_add_u32 s64, s76, 5120
    buffer_load_dwordx4 v[200:203], v3, s[32:35], s64 offen sc1
    s_add_u32 s64, s76, 152576
    buffer_load_dwordx4 v[204:207], v3, s[32:35], s64 offen sc1
    s_add_u32 s64, s76, 6144
    buffer_load_dwordx4 v[208:211], v3, s[32:35], s64 offen sc1
    s_add_u32 s64, s76, 153600
    buffer_load_dwordx4 v[212:215], v3, s[32:35], s64 offen sc1
    s_add_u32 s64, s76, 7168
    buffer_load_dwordx4 v[216:219], v3, s[32:35], s64 offen sc1
    s_add_u32 s64, s76, 154624
    buffer_load_dwordx4 v[220:223], v3, s[32:35], s64 offen sc1
    s_waitcnt vmcnt(14) lgkmcnt(0)
    v_max3_u32 v5, v160, v161, v162
    v_max3_u32 v15, v164, v165, v166
    v_max3_u32 v5, v5, v163, v167
    v_max_u32 v5, v5, v15
    v_cmp_eq_u32 vcc, -1, v5
    s_cbranch_vccnz RattA_asp_15
RattA_aok_14:
    v_mov_b32 v5, 158336
    v_mov_b32 v15, 1
    s_mov_b64 exec, 1
    ds_add_u32 v5, v15
    s_mov_b64 exec, -1
    v_mfma_f32_32x32x16_bf16 v[16:31], v[80:83], v[160:163], 0
    v_mfma_f32_32x32x16_bf16 v[32:47], v[84:87], v[160:163], 0
    v_mfma_f32_32x32x16_bf16 v[48:63], v[80:83], v[164:167], 0
    v_mfma_f32_32x32x16_bf16 v[64:79], v[84:87], v[164:167], 0
    s_waitcnt vmcnt(12)
    v_max3_u32 v5, v168, v169, v170
    v_max3_u32 v15, v172, v173, v174
    v_max3_u32 v5, v5, v171, v175
    v_max_u32 v5, v5, v15
    v_cmp_eq_u32 vcc, -1, v5
    s_cbranch_vccnz RattA_asp_17
RattA_aok_16:
    v_mfma_f32_32x32x16_bf16 v[16:31], v[88:91], v[168:171], v[16:31]
    v_mfma_f32_32x32x16_bf16 v[32:47], v[92:95], v[168:171], v[32:47]
    v_mfma_f32_32x32x16_bf16 v[48:63], v[88:91], v[172:175], v[48:63]
    v_mfma_f32_32x32x16_bf16 v[64:79], v[92:95], v[172:175], v[64:79]
    s_waitcnt vmcnt(10)
    v_max3_u32 v5, v176, v177, v178
    v_max3_u32 v15, v180, v181, v182
    v_max3_u32 v5, v5, v179, v183
    v_max_u32 v5, v5, v15
    v_cmp_eq_u32 vcc, -1, v5
    s_cbranch_vccnz RattA_asp_19
RattA_aok_18:
    v_mfma_f32_32x32x16_bf16 v[16:31], v[96:99], v[176:179], v[16:31]
    v_mfma_f32_32x32x16_bf16 v[32:47], v[100:103], v[176:179], v[32:47]
    v_mfma_f32_32x32x16_bf16 v[48:63], v[96:99], v[180:183], v[48:63]
    v_mfma_f32_32x32x16_bf16 v[64:79], v[100:103], v[180:183], v[64:79]
    s_waitcnt vmcnt(8)
    v_max3_u32 v5, v184, v185, v186
    v_max3_u32 v15, v188, v189, v190
    v_max3_u32 v5, v5, v187, v191
    v_max_u32 v5, v5, v15
    v_cmp_eq_u32 vcc, -1, v5
    s_cbranch_vccnz RattA_asp_21
RattA_aok_20:
    v_mfma_f32_32x32x16_bf16 v[16:31], v[104:107], v[184:187], v[16:31]
    v_mfma_f32_32x32x16_bf16 v[32:47], v[108:111], v[184:187], v[32:47]
    v_mfma_f32_32x32x16_bf16 v[48:63], v[104:107], v[188:191], v[48:63]
    v_mfma_f32_32x32x16_bf16 v[64:79], v[108:111], v[188:191], v[64:79]
    s_waitcnt vmcnt(6)
    v_max3_u32 v5, v192, v193, v194
    v_max3_u32 v15, v196, v197, v198
    v_max3_u32 v5, v5, v195, v199
    v_max_u32 v5, v5, v15
    v_cmp_eq_u32 vcc, -1, v5
    s_cbranch_vccnz RattA_asp_23
RattA_aok_22:
    v_mfma_f32_32x32x16_bf16 v[16:31], v[112:115], v[192:195], v[16:31]
    v_mfma_f32_32x32x16_bf16 v[32:47], v[116:119], v[192:195], v[32:47]
    v_mfma_f32_32x32x16_bf16 v[48:63], v[112:115], v[196:199], v[48:63]
    v_mfma_f32_32x32x16_bf16 v[64:79], v[116:119], v[196:199], v[64:79]
    s_waitcnt vmcnt(4)
    v_max3_u32 v5, v200, v201, v202
    v_max3_u32 v15, v204, v205, v206
    v_max3_u32 v5, v5, v203, v207
    v_max_u32 v5, v5, v15
    v_cmp_eq_u32 vcc, -1, v5
    s_cbranch_vccnz RattA_asp_25
RattA_aok_24:
    v_mfma_f32_32x32x16_bf16 v[16:31], v[120:123], v[200:203], v[16:31]
    v_mfma_f32_32x32x16_bf16 v[32:47], v[124:127], v[200:203], v[32:47]
    v_mfma_f32_32x32x16_bf16 v[48:63], v[120:123], v[204:207], v[48:63]
    v_mfma_f32_32x32x16_bf16 v[64:79], v[124:127], v[204:207], v[64:79]
    s_waitcnt vmcnt(2)
    v_max3_u32 v5, v208, v209, v210
    v_max3_u32 v15, v212, v213, v214
    v_max3_u32 v5, v5, v211, v215
    v_max_u32 v5, v5, v15
    v_cmp_eq_u32 vcc, -1, v5
    s_cbranch_vccnz RattA_asp_27
RattA_aok_26:
    v_mfma_f32_32x32x16_bf16 v[16:31], v[128:131], v[208:211], v[16:31]
    v_mfma_f32_32x32x16_bf16 v[32:47], v[132:135], v[208:211], v[32:47]
    v_mfma_f32_32x32x16_bf16 v[48:63], v[128:131], v[212:215], v[48:63]
    v_mfma_f32_32x32x16_bf16 v[64:79], v[132:135], v[212:215], v[64:79]
    s_waitcnt vmcnt(0)
    v_max3_u32 v5, v216, v217, v218
    v_max3_u32 v15, v220, v221, v222
    v_max3_u32 v5, v5, v219, v223
    v_max_u32 v5, v5, v15
    v_cmp_eq_u32 vcc, -1, v5
    s_cbranch_vccnz RattA_asp_29
RattA_aok_28:
    v_mfma_f32_32x32x16_bf16 v[16:31], v[136:139], v[216:219], v[16:31]
    v_mfma_f32_32x32x16_bf16 v[32:47], v[140:143], v[216:219], v[32:47]
    v_mfma_f32_32x32x16_bf16 v[48:63], v[136:139], v[220:223], v[48:63]
    v_mfma_f32_32x32x16_bf16 v[64:79], v[140:143], v[220:223], v[64:79]
    v_lshlrev_b32 v12, 4, v1
    s_lshl_b32 s64, s50, 11
    v_add_u32 v12, s64, v12
    v_add_u32 v13, 0x10000, v12
    v_add_u32 v14, 0x20000, v12
    v_mov_b32 v5, 158336
    s_mov_b32 s65, 0
RattA_cs_30:
    ds_read_b32 v15, v5
    s_waitcnt lgkmcnt(0)
    v_readfirstlane_b32 s64, v15
    s_add_u32 s65, s65, 1
    s_cmp_gt_u32 s65, 4000000
    s_cbranch_scc1 RattA_co_31
    s_cmp_lg_u32 s64, 4
    s_cbranch_scc1 RattA_cs_30
RattA_co_31:
    ds_write_b128 v12, v[16:19] offset:20608
    ds_write_b128 v12, v[20:23] offset:21632
    ds_write_b128 v14, v[24:27] offset:8832
    ds_write_b128 v14, v[28:31] offset:9856
    ds_write_b128 v12, v[32:35] offset:36992
    ds_write_b128 v12, v[36:39] offset:38016
    ds_write_b128 v12, v[40:43] offset:53376
    ds_write_b128 v12, v[44:47] offset:54400
    ds_write_b128 v13, v[48:51] offset:4224
    ds_write_b128 v13, v[52:55] offset:5248
    ds_write_b128 v13, v[56:59] offset:20608
    ds_write_b128 v13, v[60:63] offset:21632
    ds_write_b128 v13, v[64:67] offset:36992
    ds_write_b128 v13, v[68:71] offset:38016
    ds_write_b128 v12, v[72:75] offset:0
    ds_write_b128 v12, v[76:79] offset:1024
    s_mov_b32 s64, 20608
    s_cmp_eq_u32 s53, 1
    s_cselect_b32 s64, 69760, s64
    s_cmp_eq_u32 s53, 2
    s_cselect_b32 s64, 139904, s64
    s_cmp_eq_u32 s53, 3
    s_cselect_b32 s64, 86144, s64
    v_and_b32 v12, 31, v1
    v_lshlrev_b32 v12, 4, v12
    v_lshrrev_b32 v13, 5, v1
    v_lshlrev_b32 v13, 10, v13
    v_add_u32 v12, v12, v13
    v_add_u32 v12, s64, v12
    s_waitcnt lgkmcnt(0)
    s_barrier
    ds_read_b128 v[80:83], v12 offset:0
    ds_read_b128 v[84:87], v12 offset:512
    ds_read_b128 v[88:91], v12 offset:2048
    ds_read_b128 v[92:95], v12 offset:2560
    ds_read_b128 v[96:99], v12 offset:4096
    ds_read_b128 v[100:103], v12 offset:4608
    ds_read_b128 v[104:107], v12 offset:6144
    ds_read_b128 v[108:111], v12 offset:6656
    ds_read_b128 v[112:115], v12 offset:8192
    ds_read_b128 v[116:119], v12 offset:8704
    ds_read_b128 v[120:123], v12 offset:10240
    ds_read_b128 v[124:127], v12 offset:10752
    ds_read_b128 v[128:131], v12 offset:12288
    ds_read_b128 v[132:135], v12 offset:12800
    ds_read_b128 v[136:139], v12 offset:14336
    ds_read_b128 v[140:143], v12 offset:14848
    s_or_b32 s64, s54, s50
    s_cmp_lg_u32 s64, 0
    s_cbranch_scc1 RattA_noep_32
    s_lshl_b32 s64, s48, 7
    s_add_u32 s64, s64, 0x998000
    v_mov_b32 v28, s55
    s_mov_b64 exec, 1
    buffer_store_dword v28, off, s[32:35], s64 sc1
    s_mov_b64 exec, -1
RattA_noep_32:
    v_lshlrev_b32 v16, 16, v8
    v_and_b32 v17, 0xffff0000, v8
    v_lshlrev_b32 v18, 16, v9
    v_and_b32 v19, 0xffff0000, v9
    v_lshlrev_b32 v20, 16, v10
    v_and_b32 v21, 0xffff0000, v10
    v_lshlrev_b32 v22, 16, v11
    v_and_b32 v23, 0xffff0000, v11
    s_waitcnt lgkmcnt(14)
    v_pk_add_f32 v[16:17], v[16:17], v[80:81]
    v_pk_add_f32 v[18:19], v[18:19], v[82:83]
    v_pk_add_f32 v[20:21], v[20:21], v[84:85]
    v_pk_add_f32 v[22:23], v[22:23], v[86:87]
    s_waitcnt lgkmcnt(12)
    v_pk_add_f32 v[16:17], v[16:17], v[88:89]
    v_pk_add_f32 v[18:19], v[18:19], v[90:91]
    v_pk_add_f32 v[20:21], v[20:21], v[92:93]
    v_pk_add_f32 v[22:23], v[22:23], v[94:95]
    s_waitcnt lgkmcnt(10)
    v_pk_add_f32 v[16:17], v[16:17], v[96:97]
    v_pk_add_f32 v[18:19], v[18:19], v[98:99]
    v_pk_add_f32 v[20:21], v[20:21], v[100:101]
    v_pk_add_f32 v[22:23], v[22:23], v[102:103]
    s_waitcnt lgkmcnt(8)
    v_pk_add_f32 v[16:17], v[16:17], v[104:105]
    v_pk_add_f32 v[18:19], v[18:19], v[106:107]
    v_pk_add_f32 v[20:21], v[20:21], v[108:109]
    v_pk_add_f32 v[22:23], v[22:23], v[110:111]
    s_waitcnt lgkmcnt(6)
    v_pk_add_f32 v[16:17], v[16:17], v[112:113]
    v_pk_add_f32 v[18:19], v[18:19], v[114:115]
    v_pk_add_f32 v[20:21], v[20:21], v[116:117]
    v_pk_add_f32 v[22:23], v[22:23], v[118:119]
    s_waitcnt lgkmcnt(4)
    v_pk_add_f32 v[16:17], v[16:17], v[120:121]
    v_pk_add_f32 v[18:19], v[18:19], v[122:123]
    v_pk_add_f32 v[20:21], v[20:21], v[124:125]
    v_pk_add_f32 v[22:23], v[22:23], v[126:127]
    s_waitcnt lgkmcnt(2)
    v_pk_add_f32 v[16:17], v[16:17], v[128:129]
    v_pk_add_f32 v[18:19], v[18:19], v[130:131]
    v_pk_add_f32 v[20:21], v[20:21], v[132:133]
    v_pk_add_f32 v[22:23], v[22:23], v[134:135]
    s_waitcnt lgkmcnt(0)
    v_pk_add_f32 v[16:17], v[16:17], v[136:137]
    v_pk_add_f32 v[18:19], v[18:19], v[138:139]
    v_pk_add_f32 v[20:21], v[20:21], v[140:141]
    v_pk_add_f32 v[22:23], v[22:23], v[142:143]
    v_cvt_pk_bf16_f32 v24, v16, v17
    v_cvt_pk_bf16_f32 v25, v18, v19
    v_cvt_pk_bf16_f32 v26, v20, v21
    v_cvt_pk_bf16_f32 v27, v22, v23
    buffer_store_dwordx4 v[24:27], v4, s[44:47], s73 offen
    s_endpgm
RattA_retry:
    s_mov_b32 s67, 0
RattA_rl_33:
    buffer_load_dwordx4 v[24:27], v15, s[32:35], s12 offen offset:0 sc1
    buffer_load_dwordx4 v[28:31], v15, s[32:35], s12 offen offset:512 sc1
    buffer_load_dwordx4 v[32:35], v15, s[32:35], s12 offen offset:1024 sc1
    buffer_load_dwordx4 v[36:39], v15, s[32:35], s12 offen offset:1536 sc1
    buffer_load_dwordx4 v[56:59], v60, s[32:35], s14 offen sc1
    s_waitcnt vmcnt(0)
    s_add_u32 s67, s67, 1
    s_cmp_gt_u32 s67, 400000
    s_cbranch_scc1 RattA_recok
    v_cmp_ne_u32 s[10:11], s56, v27
    v_cmp_ne_u32 vcc, s56, v31
    s_or_b64 s[10:11], s[10:11], vcc
    v_cmp_ne_u32 vcc, s56, v35
    s_or_b64 s[10:11], s[10:11], vcc
    v_cmp_ne_u32 vcc, s56, v39
    s_or_b64 s[10:11], s[10:11], vcc
    v_cmp_ne_u32 vcc, s55, v59
    s_or_b64 s[10:11], s[10:11], vcc
    s_cmp_lg_u64 s[10:11], 0
    s_cbranch_scc1 RattA_rl_33
RattA_rok_34:
    s_branch RattA_recok
RattA_psp_11:
RattA_pl_35:
    s_sleep 4
    s_mov_b64 exec, 0xffff
    buffer_load_dword v13, v12, s[32:35], s77 offen sc1
    s_mov_b64 exec, -1
    s_waitcnt vmcnt(0)
    v_cmp_eq_u32 vcc, s55, v13
    s_add_u32 s3, s3, 1
    s_cmp_gt_u32 s3, 400000
    s_cbranch_scc1 RattA_pok_10
    s_and_b32 s64, vcc_lo, 0x3030
    s_cmp_lg_u32 s64, 0x3030
    s_cbranch_scc1 RattA_pl_35
    s_branch RattA_pok_10
RattA_gsp_13:
RattA_gl_36:
    s_sleep 4
    s_mov_b64 exec, 0xf
    buffer_load_dword v13, v0, s[32:35], s76 offen sc1
    s_mov_b64 exec, -1
    s_waitcnt vmcnt(0)
    v_cmp_ne_u32 vcc, -1, v13
    s_add_u32 s3, s3, 1
    s_cmp_gt_u32 s3, 400000
    s_cbranch_scc1 RattA_gok_12
    s_and_b32 s64, vcc_lo, 0xf
    s_cmp_lg_u32 s64, 0xf
    s_cbranch_scc1 RattA_gl_36
    s_branch RattA_gok_12
RattA_asp_15:
RattA_al_37:
    s_add_u32 s64, s76, 0
    buffer_load_dwordx4 v[160:163], v3, s[32:35], s64 offen sc1
    s_add_u32 s64, s76, 147456
    buffer_load_dwordx4 v[164:167], v3, s[32:35], s64 offen sc1
    s_add_u32 s64, s76, 1024
    buffer_load_dwordx4 v[168:171], v3, s[32:35], s64 offen sc1
    s_add_u32 s64, s76, 148480
    buffer_load_dwordx4 v[172:175], v3, s[32:35], s64 offen sc1
    s_add_u32 s64, s76, 2048
    buffer_load_dwordx4 v[176:179], v3, s[32:35], s64 offen sc1
    s_add_u32 s64, s76, 149504
    buffer_load_dwordx4 v[180:183], v3, s[32:35], s64 offen sc1
    s_add_u32 s64, s76, 3072
    buffer_load_dwordx4 v[184:187], v3, s[32:35], s64 offen sc1
    s_add_u32 s64, s76, 150528
    buffer_load_dwordx4 v[188:191], v3, s[32:35], s64 offen sc1
    s_add_u32 s64, s76, 4096
    buffer_load_dwordx4 v[192:195], v3, s[32:35], s64 offen sc1
    s_add_u32 s64, s76, 151552
    buffer_load_dwordx4 v[196:199], v3, s[32:35], s64 offen sc1
    s_add_u32 s64, s76, 5120
    buffer_load_dwordx4 v[200:203], v3, s[32:35], s64 offen sc1
    s_add_u32 s64, s76, 152576
    buffer_load_dwordx4 v[204:207], v3, s[32:35], s64 offen sc1
    s_add_u32 s64, s76, 6144
    buffer_load_dwordx4 v[208:211], v3, s[32:35], s64 offen sc1
    s_add_u32 s64, s76, 153600
    buffer_load_dwordx4 v[212:215], v3, s[32:35], s64 offen sc1
    s_add_u32 s64, s76, 7168
    buffer_load_dwordx4 v[216:219], v3, s[32:35], s64 offen sc1
    s_add_u32 s64, s76, 154624
    buffer_load_dwordx4 v[220:223], v3, s[32:35], s64 offen sc1
    s_waitcnt vmcnt(0)
    v_max3_u32 v5, v160, v161, v162
    v_max3_u32 v15, v164, v165, v166
    v_max3_u32 v5, v5, v163, v167
    v_max_u32 v5, v5, v15
    v_cmp_eq_u32 vcc, -1, v5
    s_add_u32 s3, s3, 1
    s_cmp_gt_u32 s3, 400000
    s_cbranch_scc1 RattA_aok_14
    s_cbranch_vccnz RattA_al_37
    s_branch RattA_aok_14
RattA_asp_17:
RattA_al_38:
    s_add_u32 s64, s76, 1024
    buffer_load_dwordx4 v[168:171], v3, s[32:35], s64 offen sc1
    s_add_u32 s64, s76, 148480
    buffer_load_dwordx4 v[172:175], v3, s[32:35], s64 offen sc1
    s_add_u32 s64, s76, 2048
    buffer_load_dwordx4 v[176:179], v3, s[32:35], s64 offen sc1
    s_add_u32 s64, s76, 149504
    buffer_load_dwordx4 v[180:183], v3, s[32:35], s64 offen sc1
    s_add_u32 s64, s76, 3072
    buffer_load_dwordx4 v[184:187], v3, s[32:35], s64 offen sc1
    s_add_u32 s64, s76, 150528
    buffer_load_dwordx4 v[188:191], v3, s[32:35], s64 offen sc1
    s_add_u32 s64, s76, 4096
    buffer_load_dwordx4 v[192:195], v3, s[32:35], s64 offen sc1
    s_add_u32 s64, s76, 151552
    buffer_load_dwordx4 v[196:199], v3, s[32:35], s64 offen sc1
    s_add_u32 s64, s76, 5120
    buffer_load_dwordx4 v[200:203], v3, s[32:35], s64 offen sc1
    s_add_u32 s64, s76, 152576
    buffer_load_dwordx4 v[204:207], v3, s[32:35], s64 offen sc1
    s_add_u32 s64, s76, 6144
    buffer_load_dwordx4 v[208:211], v3, s[32:35], s64 offen sc1
    s_add_u32 s64, s76, 153600
    buffer_load_dwordx4 v[212:215], v3, s[32:35], s64 offen sc1
    s_add_u32 s64, s76, 7168
    buffer_load_dwordx4 v[216:219], v3, s[32:35], s64 offen sc1
    s_add_u32 s64, s76, 154624
    buffer_load_dwordx4 v[220:223], v3, s[32:35], s64 offen sc1
    s_waitcnt vmcnt(0)
    v_max3_u32 v5, v168, v169, v170
    v_max3_u32 v15, v172, v173, v174
    v_max3_u32 v5, v5, v171, v175
    v_max_u32 v5, v5, v15
    v_cmp_eq_u32 vcc, -1, v5
    s_add_u32 s3, s3, 1
    s_cmp_gt_u32 s3, 400000
    s_cbranch_scc1 RattA_aok_16
    s_cbranch_vccnz RattA_al_38
    s_branch RattA_aok_16
RattA_asp_19:
RattA_al_39:
    s_add_u32 s64, s76, 2048
    buffer_load_dwordx4 v[176:179], v3, s[32:35], s64 offen sc1
    s_add_u32 s64, s76, 149504
    buffer_load_dwordx4 v[180:183], v3, s[32:35], s64 offen sc1
    s_add_u32 s64, s76, 3072
    buffer_load_dwordx4 v[184:187], v3, s[32:35], s64 offen sc1
    s_add_u32 s64, s76, 150528
    buffer_load_dwordx4 v[188:191], v3, s[32:35], s64 offen sc1
    s_add_u32 s64, s76, 4096
    buffer_load_dwordx4 v[192:195], v3, s[32:35], s64 offen sc1
    s_add_u32 s64, s76, 151552
    buffer_load_dwordx4 v[196:199], v3, s[32:35], s64 offen sc1
    s_add_u32 s64, s76, 5120
    buffer_load_dwordx4 v[200:203], v3, s[32:35], s64 offen sc1
    s_add_u32 s64, s76, 152576
    buffer_load_dwordx4 v[204:207], v3, s[32:35], s64 offen sc1
    s_add_u32 s64, s76, 6144
    buffer_load_dwordx4 v[208:211], v3, s[32:35], s64 offen sc1
    s_add_u32 s64, s76, 153600
    buffer_load_dwordx4 v[212:215], v3, s[32:35], s64 offen sc1
    s_add_u32 s64, s76, 7168
    buffer_load_dwordx4 v[216:219], v3, s[32:35], s64 offen sc1
    s_add_u32 s64, s76, 154624
    buffer_load_dwordx4 v[220:223], v3, s[32:35], s64 offen sc1
    s_waitcnt vmcnt(0)
    v_max3_u32 v5, v176, v177, v178
    v_max3_u32 v15, v180, v181, v182
    v_max3_u32 v5, v5, v179, v183
    v_max_u32 v5, v5, v15
    v_cmp_eq_u32 vcc, -1, v5
    s_add_u32 s3, s3, 1
    s_cmp_gt_u32 s3, 400000
    s_cbranch_scc1 RattA_aok_18
    s_cbranch_vccnz RattA_al_39
    s_branch RattA_aok_18
RattA_asp_21:
RattA_al_40:
    s_add_u32 s64, s76, 3072
    buffer_load_dwordx4 v[184:187], v3, s[32:35], s64 offen sc1
    s_add_u32 s64, s76, 150528
    buffer_load_dwordx4 v[188:191], v3, s[32:35], s64 offen sc1
    s_add_u32 s64, s76, 4096
    buffer_load_dwordx4 v[192:195], v3, s[32:35], s64 offen sc1
    s_add_u32 s64, s76, 151552
    buffer_load_dwordx4 v[196:199], v3, s[32:35], s64 offen sc1
    s_add_u32 s64, s76, 5120
    buffer_load_dwordx4 v[200:203], v3, s[32:35], s64 offen sc1
    s_add_u32 s64, s76, 152576
    buffer_load_dwordx4 v[204:207], v3, s[32:35], s64 offen sc1
    s_add_u32 s64, s76, 6144
    buffer_load_dwordx4 v[208:211], v3, s[32:35], s64 offen sc1
    s_add_u32 s64, s76, 153600
    buffer_load_dwordx4 v[212:215], v3, s[32:35], s64 offen sc1
    s_add_u32 s64, s76, 7168
    buffer_load_dwordx4 v[216:219], v3, s[32:35], s64 offen sc1
    s_add_u32 s64, s76, 154624
    buffer_load_dwordx4 v[220:223], v3, s[32:35], s64 offen sc1
    s_waitcnt vmcnt(0)
    v_max3_u32 v5, v184, v185, v186
    v_max3_u32 v15, v188, v189, v190
    v_max3_u32 v5, v5, v187, v191
    v_max_u32 v5, v5, v15
    v_cmp_eq_u32 vcc, -1, v5
    s_add_u32 s3, s3, 1
    s_cmp_gt_u32 s3, 400000
    s_cbranch_scc1 RattA_aok_20
    s_cbranch_vccnz RattA_al_40
    s_branch RattA_aok_20
RattA_asp_23:
RattA_al_41:
    s_add_u32 s64, s76, 4096
    buffer_load_dwordx4 v[192:195], v3, s[32:35], s64 offen sc1
    s_add_u32 s64, s76, 151552
    buffer_load_dwordx4 v[196:199], v3, s[32:35], s64 offen sc1
    s_add_u32 s64, s76, 5120
    buffer_load_dwordx4 v[200:203], v3, s[32:35], s64 offen sc1
    s_add_u32 s64, s76, 152576
    buffer_load_dwordx4 v[204:207], v3, s[32:35], s64 offen sc1
    s_add_u32 s64, s76, 6144
    buffer_load_dwordx4 v[208:211], v3, s[32:35], s64 offen sc1
    s_add_u32 s64, s76, 153600
    buffer_load_dwordx4 v[212:215], v3, s[32:35], s64 offen sc1
    s_add_u32 s64, s76, 7168
    buffer_load_dwordx4 v[216:219], v3, s[32:35], s64 offen sc1
    s_add_u32 s64, s76, 154624
    buffer_load_dwordx4 v[220:223], v3, s[32:35], s64 offen sc1
    s_waitcnt vmcnt(0)
    v_max3_u32 v5, v192, v193, v194
    v_max3_u32 v15, v196, v197, v198
    v_max3_u32 v5, v5, v195, v199
    v_max_u32 v5, v5, v15
    v_cmp_eq_u32 vcc, -1, v5
    s_add_u32 s3, s3, 1
    s_cmp_gt_u32 s3, 400000
    s_cbranch_scc1 RattA_aok_22
    s_cbranch_vccnz RattA_al_41
    s_branch RattA_aok_22
RattA_asp_25:
RattA_al_42:
    s_add_u32 s64, s76, 5120
    buffer_load_dwordx4 v[200:203], v3, s[32:35], s64 offen sc1
    s_add_u32 s64, s76, 152576
    buffer_load_dwordx4 v[204:207], v3, s[32:35], s64 offen sc1
    s_add_u32 s64, s76, 6144
    buffer_load_dwordx4 v[208:211], v3, s[32:35], s64 offen sc1
    s_add_u32 s64, s76, 153600
    buffer_load_dwordx4 v[212:215], v3, s[32:35], s64 offen sc1
    s_add_u32 s64, s76, 7168
    buffer_load_dwordx4 v[216:219], v3, s[32:35], s64 offen sc1
    s_add_u32 s64, s76, 154624
    buffer_load_dwordx4 v[220:223], v3, s[32:35], s64 offen sc1
    s_waitcnt vmcnt(0)
    v_max3_u32 v5, v200, v201, v202
    v_max3_u32 v15, v204, v205, v206
    v_max3_u32 v5, v5, v203, v207
    v_max_u32 v5, v5, v15
    v_cmp_eq_u32 vcc, -1, v5
    s_add_u32 s3, s3, 1
    s_cmp_gt_u32 s3, 400000
    s_cbranch_scc1 RattA_aok_24
    s_cbranch_vccnz RattA_al_42
    s_branch RattA_aok_24
RattA_asp_27:
RattA_al_43:
    s_add_u32 s64, s76, 6144
    buffer_load_dwordx4 v[208:211], v3, s[32:35], s64 offen sc1
    s_add_u32 s64, s76, 153600
    buffer_load_dwordx4 v[212:215], v3, s[32:35], s64 offen sc1
    s_add_u32 s64, s76, 7168
    buffer_load_dwordx4 v[216:219], v3, s[32:35], s64 offen sc1
    s_add_u32 s64, s76, 154624
    buffer_load_dwordx4 v[220:223], v3, s[32:35], s64 offen sc1
    s_waitcnt vmcnt(0)
    v_max3_u32 v5, v208, v209, v210
    v_max3_u32 v15, v212, v213, v214
    v_max3_u32 v5, v5, v211, v215
    v_max_u32 v5, v5, v15
    v_cmp_eq_u32 vcc, -1, v5
    s_add_u32 s3, s3, 1
    s_cmp_gt_u32 s3, 400000
    s_cbranch_scc1 RattA_aok_26
    s_cbranch_vccnz RattA_al_43
    s_branch RattA_aok_26
RattA_asp_29:
RattA_al_44:
    s_add_u32 s64, s76, 7168
    buffer_load_dwordx4 v[216:219], v3, s[32:35], s64 offen sc1
    s_add_u32 s64, s76, 154624
    buffer_load_dwordx4 v[220:223], v3, s[32:35], s64 offen sc1
    s_waitcnt vmcnt(0)
    v_max3_u32 v5, v216, v217, v218
    v_max3_u32 v15, v220, v221, v222
    v_max3_u32 v5, v5, v219, v223
    v_max_u32 v5, v5, v15
    v_cmp_eq_u32 vcc, -1, v5
    s_add_u32 s3, s3, 1
    s_cmp_gt_u32 s3, 400000
    s_cbranch_scc1 RattA_aok_28
    s_cbranch_vccnz RattA_al_44
    s_branch RattA_aok_28
RattB:
    s_mov_b32 s3, 0
    v_lshrrev_b32 v40, 3, v1
    v_and_b32 v41, 7, v1
    v_lshrrev_b32 v42, 4, v1
    v_and_b32 v43, 1, v42
    v_lshlrev_b32 v43, 2, v43
    v_xor_b32 v43, v43, v41
    v_lshlrev_b32 v44, 4, v43
    v_mul_u32_u24 v45, 3072, v40
    v_add_u32 v16, v45, v44
    v_mul_u32_u24 v45, 3584, v40
    v_add_u32 v17, v45, v44
    v_xor_b32 v44, 32, v44
    v_add_u32 v18, v45, v44
    s_mul_i32 s59, s53, 24576
    s_lshl_b32 s64, s49, 7
    s_add_u32 s59, s59, s64
    s_mul_i32 s60, s53, 28672
    s_add_u32 s60, s60, s64
    s_lshl_b32 s57, s53, 10
    s_and_b32 s64, s53, 1
    s_lshl_b32 s64, s64, 3
    v_add_u32 v43, s64, v40
    v_and_b32 v44, 7, v43
    v_lshlrev_b32 v44, 1, v44
    v_lshrrev_b32 v45, 3, v43
    v_add_u32 v44, v44, v45
    s_lshl_b32 s64, s48, 7
    s_sub_u32 s64, s64, 16
    s_max_i32 s64, s64, 0
    v_add_u32 v44, s64, v44
    v_lshlrev_b32 v44, 10, v44
    v_bfe_u32 v45, v43, 1, 3
    v_xor_b32 v45, v45, v41
    v_lshlrev_b32 v45, 4, v45
    v_add_u32 v23, v44, v45
    s_and_b32 s58, s53, 1
    s_lshl_b32 s58, s58, 10
    s_add_u32 s58, s58, 119424
    s_lshr_b32 s64, s48, 3
    s_xor_b32 s65, s64, 1
    s_mul_i32 s75, s64, 786432
    s_add_u32 s75, s75, s59
    s_mul_i32 s76, s65, 786432
    s_add_u32 s76, s76, s59
    s_mul_i32 s77, s64, 917504
    s_add_u32 s77, s77, s60
    s_mul_i32 s78, s65, 917504
    s_add_u32 s78, s78, s60
    s_lshl_b32 s62, s64, 9
    s_lshl_b32 s63, s65, 9
    s_waitcnt lgkmcnt(0)
    s_mov_b32 s16, s4
    s_mov_b32 s17, s5
    s_mov_b32 s18, 0x200000
    s_mov_b32 s19, 0x00020000
    s_mov_b32 s32, s12
    s_mov_b32 s33, s13
    s_mov_b32 s34, 0x1000000
    s_mov_b32 s35, 0x00020000
    s_mov_b32 s20, s6
    s_mov_b32 s21, s7
    s_mov_b32 s22, 0x180000
    s_mov_b32 s23, 0x00020000
    s_mov_b32 s24, s8
    s_mov_b32 s25, s9
    s_mov_b32 s26, 0x1c0000
    s_mov_b32 s27, 0x00020000
    s_mov_b32 s28, s10
    s_mov_b32 s29, s11
    s_mov_b32 s30, 0x1c0000
    s_mov_b32 s31, 0x00020000
    s_add_u32 m0, s57, 0
    s_nop 0
    buffer_load_dwordx4 v16, s[20:23], s75 offen lds
    s_add_u32 m0, s57, 4096
    s_add_u32 s64, s75, 1024
    buffer_load_dwordx4 v16, s[20:23], s64 offen lds
    s_add_u32 m0, s57, 8192
    s_add_u32 s64, s75, 2048
    buffer_load_dwordx4 v16, s[20:23], s64 offen lds
    s_add_u32 m0, s57, 12288
    s_nop 0
    buffer_load_dwordx4 v17, s[24:27], s77 offen lds
    s_add_u32 m0, s57, 16384
    s_nop 0
    buffer_load_dwordx4 v18, s[28:31], s77 offen lds
    s_add_u32 m0, s58, 0
    s_nop 0
    buffer_load_dwordx4 v23, s[16:19], s62 offen lds
    s_lshl_b32 s64, s48, 7
    s_add_u32 s64, s64, 0x998000
    s_lshl_b32 s65, s54, 7
    s_add_u32 s65, s65, 0x999000
    buffer_load_dword v62, off, s[32:35], s64 sc1
    buffer_load_dword v63, off, s[32:35], s65 sc1
    s_add_u32 m0, s57, 20608
    s_add_u32 s64, s75, 98304
    buffer_load_dwordx4 v16, s[20:23], s64 offen lds
    s_add_u32 m0, s57, 24704
    s_add_u32 s64, s75, 99328
    buffer_load_dwordx4 v16, s[20:23], s64 offen lds
    s_add_u32 m0, s57, 28800
    s_add_u32 s64, s75, 100352
    buffer_load_dwordx4 v16, s[20:23], s64 offen lds
    s_add_u32 m0, s57, 32896
    s_add_u32 s65, s77, 114688
    buffer_load_dwordx4 v17, s[24:27], s65 offen lds
    s_add_u32 m0, s57, 36992
    s_nop 0
    buffer_load_dwordx4 v18, s[28:31], s65 offen lds
    s_add_u32 m0, s57, 41216
    s_add_u32 s64, s75, 196608
    buffer_load_dwordx4 v16, s[20:23], s64 offen lds
    s_add_u32 m0, s57, 45312
    s_add_u32 s64, s75, 197632
    buffer_load_dwordx4 v16, s[20:23], s64 offen lds
    s_add_u32 m0, s57, 49408
    s_add_u32 s64, s75, 198656
    buffer_load_dwordx4 v16, s[20:23], s64 offen lds
    s_add_u32 m0, s57, 53504
    s_add_u32 s65, s77, 229376
    buffer_load_dwordx4 v17, s[24:27], s65 offen lds
    s_add_u32 m0, s57, 57600
    s_nop 0
    buffer_load_dwordx4 v18, s[28:31], s65 offen lds
    s_add_u32 m0, s58, 18432
    s_add_u32 s64, s62, 128
    buffer_load_dwordx4 v23, s[16:19], s64 offen lds
    s_add_u32 m0, s57, 61824
    s_add_u32 s64, s75, 294912
    buffer_load_dwordx4 v16, s[20:23], s64 offen lds
    s_add_u32 m0, s57, 65920
    s_add_u32 s64, s75, 295936
    buffer_load_dwordx4 v16, s[20:23], s64 offen lds
    s_add_u32 m0, s57, 70016
    s_add_u32 s64, s75, 296960
    buffer_load_dwordx4 v16, s[20:23], s64 offen lds
    s_add_u32 m0, s57, 74112
    s_add_u32 s65, s77, 344064
    buffer_load_dwordx4 v17, s[24:27], s65 offen lds
    s_add_u32 m0, s57, 78208
    s_nop 0
    buffer_load_dwordx4 v18, s[28:31], s65 offen lds
    s_add_u32 m0, s57, 82432
    s_add_u32 s64, s75, 393216
    buffer_load_dwordx4 v16, s[20:23], s64 offen lds
    s_add_u32 m0, s57, 86528
    s_add_u32 s64, s75, 394240
    buffer_load_dwordx4 v16, s[20:23], s64 offen lds
    s_add_u32 m0, s57, 90624
    s_add_u32 s64, s75, 395264
    buffer_load_dwordx4 v16, s[20:23], s64 offen lds
    s_add_u32 m0, s57, 94720
    s_add_u32 s65, s77, 458752
    buffer_load_dwordx4 v17, s[24:27], s65 offen lds
    s_add_u32 m0, s57, 98816
    s_nop 0
    buffer_load_dwordx4 v18, s[28:31], s65 offen lds
    s_add_u32 m0, s58, 36864
    s_add_u32 s64, s62, 256
    buffer_load_dwordx4 v23, s[16:19], s64 offen lds
    s_mov_b32 s36, s14
    s_mov_b32 s37, s15
    s_mov_b32 s38, 0x80000
    s_mov_b32 s39, 0x00020000
    s_mov_b32 s40, s44
    s_mov_b32 s41, s45
    s_mov_b32 s42, 0x1c0000
    s_mov_b32 s43, 0x00020000
    s_mov_b32 s44, s46
    s_mov_b32 s45, s47
    s_mov_b32 s46, 0x200000
    s_mov_b32 s47, 0x00020000
    v_lshrrev_b32 v46, 4, v1
    v_bfe_u32 v47, v1, 2, 2
    v_and_b32 v48, 3, v1
    v_lshrrev_b32 v49, 1, v46
    v_and_b32 v50, 1, v46
    v_lshlrev_b32 v51, 3, v49
    v_add_u32 v51, v51, v47
    v_lshrrev_b32 v52, 1, v47
    v_xor_b32 v53, s52, v52
    v_lshlrev_b32 v53, 6, v53
    v_lshlrev_b32 v54, 7, v51
    v_add_u32 v54, v54, v53
    v_lshlrev_b32 v55, 3, v48
    v_add_u32 v54, v54, v55
    v_mul_u32_u24 v55, 4128, v50
    v_add_u32 v2, v54, v55
    v_add_u32 v2, 12288, v2
    v_xor_b32 v4, 32, v2
    v_add_u32 v5, 61824, v4
    v_lshlrev_b32 v55, 3, v46
    v_add_u32 v55, v55, v47
    v_lshlrev_b32 v55, 7, v55
    s_lshr_b32 s64, s53, 1
    s_and_b32 s65, s53, 1
    s_lshl_b32 s65, s65, 5
    s_add_u32 s65, s65, 4096
    v_xor_b32 v56, s64, v52
    v_lshlrev_b32 v56, 6, v56
    v_add_u32 v55, v55, v56
    v_lshlrev_b32 v56, 3, v48
    v_add_u32 v55, v55, v56
    v_add_u32 v6, s65, v55
    v_add_u32 v7, 61824, v6
    v_add_u32 v3, 61824, v2
    v_and_b32 v53, 31, v1
    v_lshrrev_b32 v54, 5, v1
    v_bfe_u32 v55, v1, 1, 3
    v_xor_b32 v55, v55, v54
    v_lshlrev_b32 v55, 4, v55
    v_lshlrev_b32 v53, 7, v53
    v_add_u32 v53, v53, v55
    s_lshl_b32 s64, s51, 13
    s_add_u32 s64, s64, 103040
    v_add_u32 v8, s64, v53
    v_xor_b32 v9, 32, v8
    v_xor_b32 v10, 64, v8
    v_xor_b32 v11, 96, v8
    v_and_b32 v53, 15, v1
    v_lshrrev_b32 v54, 4, v1
    v_bfe_u32 v55, v1, 1, 3
    v_xor_b32 v55, v55, v54
    v_lshlrev_b32 v55, 4, v55
    v_lshlrev_b32 v53, 7, v53
    v_add_u32 v53, v53, v55
    v_add_u32 v12, 119424, v53
    v_xor_b32 v13, 64, v12
    v_lshrrev_b32 v53, 3, v1
    v_and_b32 v54, 3, v53
    v_lshrrev_b32 v55, 2, v53
    v_lshlrev_b32 v55, 3, v55
    v_add_u32 v54, v54, v55
    v_lshlrev_b32 v54, 10, v54
    v_bfe_u32 v55, v53, 1, 1
    v_lshlrev_b32 v55, 2, v55
    v_and_b32 v56, 7, v1
    v_xor_b32 v55, v55, v56
    v_lshlrev_b32 v55, 4, v55
    v_add_u32 v14, v54, v55
    s_and_b32 s64, s2, 7
    s_lshr_b32 s64, s64, 1
    s_and_b32 s65, s64, 1
    s_lshl_b32 s69, s48, 1
    s_add_u32 s69, s69, s65
    s_lshr_b32 s64, s64, 1
    s_lshl_b32 s64, s64, 2
    s_add_u32 s70, s64, s79
    s_mul_i32 s71, s53, 327680
    s_add_u32 s71, s71, 524288
    s_lshl_b32 s64, s70, 7
    s_add_u32 s71, s71, s64
    s_lshl_b32 s74, s50, 11
    s_mul_i32 s72, s69, 294912
    s_and_b32 s68, s48, 7
    s_cmp_eq_u32 s51, 1
    s_cselect_b32 s68, s68, 99
    s_waitcnt vmcnt(22)
    v_readfirstlane_b32 s55, v62
    v_readfirstlane_b32 s56, v63
    s_mul_i32 s55, s55, 0x9e3779b1
    s_add_u32 s55, s55, 0x7f4a7c15
    s_mul_i32 s56, s56, 0x9e3779b1
    s_add_u32 s56, s56, 0x7f4a7c15
    s_waitcnt lgkmcnt(0)
    s_barrier
    ds_read_b128 v[160:163], v8 offset:0
    ds_read_b128 v[164:167], v8 offset:4096
    ds_read_b64_tr_b16 v[176:177], v2 offset:0
    ds_read_b64_tr_b16 v[178:179], v2 offset:512
    ds_read_b64_tr_b16 v[180:181], v4 offset:0
    ds_read_b64_tr_b16 v[182:183], v4 offset:512
    ds_read_b128 v[168:171], v9 offset:0
    ds_read_b128 v[172:175], v9 offset:4096
    ds_read_b64_tr_b16 v[184:185], v2 offset:2048
    ds_read_b64_tr_b16 v[186:187], v2 offset:2560
    ds_read_b64_tr_b16 v[188:189], v4 offset:2048
    ds_read_b64_tr_b16 v[190:191], v4 offset:2560
    ds_read_b64_tr_b16 v[192:193], v6 offset:0
    ds_read_b64_tr_b16 v[194:195], v6 offset:512
    ds_read_b64_tr_b16 v[196:197], v6 offset:4096
    ds_read_b64_tr_b16 v[198:199], v6 offset:4608
    ds_read_b128 v[200:203], v12 offset:0
    s_waitcnt vmcnt(17) lgkmcnt(0)
    s_barrier
    s_cmp_lg_u32 s68, 0
    s_cbranch_scc1 RattB_nocs_45
    v_bfe_u32 v40, v1, 4, 1
    v_and_b32 v41, 1, v1
    v_cmp_eq_u32 vcc, v40, v41
    v_mov_b32 v42, 0x3f803f80
    s_nop 0
    v_cndmask_b32 v40, 0, v42, vcc
    v_mov_b32 v41, v40
    v_mov_b32 v42, v40
    v_mov_b32 v43, v40
    s_nop 1
    v_mfma_f32_16x16x32_bf16 v[44:47], v[40:43], v[176:179], 0
    v_mfma_f32_16x16x32_bf16 v[48:51], v[40:43], v[180:183], 0
    v_mfma_f32_16x16x32_bf16 v[44:47], v[40:43], v[184:187], v[44:47]
    v_mfma_f32_16x16x32_bf16 v[48:51], v[40:43], v[188:191], v[48:51]
    v_bfe_u32 v28, v1, 4, 1
    v_cmp_eq_u32 vcc, 1, v28
    s_nop 4
    v_cndmask_b32 v24, v44, v45, vcc
    v_cndmask_b32 v25, v48, v49, vcc
    v_mov_b32 v26, s56
    v_mov_b32 v27, s56
    s_lshl_b32 s64, s54, 2
    s_add_u32 s64, s64, s52
    s_add_u32 s64, s64, 2
    s_lshl_b32 s64, s64, 4
    s_add_u32 s64, s64, s48
    s_lshl_b32 s64, s64, 9
    s_add_u32 s64, s64, 0x910000
    v_lshlrev_b32 v28, 4, v1
    s_mov_b32 exec_hi, 0
    buffer_store_dwordx4 v[24:27], v28, s[32:35], s64 offen sc1
    s_mov_b32 exec_hi, -1
RattB_nocs_45:
    s_add_u32 m0, s57, 0
    s_add_u32 s64, s75, 491520
    buffer_load_dwordx4 v16, s[20:23], s64 offen lds
    ds_read_b128 v[204:207], v10 offset:0
    ds_read_b128 v[208:211], v10 offset:4096
    s_add_u32 m0, s57, 4096
    s_add_u32 s64, s75, 492544
    buffer_load_dwordx4 v16, s[20:23], s64 offen lds
    ds_read_b64_tr_b16 v[220:221], v2 offset:20608
    ds_read_b64_tr_b16 v[222:223], v2 offset:21120
    s_add_u32 m0, s57, 8192
    s_add_u32 s64, s75, 493568
    buffer_load_dwordx4 v16, s[20:23], s64 offen lds
    ds_read_b64_tr_b16 v[224:225], v4 offset:20608
    ds_read_b64_tr_b16 v[226:227], v4 offset:21120
    s_add_u32 m0, s57, 12288
    s_add_u32 s65, s77, 573440
    buffer_load_dwordx4 v17, s[24:27], s65 offen lds
    ds_read_b128 v[212:215], v11 offset:0
    ds_read_b128 v[216:219], v11 offset:4096
    s_add_u32 m0, s57, 16384
    s_nop 0
    buffer_load_dwordx4 v18, s[28:31], s65 offen lds
    ds_read_b64_tr_b16 v[228:229], v2 offset:22656
    ds_read_b64_tr_b16 v[230:231], v2 offset:23168
    ds_read_b64_tr_b16 v[232:233], v4 offset:22656
    ds_read_b64_tr_b16 v[234:235], v4 offset:23168
    ds_read_b64_tr_b16 v[236:237], v6 offset:20608
    ds_read_b64_tr_b16 v[238:239], v6 offset:21120
    ds_read_b64_tr_b16 v[240:241], v6 offset:24704
    ds_read_b64_tr_b16 v[242:243], v6 offset:25216
    ds_read_b128 v[244:247], v13 offset:0
    v_mfma_f32_32x32x16_bf16 v[64:79], v[176:179], v[160:163], 0
    v_mfma_f32_32x32x16_bf16 v[80:95], v[176:179], v[164:167], 0
    v_mfma_f32_32x32x16_bf16 v[96:111], v[180:183], v[160:163], 0
    v_mfma_f32_32x32x16_bf16 v[112:127], v[180:183], v[164:167], 0
    v_mfma_f32_16x16x32_bf16 v[128:131], v[192:195], v[200:203], 0
    v_mfma_f32_32x32x16_bf16 v[64:79], v[184:187], v[168:171], v[64:79]
    v_mfma_f32_32x32x16_bf16 v[80:95], v[184:187], v[172:175], v[80:95]
    v_mfma_f32_32x32x16_bf16 v[96:111], v[188:191], v[168:171], v[96:111]
    v_mfma_f32_16x16x32_bf16 v[132:135], v[196:199], v[200:203], 0
    v_mfma_f32_32x32x16_bf16 v[112:127], v[188:191], v[172:175], v[112:127]
    s_waitcnt vmcnt(16) lgkmcnt(0)
    s_barrier
    s_cmp_lg_u32 s68, 1
    s_cbranch_scc1 RattB_nocs_46
    v_bfe_u32 v40, v1, 4, 1
    v_and_b32 v41, 1, v1
    v_cmp_eq_u32 vcc, v40, v41
    v_mov_b32 v42, 0x3f803f80
    s_nop 0
    v_cndmask_b32 v40, 0, v42, vcc
    v_mov_b32 v41, v40
    v_mov_b32 v42, v40
    v_mov_b32 v43, v40
    s_nop 1
    v_mfma_f32_16x16x32_bf16 v[44:47], v[40:43], v[220:223], 0
    v_mfma_f32_16x16x32_bf16 v[48:51], v[40:43], v[224:227], 0
    v_mfma_f32_16x16x32_bf16 v[44:47], v[40:43], v[228:231], v[44:47]
    v_mfma_f32_16x16x32_bf16 v[48:51], v[40:43], v[232:235], v[48:51]
    v_bfe_u32 v28, v1, 4, 1
    v_cmp_eq_u32 vcc, 1, v28
    s_nop 4
    v_cndmask_b32 v24, v44, v45, vcc
    v_cndmask_b32 v25, v48, v49, vcc
    v_mov_b32 v26, s56
    v_mov_b32 v27, s56
    s_lshl_b32 s64, s54, 2
    s_add_u32 s64, s64, s52
    s_add_u32 s64, s64, 2
    s_lshl_b32 s64, s64, 4
    s_add_u32 s64, s64, s48
    s_lshl_b32 s64, s64, 9
    s_add_u32 s64, s64, 0x910000
    v_lshlrev_b32 v28, 4, v1
    s_mov_b32 exec_hi, 0
    buffer_store_dwordx4 v[24:27], v28, s[32:35], s64 offen sc1
    s_mov_b32 exec_hi, -1
RattB_nocs_46:
    s_add_u32 m0, s57, 20608
    s_add_u32 s64, s75, 589824
    buffer_load_dwordx4 v16, s[20:23], s64 offen lds
    ds_read_b128 v[160:163], v8 offset:18432
    ds_read_b128 v[164:167], v8 offset:22528
    s_add_u32 m0, s57, 24704
    s_add_u32 s64, s75, 590848
    buffer_load_dwordx4 v16, s[20:23], s64 offen lds
    ds_read_b64_tr_b16 v[176:177], v2 offset:41216
    ds_read_b64_tr_b16 v[178:179], v2 offset:41728
    s_add_u32 m0, s57, 28800
    s_add_u32 s64, s75, 591872
    buffer_load_dwordx4 v16, s[20:23], s64 offen lds
    ds_read_b64_tr_b16 v[180:181], v4 offset:41216
    ds_read_b64_tr_b16 v[182:183], v4 offset:41728
    s_add_u32 m0, s57, 32896
    s_add_u32 s65, s77, 688128
    buffer_load_dwordx4 v17, s[24:27], s65 offen lds
    ds_read_b128 v[168:171], v9 offset:18432
    ds_read_b128 v[172:175], v9 offset:22528
    s_add_u32 m0, s57, 36992
    s_nop 0
    buffer_load_dwordx4 v18, s[28:31], s65 offen lds
    ds_read_b64_tr_b16 v[184:185], v2 offset:43264
    ds_read_b64_tr_b16 v[186:187], v2 offset:43776
    s_add_u32 m0, s58, 0
    s_add_u32 s64, s62, 384
    buffer_load_dwordx4 v23, s[16:19], s64 offen lds
    ds_read_b64_tr_b16 v[188:189], v4 offset:43264
    ds_read_b64_tr_b16 v[190:191], v4 offset:43776
    ds_read_b64_tr_b16 v[192:193], v6 offset:41216
    ds_read_b64_tr_b16 v[194:195], v6 offset:41728
    ds_read_b64_tr_b16 v[196:197], v6 offset:45312
    ds_read_b64_tr_b16 v[198:199], v6 offset:45824
    ds_read_b128 v[200:203], v12 offset:18432
    v_mfma_f32_32x32x16_bf16 v[64:79], v[220:223], v[204:207], v[64:79]
    v_mfma_f32_32x32x16_bf16 v[80:95], v[220:223], v[208:211], v[80:95]
    v_mfma_f32_32x32x16_bf16 v[96:111], v[224:227], v[204:207], v[96:111]
    v_mfma_f32_32x32x16_bf16 v[112:127], v[224:227], v[208:211], v[112:127]
    v_mfma_f32_16x16x32_bf16 v[128:131], v[236:239], v[244:247], v[128:131]
    v_mfma_f32_32x32x16_bf16 v[64:79], v[228:231], v[212:215], v[64:79]
    v_mfma_f32_32x32x16_bf16 v[80:95], v[228:231], v[216:219], v[80:95]
    v_mfma_f32_32x32x16_bf16 v[96:111], v[232:235], v[212:215], v[96:111]
    v_mfma_f32_16x16x32_bf16 v[132:135], v[240:243], v[244:247], v[132:135]
    v_mfma_f32_32x32x16_bf16 v[112:127], v[232:235], v[216:219], v[112:127]
    s_waitcnt vmcnt(17) lgkmcnt(0)
    s_barrier
    s_cmp_lg_u32 s68, 2
    s_cbranch_scc1 RattB_nocs_47
    v_bfe_u32 v40, v1, 4, 1
    v_and_b32 v41, 1, v1
    v_cmp_eq_u32 vcc, v40, v41
    v_mov_b32 v42, 0x3f803f80
    s_nop 0
    v_cndmask_b32 v40, 0, v42, vcc
    v_mov_b32 v41, v40
    v_mov_b32 v42, v40
    v_mov_b32 v43, v40
    s_nop 1
    v_mfma_f32_16x16x32_bf16 v[44:47], v[40:43], v[176:179], 0
    v_mfma_f32_16x16x32_bf16 v[48:51], v[40:43], v[180:183], 0
    v_mfma_f32_16x16x32_bf16 v[44:47], v[40:43], v[184:187], v[44:47]
    v_mfma_f32_16x16x32_bf16 v[48:51], v[40:43], v[188:191], v[48:51]
    v_bfe_u32 v28, v1, 4, 1
    v_cmp_eq_u32 vcc, 1, v28
    s_nop 4
    v_cndmask_b32 v24, v44, v45, vcc
    v_cndmask_b32 v25, v48, v49, vcc
    v_mov_b32 v26, s56
    v_mov_b32 v27, s56
    s_lshl_b32 s64, s54, 2
    s_add_u32 s64, s64, s52
    s_add_u32 s64, s64, 2
    s_lshl_b32 s64, s64, 4
    s_add_u32 s64, s64, s48
    s_lshl_b32 s64, s64, 9
    s_add_u32 s64, s64, 0x910000
    v_lshlrev_b32 v28, 4, v1
    s_mov_b32 exec_hi, 0
    buffer_store_dwordx4 v[24:27], v28, s[32:35], s64 offen sc1
    s_mov_b32 exec_hi, -1
RattB_nocs_47:
    s_add_u32 m0, s57, 41216
    s_add_u32 s64, s75, 688128
    buffer_load_dwordx4 v16, s[20:23], s64 offen lds
    ds_read_b128 v[204:207], v10 offset:18432
    ds_read_b128 v[208:211], v10 offset:22528
    s_add_u32 m0, s57, 45312
    s_add_u32 s64, s75, 689152
    buffer_load_dwordx4 v16, s[20:23], s64 offen lds
    ds_read_b64_tr_b16 v[220:221], v3 offset:0
    ds_read_b64_tr_b16 v[222:223], v3 offset:512
    s_add_u32 m0, s57, 49408
    s_add_u32 s64, s75, 690176
    buffer_load_dwordx4 v16, s[20:23], s64 offen lds
    ds_read_b64_tr_b16 v[224:225], v5 offset:0
    ds_read_b64_tr_b16 v[226:227], v5 offset:512
    s_add_u32 m0, s57, 53504
    s_add_u32 s65, s77, 802816
    buffer_load_dwordx4 v17, s[24:27], s65 offen lds
    ds_read_b128 v[212:215], v11 offset:18432
    ds_read_b128 v[216:219], v11 offset:22528
    s_add_u32 m0, s57, 57600
    s_nop 0
    buffer_load_dwordx4 v18, s[28:31], s65 offen lds
    ds_read_b64_tr_b16 v[228:229], v3 offset:2048
    ds_read_b64_tr_b16 v[230:231], v3 offset:2560
    ds_read_b64_tr_b16 v[232:233], v5 offset:2048
    ds_read_b64_tr_b16 v[234:235], v5 offset:2560
    ds_read_b64_tr_b16 v[236:237], v7 offset:0
    ds_read_b64_tr_b16 v[238:239], v7 offset:512
    ds_read_b64_tr_b16 v[240:241], v7 offset:4096
    ds_read_b64_tr_b16 v[242:243], v7 offset:4608
    ds_read_b128 v[244:247], v13 offset:18432
    v_mfma_f32_32x32x16_bf16 v[64:79], v[176:179], v[160:163], v[64:79]
    v_mfma_f32_32x32x16_bf16 v[80:95], v[176:179], v[164:167], v[80:95]
    v_mfma_f32_32x32x16_bf16 v[96:111], v[180:183], v[160:163], v[96:111]
    v_mfma_f32_32x32x16_bf16 v[112:127], v[180:183], v[164:167], v[112:127]
    v_mfma_f32_16x16x32_bf16 v[128:131], v[192:195], v[200:203], v[128:131]
    v_mfma_f32_32x32x16_bf16 v[64:79], v[184:187], v[168:171], v[64:79]
    v_mfma_f32_32x32x16_bf16 v[80:95], v[184:187], v[172:175], v[80:95]
    v_mfma_f32_32x32x16_bf16 v[96:111], v[188:191], v[168:171], v[96:111]
    v_mfma_f32_16x16x32_bf16 v[132:135], v[196:199], v[200:203], v[132:135]
    v_mfma_f32_32x32x16_bf16 v[112:127], v[188:191], v[172:175], v[112:127]
    s_waitcnt vmcnt(16) lgkmcnt(0)
    s_barrier
    s_cmp_lg_u32 s68, 3
    s_cbranch_scc1 RattB_nocs_48
    v_bfe_u32 v40, v1, 4, 1
    v_and_b32 v41, 1, v1
    v_cmp_eq_u32 vcc, v40, v41
    v_mov_b32 v42, 0x3f803f80
    s_nop 0
    v_cndmask_b32 v40, 0, v42, vcc
    v_mov_b32 v41, v40
    v_mov_b32 v42, v40
    v_mov_b32 v43, v40
    s_nop 1
    v_mfma_f32_16x16x32_bf16 v[44:47], v[40:43], v[220:223], 0
    v_mfma_f32_16x16x32_bf16 v[48:51], v[40:43], v[224:227], 0
    v_mfma_f32_16x16x32_bf16 v[44:47], v[40:43], v[228:231], v[44:47]
    v_mfma_f32_16x16x32_bf16 v[48:51], v[40:43], v[232:235], v[48:51]
    v_bfe_u32 v28, v1, 4, 1
    v_cmp_eq_u32 vcc, 1, v28
    s_nop 4
    v_cndmask_b32 v24, v44, v45, vcc
    v_cndmask_b32 v25, v48, v49, vcc
    v_mov_b32 v26, s56
    v_mov_b32 v27, s56
    s_lshl_b32 s64, s54, 2
    s_add_u32 s64, s64, s52
    s_add_u32 s64, s64, 2
    s_lshl_b32 s64, s64, 4
    s_add_u32 s64, s64, s48
    s_lshl_b32 s64, s64, 9
    s_add_u32 s64, s64, 0x910000
    v_lshlrev_b32 v28, 4, v1
    s_mov_b32 exec_hi, 0
    buffer_store_dwordx4 v[24:27], v28, s[32:35], s64 offen sc1
    s_mov_b32 exec_hi, -1
RattB_nocs_48:
    s_add_u32 m0, s57, 61824
    s_nop 0
    buffer_load_dwordx4 v16, s[20:23], s76 offen lds
    ds_read_b128 v[160:163], v8 offset:36864
    ds_read_b128 v[164:167], v8 offset:40960
    s_add_u32 m0, s57, 65920
    s_add_u32 s64, s76, 1024
    buffer_load_dwordx4 v16, s[20:23], s64 offen lds
    ds_read_b64_tr_b16 v[176:177], v3 offset:20608
    ds_read_b64_tr_b16 v[178:179], v3 offset:21120
    s_add_u32 m0, s57, 70016
    s_add_u32 s64, s76, 2048
    buffer_load_dwordx4 v16, s[20:23], s64 offen lds
    ds_read_b64_tr_b16 v[180:181], v5 offset:20608
    ds_read_b64_tr_b16 v[182:183], v5 offset:21120
    s_add_u32 m0, s57, 74112
    s_nop 0
    buffer_load_dwordx4 v17, s[24:27], s78 offen lds
    ds_read_b128 v[168:171], v9 offset:36864
    ds_read_b128 v[172:175], v9 offset:40960
    s_add_u32 m0, s57, 78208
    s_nop 0
    buffer_load_dwordx4 v18, s[28:31], s78 offen lds
    ds_read_b64_tr_b16 v[184:185], v3 offset:22656
    ds_read_b64_tr_b16 v[186:187], v3 offset:23168
    s_add_u32 m0, s58, 18432
    s_nop 0
    buffer_load_dwordx4 v23, s[16:19], s63 offen lds
    ds_read_b64_tr_b16 v[188:189], v5 offset:22656
    ds_read_b64_tr_b16 v[190:191], v5 offset:23168
    ds_read_b64_tr_b16 v[192:193], v7 offset:20608
    ds_read_b64_tr_b16 v[194:195], v7 offset:21120
    ds_read_b64_tr_b16 v[196:197], v7 offset:24704
    ds_read_b64_tr_b16 v[198:199], v7 offset:25216
    ds_read_b128 v[200:203], v12 offset:36864
    v_mfma_f32_32x32x16_bf16 v[64:79], v[220:223], v[204:207], v[64:79]
    v_mfma_f32_32x32x16_bf16 v[80:95], v[220:223], v[208:211], v[80:95]
    v_mfma_f32_32x32x16_bf16 v[96:111], v[224:227], v[204:207], v[96:111]
    v_mfma_f32_32x32x16_bf16 v[112:127], v[224:227], v[208:211], v[112:127]
    v_mfma_f32_16x16x32_bf16 v[128:131], v[236:239], v[244:247], v[128:131]
    v_mfma_f32_32x32x16_bf16 v[64:79], v[228:231], v[212:215], v[64:79]
    v_mfma_f32_32x32x16_bf16 v[80:95], v[228:231], v[216:219], v[80:95]
    v_mfma_f32_32x32x16_bf16 v[96:111], v[232:235], v[212:215], v[96:111]
    v_mfma_f32_16x16x32_bf16 v[132:135], v[240:243], v[244:247], v[132:135]
    v_mfma_f32_32x32x16_bf16 v[112:127], v[232:235], v[216:219], v[112:127]
    s_waitcnt vmcnt(17) lgkmcnt(0)
    s_barrier
    s_cmp_lg_u32 s68, 4
    s_cbranch_scc1 RattB_nocs_49
    v_bfe_u32 v40, v1, 4, 1
    v_and_b32 v41, 1, v1
    v_cmp_eq_u32 vcc, v40, v41
    v_mov_b32 v42, 0x3f803f80
    s_nop 0
    v_cndmask_b32 v40, 0, v42, vcc
    v_mov_b32 v41, v40
    v_mov_b32 v42, v40
    v_mov_b32 v43, v40
    s_nop 1
    v_mfma_f32_16x16x32_bf16 v[44:47], v[40:43], v[176:179], 0
    v_mfma_f32_16x16x32_bf16 v[48:51], v[40:43], v[180:183], 0
    v_mfma_f32_16x16x32_bf16 v[44:47], v[40:43], v[184:187], v[44:47]
    v_mfma_f32_16x16x32_bf16 v[48:51], v[40:43], v[188:191], v[48:51]
    v_bfe_u32 v28, v1, 4, 1
    v_cmp_eq_u32 vcc, 1, v28
    s_nop 4
    v_cndmask_b32 v24, v44, v45, vcc
    v_cndmask_b32 v25, v48, v49, vcc
    v_mov_b32 v26, s56
    v_mov_b32 v27, s56
    s_lshl_b32 s64, s54, 2
    s_add_u32 s64, s64, s52
    s_add_u32 s64, s64, 2
    s_lshl_b32 s64, s64, 4
    s_add_u32 s64, s64, s48
    s_lshl_b32 s64, s64, 9
    s_add_u32 s64, s64, 0x910000
    v_lshlrev_b32 v28, 4, v1
    s_mov_b32 exec_hi, 0
    buffer_store_dwordx4 v[24:27], v28, s[32:35], s64 offen sc1
    s_mov_b32 exec_hi, -1
RattB_nocs_49:
    s_add_u32 m0, s57, 82432
    s_add_u32 s64, s76, 98304
    buffer_load_dwordx4 v16, s[20:23], s64 offen lds
    ds_read_b128 v[204:207], v10 offset:36864
    ds_read_b128 v[208:211], v10 offset:40960
    s_add_u32 m0, s57, 86528
    s_add_u32 s64, s76, 99328
    buffer_load_dwordx4 v16, s[20:23], s64 offen lds
    ds_read_b64_tr_b16 v[220:221], v2 offset:0
    ds_read_b64_tr_b16 v[222:223], v2 offset:512
    s_add_u32 m0, s57, 90624
    s_add_u32 s64, s76, 100352
    buffer_load_dwordx4 v16, s[20:23], s64 offen lds
    ds_read_b64_tr_b16 v[224:225], v4 offset:0
    ds_read_b64_tr_b16 v[226:227], v4 offset:512
    s_add_u32 m0, s57, 94720
    s_add_u32 s65, s78, 114688
    buffer_load_dwordx4 v17, s[24:27], s65 offen lds
    ds_read_b128 v[212:215], v11 offset:36864
    ds_read_b128 v[216:219], v11 offset:40960
    s_add_u32 m0, s57, 98816
    s_nop 0
    buffer_load_dwordx4 v18, s[28:31], s65 offen lds
    ds_read_b64_tr_b16 v[228:229], v2 offset:2048
    ds_read_b64_tr_b16 v[230:231], v2 offset:2560
    ds_read_b64_tr_b16 v[232:233], v4 offset:2048
    ds_read_b64_tr_b16 v[234:235], v4 offset:2560
    ds_read_b64_tr_b16 v[236:237], v6 offset:0
    ds_read_b64_tr_b16 v[238:239], v6 offset:512
    ds_read_b64_tr_b16 v[240:241], v6 offset:4096
    ds_read_b64_tr_b16 v[242:243], v6 offset:4608
    ds_read_b128 v[244:247], v13 offset:36864
    v_mfma_f32_32x32x16_bf16 v[64:79], v[176:179], v[160:163], v[64:79]
    v_mfma_f32_32x32x16_bf16 v[80:95], v[176:179], v[164:167], v[80:95]
    v_mfma_f32_32x32x16_bf16 v[96:111], v[180:183], v[160:163], v[96:111]
    v_mfma_f32_32x32x16_bf16 v[112:127], v[180:183], v[164:167], v[112:127]
    v_mfma_f32_16x16x32_bf16 v[128:131], v[192:195], v[200:203], v[128:131]
    v_mfma_f32_32x32x16_bf16 v[64:79], v[184:187], v[168:171], v[64:79]
    v_mfma_f32_32x32x16_bf16 v[80:95], v[184:187], v[172:175], v[80:95]
    v_mfma_f32_32x32x16_bf16 v[96:111], v[188:191], v[168:171], v[96:111]
    v_mfma_f32_16x16x32_bf16 v[132:135], v[196:199], v[200:203], v[132:135]
    v_mfma_f32_32x32x16_bf16 v[112:127], v[188:191], v[172:175], v[112:127]
    s_waitcnt vmcnt(16) lgkmcnt(0)
    s_barrier
    s_cmp_lg_u32 s68, 5
    s_cbranch_scc1 RattB_nocs_50
    v_bfe_u32 v40, v1, 4, 1
    v_and_b32 v41, 1, v1
    v_cmp_eq_u32 vcc, v40, v41
    v_mov_b32 v42, 0x3f803f80
    s_nop 0
    v_cndmask_b32 v40, 0, v42, vcc
    v_mov_b32 v41, v40
    v_mov_b32 v42, v40
    v_mov_b32 v43, v40
    s_nop 1
    v_mfma_f32_16x16x32_bf16 v[44:47], v[40:43], v[220:223], 0
    v_mfma_f32_16x16x32_bf16 v[48:51], v[40:43], v[224:227], 0
    v_mfma_f32_16x16x32_bf16 v[44:47], v[40:43], v[228:231], v[44:47]
    v_mfma_f32_16x16x32_bf16 v[48:51], v[40:43], v[232:235], v[48:51]
    v_bfe_u32 v28, v1, 4, 1
    v_cmp_eq_u32 vcc, 1, v28
    s_nop 4
    v_cndmask_b32 v24, v44, v45, vcc
    v_cndmask_b32 v25, v48, v49, vcc
    v_mov_b32 v26, s56
    v_mov_b32 v27, s56
    s_lshl_b32 s64, s54, 2
    s_add_u32 s64, s64, s52
    s_add_u32 s64, s64, 2
    s_lshl_b32 s64, s64, 4
    s_add_u32 s64, s64, s48
    s_lshl_b32 s64, s64, 9
    s_add_u32 s64, s64, 0x910000
    v_lshlrev_b32 v28, 4, v1
    s_mov_b32 exec_hi, 0
    buffer_store_dwordx4 v[24:27], v28, s[32:35], s64 offen sc1
    s_mov_b32 exec_hi, -1
RattB_nocs_50:
    s_add_u32 m0, s57, 0
    s_add_u32 s64, s76, 196608
    buffer_load_dwordx4 v16, s[20:23], s64 offen lds
    ds_read_b128 v[160:163], v8 offset:0
    ds_read_b128 v[164:167], v8 offset:4096
    s_add_u32 m0, s57, 4096
    s_add_u32 s64, s76, 197632
    buffer_load_dwordx4 v16, s[20:23], s64 offen lds
    ds_read_b64_tr_b16 v[176:177], v2 offset:20608
    ds_read_b64_tr_b16 v[178:179], v2 offset:21120
    s_add_u32 m0, s57, 8192
    s_add_u32 s64, s76, 198656
    buffer_load_dwordx4 v16, s[20:23], s64 offen lds
    ds_read_b64_tr_b16 v[180:181], v4 offset:20608
    ds_read_b64_tr_b16 v[182:183], v4 offset:21120
    s_add_u32 m0, s57, 12288
    s_add_u32 s65, s78, 229376
    buffer_load_dwordx4 v17, s[24:27], s65 offen lds
    ds_read_b128 v[168:171], v9 offset:0
    ds_read_b128 v[172:175], v9 offset:4096
    s_add_u32 m0, s57, 16384
    s_nop 0
    buffer_load_dwordx4 v18, s[28:31], s65 offen lds
    ds_read_b64_tr_b16 v[184:185], v2 offset:22656
    ds_read_b64_tr_b16 v[186:187], v2 offset:23168
    s_add_u32 m0, s58, 36864
    s_add_u32 s64, s63, 128
    buffer_load_dwordx4 v23, s[16:19], s64 offen lds
    ds_read_b64_tr_b16 v[188:189], v4 offset:22656
    ds_read_b64_tr_b16 v[190:191], v4 offset:23168
    ds_read_b64_tr_b16 v[192:193], v6 offset:20608
    ds_read_b64_tr_b16 v[194:195], v6 offset:21120
    ds_read_b64_tr_b16 v[196:197], v6 offset:24704
    ds_read_b64_tr_b16 v[198:199], v6 offset:25216
    ds_read_b128 v[200:203], v12 offset:0
    v_mfma_f32_32x32x16_bf16 v[64:79], v[220:223], v[204:207], v[64:79]
    v_mfma_f32_32x32x16_bf16 v[80:95], v[220:223], v[208:211], v[80:95]
    v_mfma_f32_32x32x16_bf16 v[96:111], v[224:227], v[204:207], v[96:111]
    v_mfma_f32_32x32x16_bf16 v[112:127], v[224:227], v[208:211], v[112:127]
    v_mfma_f32_16x16x32_bf16 v[128:131], v[236:239], v[244:247], v[128:131]
    v_mfma_f32_32x32x16_bf16 v[64:79], v[228:231], v[212:215], v[64:79]
    v_mfma_f32_32x32x16_bf16 v[80:95], v[228:231], v[216:219], v[80:95]
    v_mfma_f32_32x32x16_bf16 v[96:111], v[232:235], v[212:215], v[96:111]
    v_mfma_f32_16x16x32_bf16 v[132:135], v[240:243], v[244:247], v[132:135]
    v_mfma_f32_32x32x16_bf16 v[112:127], v[232:235], v[216:219], v[112:127]
    s_waitcnt vmcnt(17) lgkmcnt(0)
    s_barrier
    s_cmp_lg_u32 s68, 6
    s_cbranch_scc1 RattB_nocs_51
    v_bfe_u32 v40, v1, 4, 1
    v_and_b32 v41, 1, v1
    v_cmp_eq_u32 vcc, v40, v41
    v_mov_b32 v42, 0x3f803f80
    s_nop 0
    v_cndmask_b32 v40, 0, v42, vcc
    v_mov_b32 v41, v40
    v_mov_b32 v42, v40
    v_mov_b32 v43, v40
    s_nop 1
    v_mfma_f32_16x16x32_bf16 v[44:47], v[40:43], v[176:179], 0
    v_mfma_f32_16x16x32_bf16 v[48:51], v[40:43], v[180:183], 0
    v_mfma_f32_16x16x32_bf16 v[44:47], v[40:43], v[184:187], v[44:47]
    v_mfma_f32_16x16x32_bf16 v[48:51], v[40:43], v[188:191], v[48:51]
    v_bfe_u32 v28, v1, 4, 1
    v_cmp_eq_u32 vcc, 1, v28
    s_nop 4
    v_cndmask_b32 v24, v44, v45, vcc
    v_cndmask_b32 v25, v48, v49, vcc
    v_mov_b32 v26, s56
    v_mov_b32 v27, s56
    s_lshl_b32 s64, s54, 2
    s_add_u32 s64, s64, s52
    s_add_u32 s64, s64, 2
    s_lshl_b32 s64, s64, 4
    s_add_u32 s64, s64, s48
    s_lshl_b32 s64, s64, 9
    s_add_u32 s64, s64, 0x910000
    v_lshlrev_b32 v28, 4, v1
    s_mov_b32 exec_hi, 0
    buffer_store_dwordx4 v[24:27], v28, s[32:35], s64 offen sc1
    s_mov_b32 exec_hi, -1
RattB_nocs_51:
    s_add_u32 m0, s57, 20608
    s_add_u32 s64, s76, 294912
    buffer_load_dwordx4 v16, s[20:23], s64 offen lds
    ds_read_b128 v[204:207], v10 offset:0
    ds_read_b128 v[208:211], v10 offset:4096
    s_add_u32 m0, s57, 24704
    s_add_u32 s64, s76, 295936
    buffer_load_dwordx4 v16, s[20:23], s64 offen lds
    ds_read_b64_tr_b16 v[220:221], v2 offset:41216
    ds_read_b64_tr_b16 v[222:223], v2 offset:41728
    s_add_u32 m0, s57, 28800
    s_add_u32 s64, s76, 296960
    buffer_load_dwordx4 v16, s[20:23], s64 offen lds
    ds_read_b64_tr_b16 v[224:225], v4 offset:41216
    ds_read_b64_tr_b16 v[226:227], v4 offset:41728
    s_add_u32 m0, s57, 32896
    s_add_u32 s65, s78, 344064
    buffer_load_dwordx4 v17, s[24:27], s65 offen lds
    ds_read_b128 v[212:215], v11 offset:0
    ds_read_b128 v[216:219], v11 offset:4096
    s_add_u32 m0, s57, 36992
    s_nop 0
    buffer_load_dwordx4 v18, s[28:31], s65 offen lds
    ds_read_b64_tr_b16 v[228:229], v2 offset:43264
    ds_read_b64_tr_b16 v[230:231], v2 offset:43776
    ds_read_b64_tr_b16 v[232:233], v4 offset:43264
    ds_read_b64_tr_b16 v[234:235], v4 offset:43776
    ds_read_b64_tr_b16 v[236:237], v6 offset:41216
    ds_read_b64_tr_b16 v[238:239], v6 offset:41728
    ds_read_b64_tr_b16 v[240:241], v6 offset:45312
    ds_read_b64_tr_b16 v[242:243], v6 offset:45824
    ds_read_b128 v[244:247], v13 offset:0
    v_mfma_f32_32x32x16_bf16 v[64:79], v[176:179], v[160:163], v[64:79]
    v_mfma_f32_32x32x16_bf16 v[80:95], v[176:179], v[164:167], v[80:95]
    v_mfma_f32_32x32x16_bf16 v[96:111], v[180:183], v[160:163], v[96:111]
    v_mfma_f32_32x32x16_bf16 v[112:127], v[180:183], v[164:167], v[112:127]
    v_mfma_f32_16x16x32_bf16 v[128:131], v[192:195], v[200:203], v[128:131]
    v_mfma_f32_32x32x16_bf16 v[64:79], v[184:187], v[168:171], v[64:79]
    v_mfma_f32_32x32x16_bf16 v[80:95], v[184:187], v[172:175], v[80:95]
    v_mfma_f32_32x32x16_bf16 v[96:111], v[188:191], v[168:171], v[96:111]
    v_mfma_f32_16x16x32_bf16 v[132:135], v[196:199], v[200:203], v[132:135]
    v_mfma_f32_32x32x16_bf16 v[112:127], v[188:191], v[172:175], v[112:127]
    s_waitcnt vmcnt(16) lgkmcnt(0)
    s_barrier
    s_cmp_lg_u32 s68, 7
    s_cbranch_scc1 RattB_nocs_52
    v_bfe_u32 v40, v1, 4, 1
    v_and_b32 v41, 1, v1
    v_cmp_eq_u32 vcc, v40, v41
    v_mov_b32 v42, 0x3f803f80
    s_nop 0
    v_cndmask_b32 v40, 0, v42, vcc
    v_mov_b32 v41, v40
    v_mov_b32 v42, v40
    v_mov_b32 v43, v40
    s_nop 1
    v_mfma_f32_16x16x32_bf16 v[44:47], v[40:43], v[220:223], 0
    v_mfma_f32_16x16x32_bf16 v[48:51], v[40:43], v[224:227], 0
    v_mfma_f32_16x16x32_bf16 v[44:47], v[40:43], v[228:231], v[44:47]
    v_mfma_f32_16x16x32_bf16 v[48:51], v[40:43], v[232:235], v[48:51]
    v_bfe_u32 v28, v1, 4, 1
    v_cmp_eq_u32 vcc, 1, v28
    s_nop 4
    v_cndmask_b32 v24, v44, v45, vcc
    v_cndmask_b32 v25, v48, v49, vcc
    v_mov_b32 v26, s56
    v_mov_b32 v27, s56
    s_lshl_b32 s64, s54, 2
    s_add_u32 s64, s64, s52
    s_add_u32 s64, s64, 2
    s_lshl_b32 s64, s64, 4
    s_add_u32 s64, s64, s48
    s_lshl_b32 s64, s64, 9
    s_add_u32 s64, s64, 0x910000
    v_lshlrev_b32 v28, 4, v1
    s_mov_b32 exec_hi, 0
    buffer_store_dwordx4 v[24:27], v28, s[32:35], s64 offen sc1
    s_mov_b32 exec_hi, -1
RattB_nocs_52:
    s_add_u32 m0, s57, 41216
    s_add_u32 s64, s76, 393216
    buffer_load_dwordx4 v16, s[20:23], s64 offen lds
    ds_read_b128 v[160:163], v8 offset:18432
    ds_read_b128 v[164:167], v8 offset:22528
    s_add_u32 m0, s57, 45312
    s_add_u32 s64, s76, 394240
    buffer_load_dwordx4 v16, s[20:23], s64 offen lds
    ds_read_b64_tr_b16 v[176:177], v3 offset:0
    ds_read_b64_tr_b16 v[178:179], v3 offset:512
    s_add_u32 m0, s57, 49408
    s_add_u32 s64, s76, 395264
    buffer_load_dwordx4 v16, s[20:23], s64 offen lds
    ds_read_b64_tr_b16 v[180:181], v5 offset:0
    ds_read_b64_tr_b16 v[182:183], v5 offset:512
    s_add_u32 m0, s57, 53504
    s_add_u32 s65, s78, 458752
    buffer_load_dwordx4 v17, s[24:27], s65 offen lds
    ds_read_b128 v[168:171], v9 offset:18432
    ds_read_b128 v[172:175], v9 offset:22528
    s_add_u32 m0, s57, 57600
    s_nop 0
    buffer_load_dwordx4 v18, s[28:31], s65 offen lds
    ds_read_b64_tr_b16 v[184:185], v3 offset:2048
    ds_read_b64_tr_b16 v[186:187], v3 offset:2560
    s_add_u32 m0, s58, 0
    s_add_u32 s64, s63, 256
    buffer_load_dwordx4 v23, s[16:19], s64 offen lds
    ds_read_b64_tr_b16 v[188:189], v5 offset:2048
    ds_read_b64_tr_b16 v[190:191], v5 offset:2560
    ds_read_b64_tr_b16 v[192:193], v7 offset:0
    ds_read_b64_tr_b16 v[194:195], v7 offset:512
    ds_read_b64_tr_b16 v[196:197], v7 offset:4096
    ds_read_b64_tr_b16 v[198:199], v7 offset:4608
    ds_read_b128 v[200:203], v12 offset:18432
    v_mfma_f32_32x32x16_bf16 v[64:79], v[220:223], v[204:207], v[64:79]
    v_mfma_f32_32x32x16_bf16 v[80:95], v[220:223], v[208:211], v[80:95]
    v_mfma_f32_32x32x16_bf16 v[96:111], v[224:227], v[204:207], v[96:111]
    v_mfma_f32_32x32x16_bf16 v[112:127], v[224:227], v[208:211], v[112:127]
    v_mfma_f32_16x16x32_bf16 v[128:131], v[236:239], v[244:247], v[128:131]
    v_mfma_f32_32x32x16_bf16 v[64:79], v[228:231], v[212:215], v[64:79]
    v_mfma_f32_32x32x16_bf16 v[80:95], v[228:231], v[216:219], v[80:95]
    v_mfma_f32_32x32x16_bf16 v[96:111], v[232:235], v[212:215], v[96:111]
    v_mfma_f32_16x16x32_bf16 v[132:135], v[240:243], v[244:247], v[132:135]
    v_mfma_f32_32x32x16_bf16 v[112:127], v[232:235], v[216:219], v[112:127]
    s_waitcnt vmcnt(17) lgkmcnt(0)
    s_barrier
    s_add_u32 m0, s57, 61824
    s_add_u32 s64, s76, 491520
    buffer_load_dwordx4 v16, s[20:23], s64 offen lds
    ds_read_b128 v[204:207], v10 offset:18432
    ds_read_b128 v[208:211], v10 offset:22528
    s_add_u32 m0, s57, 65920
    s_add_u32 s64, s76, 492544
    buffer_load_dwordx4 v16, s[20:23], s64 offen lds
    ds_read_b64_tr_b16 v[220:221], v3 offset:20608
    ds_read_b64_tr_b16 v[222:223], v3 offset:21120
    s_add_u32 m0, s57, 70016
    s_add_u32 s64, s76, 493568
    buffer_load_dwordx4 v16, s[20:23], s64 offen lds
    ds_read_b64_tr_b16 v[224:225], v5 offset:20608
    ds_read_b64_tr_b16 v[226:227], v5 offset:21120
    s_add_u32 m0, s57, 74112
    s_add_u32 s65, s78, 573440
    buffer_load_dwordx4 v17, s[24:27], s65 offen lds
    ds_read_b128 v[212:215], v11 offset:18432
    ds_read_b128 v[216:219], v11 offset:22528
    s_add_u32 m0, s57, 78208
    s_nop 0
    buffer_load_dwordx4 v18, s[28:31], s65 offen lds
    ds_read_b64_tr_b16 v[228:229], v3 offset:22656
    ds_read_b64_tr_b16 v[230:231], v3 offset:23168
    ds_read_b64_tr_b16 v[232:233], v5 offset:22656
    ds_read_b64_tr_b16 v[234:235], v5 offset:23168
    ds_read_b64_tr_b16 v[236:237], v7 offset:20608
    ds_read_b64_tr_b16 v[238:239], v7 offset:21120
    ds_read_b64_tr_b16 v[240:241], v7 offset:24704
    ds_read_b64_tr_b16 v[242:243], v7 offset:25216
    ds_read_b128 v[244:247], v13 offset:18432
    v_mfma_f32_32x32x16_bf16 v[64:79], v[176:179], v[160:163], v[64:79]
    v_mfma_f32_32x32x16_bf16 v[80:95], v[176:179], v[164:167], v[80:95]
    v_mfma_f32_32x32x16_bf16 v[96:111], v[180:183], v[160:163], v[96:111]
    v_mfma_f32_32x32x16_bf16 v[112:127], v[180:183], v[164:167], v[112:127]
    v_mfma_f32_16x16x32_bf16 v[128:131], v[192:195], v[200:203], v[128:131]
    v_mfma_f32_32x32x16_bf16 v[64:79], v[184:187], v[168:171], v[64:79]
    v_mfma_f32_32x32x16_bf16 v[80:95], v[184:187], v[172:175], v[80:95]
    v_mfma_f32_32x32x16_bf16 v[96:111], v[188:191], v[168:171], v[96:111]
    v_mfma_f32_16x16x32_bf16 v[132:135], v[196:199], v[200:203], v[132:135]
    v_mfma_f32_32x32x16_bf16 v[112:127], v[188:191], v[172:175], v[112:127]
    s_waitcnt vmcnt(16) lgkmcnt(0)
    s_barrier
    s_add_u32 m0, s57, 82432
    s_add_u32 s64, s76, 589824
    buffer_load_dwordx4 v16, s[20:23], s64 offen lds
    ds_read_b128 v[160:163], v8 offset:36864
    ds_read_b128 v[164:167], v8 offset:40960
    s_add_u32 m0, s57, 86528
    s_add_u32 s64, s76, 590848
    buffer_load_dwordx4 v16, s[20:23], s64 offen lds
    ds_read_b64_tr_b16 v[176:177], v2 offset:0
    ds_read_b64_tr_b16 v[178:179], v2 offset:512
    s_add_u32 m0, s57, 90624
    s_add_u32 s64, s76, 591872
    buffer_load_dwordx4 v16, s[20:23], s64 offen lds
    ds_read_b64_tr_b16 v[180:181], v4 offset:0
    ds_read_b64_tr_b16 v[182:183], v4 offset:512
    s_add_u32 m0, s57, 94720
    s_add_u32 s65, s78, 688128
    buffer_load_dwordx4 v17, s[24:27], s65 offen lds
    ds_read_b128 v[168:171], v9 offset:36864
    ds_read_b128 v[172:175], v9 offset:40960
    s_add_u32 m0, s57, 98816
    s_nop 0
    buffer_load_dwordx4 v18, s[28:31], s65 offen lds
    ds_read_b64_tr_b16 v[184:185], v2 offset:2048
    ds_read_b64_tr_b16 v[186:187], v2 offset:2560
    s_add_u32 m0, s58, 18432
    s_add_u32 s64, s63, 384
    buffer_load_dwordx4 v23, s[16:19], s64 offen lds
    ds_read_b64_tr_b16 v[188:189], v4 offset:2048
    ds_read_b64_tr_b16 v[190:191], v4 offset:2560
    ds_read_b64_tr_b16 v[192:193], v6 offset:0
    ds_read_b64_tr_b16 v[194:195], v6 offset:512
    ds_read_b64_tr_b16 v[196:197], v6 offset:4096
    ds_read_b64_tr_b16 v[198:199], v6 offset:4608
    ds_read_b128 v[200:203], v12 offset:36864
    v_mfma_f32_32x32x16_bf16 v[64:79], v[220:223], v[204:207], v[64:79]
    v_and_b32 v15, 31, v1
    v_lshlrev_b32 v15, 4, v15
    v_lshrrev_b32 v60, 5, v1
    v_lshlrev_b32 v61, 11, v60
    v_add_u32 v15, v15, v61
    v_mfma_f32_32x32x16_bf16 v[80:95], v[220:223], v[208:211], v[80:95]
    v_mfma_f32_32x32x16_bf16 v[96:111], v[224:227], v[204:207], v[96:111]
    s_lshl_b32 s12, s54, 2
    s_add_u32 s12, s12, s52
    s_add_u32 s12, s12, 2
    s_lshl_b32 s12, s12, 1
    s_add_u32 s12, s12, s51
    s_lshl_b32 s12, s12, 12
    s_add_u32 s12, s12, 0x910000
    v_mfma_f32_32x32x16_bf16 v[112:127], v[224:227], v[208:211], v[112:127]
    v_mfma_f32_16x16x32_bf16 v[128:131], v[236:239], v[244:247], v[128:131]
    v_and_b32 v61, 31, v1
    v_lshlrev_b32 v61, 5, v61
    v_lshlrev_b32 v60, 4, v60
    v_add_u32 v60, v60, v61
    v_mfma_f32_32x32x16_bf16 v[64:79], v[228:231], v[212:215], v[64:79]
    v_mfma_f32_32x32x16_bf16 v[80:95], v[228:231], v[216:219], v[80:95]
    s_lshl_b32 s14, s48, 11
    s_lshl_b32 s13, s51, 10
    s_add_u32 s14, s14, s13
    s_add_u32 s14, s14, 0x900000
    v_mfma_f32_32x32x16_bf16 v[96:111], v[232:235], v[212:215], v[96:111]
    v_mfma_f32_16x16x32_bf16 v[132:135], v[240:243], v[244:247], v[132:135]
    v_mfma_f32_32x32x16_bf16 v[112:127], v[232:235], v[216:219], v[112:127]
    s_waitcnt vmcnt(17) lgkmcnt(0)
    s_barrier
    s_add_u32 m0, s57, 0
    s_add_u32 s64, s76, 688128
    buffer_load_dwordx4 v16, s[20:23], s64 offen lds
    ds_read_b128 v[204:207], v10 offset:36864
    ds_read_b128 v[208:211], v10 offset:40960
    s_add_u32 m0, s57, 4096
    s_add_u32 s64, s76, 689152
    buffer_load_dwordx4 v16, s[20:23], s64 offen lds
    ds_read_b64_tr_b16 v[220:221], v2 offset:20608
    ds_read_b64_tr_b16 v[222:223], v2 offset:21120
    s_add_u32 m0, s57, 8192
    s_add_u32 s64, s76, 690176
    buffer_load_dwordx4 v16, s[20:23], s64 offen lds
    ds_read_b64_tr_b16 v[224:225], v4 offset:20608
    ds_read_b64_tr_b16 v[226:227], v4 offset:21120
    s_add_u32 m0, s57, 12288
    s_add_u32 s65, s78, 802816
    buffer_load_dwordx4 v17, s[24:27], s65 offen lds
    ds_read_b128 v[212:215], v11 offset:36864
    ds_read_b128 v[216:219], v11 offset:40960
    s_add_u32 m0, s57, 16384
    s_nop 0
    buffer_load_dwordx4 v18, s[28:31], s65 offen lds
    ds_read_b64_tr_b16 v[228:229], v2 offset:22656
    ds_read_b64_tr_b16 v[230:231], v2 offset:23168
    ds_read_b64_tr_b16 v[232:233], v4 offset:22656
    ds_read_b64_tr_b16 v[234:235], v4 offset:23168
    ds_read_b64_tr_b16 v[236:237], v6 offset:20608
    ds_read_b64_tr_b16 v[238:239], v6 offset:21120
    ds_read_b64_tr_b16 v[240:241], v6 offset:24704
    ds_read_b64_tr_b16 v[242:243], v6 offset:25216
    ds_read_b128 v[244:247], v13 offset:36864
    v_mfma_f32_32x32x16_bf16 v[64:79], v[176:179], v[160:163], v[64:79]
    v_mfma_f32_32x32x16_bf16 v[80:95], v[176:179], v[164:167], v[80:95]
    v_mfma_f32_32x32x16_bf16 v[96:111], v[180:183], v[160:163], v[96:111]
    v_mfma_f32_32x32x16_bf16 v[112:127], v[180:183], v[164:167], v[112:127]
    v_mfma_f32_16x16x32_bf16 v[128:131], v[192:195], v[200:203], v[128:131]
    v_mfma_f32_32x32x16_bf16 v[64:79], v[184:187], v[168:171], v[64:79]
    v_mfma_f32_32x32x16_bf16 v[80:95], v[184:187], v[172:175], v[80:95]
    v_mfma_f32_32x32x16_bf16 v[96:111], v[188:191], v[168:171], v[96:111]
    v_mfma_f32_16x16x32_bf16 v[132:135], v[196:199], v[200:203], v[132:135]
    v_mfma_f32_32x32x16_bf16 v[112:127], v[188:191], v[172:175], v[112:127]
    s_waitcnt vmcnt(16) lgkmcnt(0)
    s_barrier
    buffer_load_dwordx4 v[24:27], v15, s[32:35], s12 offen offset:0 sc1
    ds_read_b128 v[160:163], v8 offset:0
    ds_read_b128 v[164:167], v8 offset:4096
    buffer_load_dwordx4 v[28:31], v15, s[32:35], s12 offen offset:512 sc1
    ds_read_b64_tr_b16 v[176:177], v2 offset:41216
    ds_read_b64_tr_b16 v[178:179], v2 offset:41728
    buffer_load_dwordx4 v[32:35], v15, s[32:35], s12 offen offset:1024 sc1
    ds_read_b64_tr_b16 v[180:181], v4 offset:41216
    ds_read_b64_tr_b16 v[182:183], v4 offset:41728
    buffer_load_dwordx4 v[36:39], v15, s[32:35], s12 offen offset:1536 sc1
    ds_read_b128 v[168:171], v9 offset:0
    ds_read_b128 v[172:175], v9 offset:4096
    buffer_load_dwordx4 v[56:59], v60, s[32:35], s14 offen sc1
    ds_read_b64_tr_b16 v[184:185], v2 offset:43264
    ds_read_b64_tr_b16 v[186:187], v2 offset:43776
    ds_read_b64_tr_b16 v[188:189], v4 offset:43264
    ds_read_b64_tr_b16 v[190:191], v4 offset:43776
    ds_read_b64_tr_b16 v[192:193], v6 offset:41216
    ds_read_b64_tr_b16 v[194:195], v6 offset:41728
    ds_read_b64_tr_b16 v[196:197], v6 offset:45312
    ds_read_b64_tr_b16 v[198:199], v6 offset:45824
    ds_read_b128 v[200:203], v12 offset:0
    v_mfma_f32_32x32x16_bf16 v[64:79], v[220:223], v[204:207], v[64:79]
    v_mfma_f32_32x32x16_bf16 v[80:95], v[220:223], v[208:211], v[80:95]
    v_mfma_f32_32x32x16_bf16 v[96:111], v[224:227], v[204:207], v[96:111]
    v_mfma_f32_32x32x16_bf16 v[112:127], v[224:227], v[208:211], v[112:127]
    v_mfma_f32_16x16x32_bf16 v[128:131], v[236:239], v[244:247], v[128:131]
    v_mfma_f32_32x32x16_bf16 v[64:79], v[228:231], v[212:215], v[64:79]
    v_mfma_f32_32x32x16_bf16 v[80:95], v[228:231], v[216:219], v[80:95]
    v_mfma_f32_32x32x16_bf16 v[96:111], v[232:235], v[212:215], v[96:111]
    v_mfma_f32_16x16x32_bf16 v[132:135], v[240:243], v[244:247], v[132:135]
    v_mfma_f32_32x32x16_bf16 v[112:127], v[232:235], v[216:219], v[112:127]
    s_waitcnt vmcnt(16) lgkmcnt(0)
    s_barrier
    s_add_u32 m0, s74, 20608
    s_add_u32 s64, s71, 0
    buffer_load_dwordx4 v14, s[40:43], s64 offen lds
    ds_read_b128 v[204:207], v10 offset:0
    ds_read_b128 v[208:211], v10 offset:4096
    s_add_u32 m0, s74, 21632
    s_add_u32 s64, s71, 4096
    buffer_load_dwordx4 v14, s[40:43], s64 offen lds
    ds_read_b64_tr_b16 v[220:221], v3 offset:0
    ds_read_b64_tr_b16 v[222:223], v3 offset:512
    s_add_u32 m0, s74, 139904
    s_add_u32 s64, s71, 16384
    buffer_load_dwordx4 v14, s[40:43], s64 offen lds
    ds_read_b64_tr_b16 v[224:225], v5 offset:0
    ds_read_b64_tr_b16 v[226:227], v5 offset:512
    s_add_u32 m0, s74, 140928
    s_add_u32 s64, s71, 20480
    buffer_load_dwordx4 v14, s[40:43], s64 offen lds
    ds_read_b128 v[212:215], v11 offset:0
    ds_read_b128 v[216:219], v11 offset:4096
    s_add_u32 m0, s74, 36992
    s_add_u32 s64, s71, 32768
    buffer_load_dwordx4 v14, s[40:43], s64 offen lds
    ds_read_b64_tr_b16 v[228:229], v3 offset:2048
    ds_read_b64_tr_b16 v[230:231], v3 offset:2560
    s_add_u32 m0, s74, 38016
    s_add_u32 s64, s71, 36864
    buffer_load_dwordx4 v14, s[40:43], s64 offen lds
    ds_read_b64_tr_b16 v[232:233], v5 offset:2048
    ds_read_b64_tr_b16 v[234:235], v5 offset:2560
    ds_read_b64_tr_b16 v[236:237], v7 offset:0
    ds_read_b64_tr_b16 v[238:239], v7 offset:512
    ds_read_b64_tr_b16 v[240:241], v7 offset:4096
    ds_read_b64_tr_b16 v[242:243], v7 offset:4608
    ds_read_b128 v[244:247], v13 offset:0
    v_mfma_f32_32x32x16_bf16 v[64:79], v[176:179], v[160:163], v[64:79]
    v_mfma_f32_32x32x16_bf16 v[80:95], v[176:179], v[164:167], v[80:95]
    v_mfma_f32_32x32x16_bf16 v[96:111], v[180:183], v[160:163], v[96:111]
    v_mfma_f32_32x32x16_bf16 v[112:127], v[180:183], v[164:167], v[112:127]
    v_mfma_f32_16x16x32_bf16 v[128:131], v[192:195], v[200:203], v[128:131]
    v_mfma_f32_32x32x16_bf16 v[64:79], v[184:187], v[168:171], v[64:79]
    v_mfma_f32_32x32x16_bf16 v[80:95], v[184:187], v[172:175], v[80:95]
    v_mfma_f32_32x32x16_bf16 v[96:111], v[188:191], v[168:171], v[96:111]
    v_mfma_f32_16x16x32_bf16 v[132:135], v[196:199], v[200:203], v[132:135]
    v_mfma_f32_32x32x16_bf16 v[112:127], v[188:191], v[172:175], v[112:127]
    s_waitcnt vmcnt(16) lgkmcnt(0)
    s_barrier
    s_add_u32 m0, s74, 53376
    s_add_u32 s64, s71, 49152
    buffer_load_dwordx4 v14, s[40:43], s64 offen lds
    ds_read_b128 v[160:163], v8 offset:18432
    ds_read_b128 v[164:167], v8 offset:22528
    s_add_u32 m0, s74, 54400
    s_add_u32 s64, s71, 53248
    buffer_load_dwordx4 v14, s[40:43], s64 offen lds
    ds_read_b64_tr_b16 v[176:177], v3 offset:20608
    ds_read_b64_tr_b16 v[178:179], v3 offset:21120
    ds_read_b64_tr_b16 v[180:181], v5 offset:20608
    ds_read_b64_tr_b16 v[182:183], v5 offset:21120
    ds_read_b128 v[168:171], v9 offset:18432
    ds_read_b128 v[172:175], v9 offset:22528
    ds_read_b64_tr_b16 v[184:185], v3 offset:22656
    ds_read_b64_tr_b16 v[186:187], v3 offset:23168
    ds_read_b64_tr_b16 v[188:189], v5 offset:22656
    ds_read_b64_tr_b16 v[190:191], v5 offset:23168
    ds_read_b64_tr_b16 v[192:193], v7 offset:20608
    ds_read_b64_tr_b16 v[194:195], v7 offset:21120
    ds_read_b64_tr_b16 v[196:197], v7 offset:24704
    ds_read_b64_tr_b16 v[198:199], v7 offset:25216
    ds_read_b128 v[200:203], v12 offset:18432
    v_mfma_f32_32x32x16_bf16 v[64:79], v[220:223], v[204:207], v[64:79]
    s_waitcnt vmcnt(8)
    v_cmp_ne_u32 s[10:11], s56, v27
    v_cmp_ne_u32 vcc, s56, v31
    s_or_b64 s[10:11], s[10:11], vcc
    v_cmp_ne_u32 vcc, s56, v35
    s_or_b64 s[10:11], s[10:11], vcc
    v_cmp_ne_u32 vcc, s56, v39
    s_or_b64 s[10:11], s[10:11], vcc
    v_cmp_ne_u32 vcc, s55, v59
    s_or_b64 s[10:11], s[10:11], vcc
    s_cmp_lg_u64 s[10:11], 0
    s_cbranch_scc1 RattB_retry
RattB_recok:
    v_mfma_f32_32x32x16_bf16 v[80:95], v[220:223], v[208:211], v[80:95]
    v_add_f32 v24, v24, v28
    v_add_f32 v32, v32, v36
    v_add_f32 v25, v25, v29
    v_add_f32 v33, v33, v37
    v_mfma_f32_32x32x16_bf16 v[96:111], v[224:227], v[204:207], v[96:111]
    v_add_f32 v24, v24, v32
    v_add_f32 v25, v25, v33
    v_mfma_f32_32x32x16_bf16 v[112:127], v[224:227], v[208:211], v[112:127]
    v_mov_b32 v28, v24
    v_mov_b32 v29, v25
    s_add_u32 s66, s52, 2
    s_lshl_b32 s66, s66, 10
    s_lshl_b32 s67, s51, 9
    s_add_u32 s67, s67, s66
    s_add_u32 s67, s67, 158592
    v_mfma_f32_16x16x32_bf16 v[128:131], v[236:239], v[244:247], v[128:131]
    v_permlane32_swap_b32 v24, v28
    v_permlane32_swap_b32 v25, v29
    v_and_b32 v40, 31, v1
    v_lshlrev_b32 v40, 4, v40
    v_mfma_f32_32x32x16_bf16 v[64:79], v[228:231], v[212:215], v[64:79]
    v_add_f32 v24, v24, v28
    v_add_f32 v25, v25, v29
    v_add_u32 v41, s67, v40
    v_mfma_f32_32x32x16_bf16 v[80:95], v[228:231], v[216:219], v[80:95]
    ds_write_b128 v41, v[24:27]
    v_lshrrev_b32 v42, 5, v1
    v_lshlrev_b32 v42, 9, v42
    v_add_u32 v42, v42, v40
    s_add_u32 s66, s66, 158592
    v_add_u32 v42, s66, v42
    v_mfma_f32_32x32x16_bf16 v[96:111], v[232:235], v[212:215], v[96:111]
    v_mov_b32 v28, v56
    v_mov_b32 v29, v57
    v_mov_b32 v30, v56
    v_mov_b32 v31, v57
    v_mfma_f32_16x16x32_bf16 v[132:135], v[240:243], v[244:247], v[132:135]
    v_permlane32_swap_b32 v28, v30
    v_permlane32_swap_b32 v29, v31
    v_mfma_f32_32x32x16_bf16 v[112:127], v[232:235], v[216:219], v[112:127]
    s_waitcnt lgkmcnt(0)
    s_barrier
    ds_read_b128 v[24:27], v42
    v_and_b32 v40, 15, v1
    v_lshlrev_b32 v40, 4, v40
    v_bfe_u32 v41, v1, 4, 1
    v_lshlrev_b32 v41, 9, v41
    v_add_u32 v40, v40, v41
    s_lshr_b32 s66, s53, 1
    s_lshl_b32 s66, s66, 10
    s_and_b32 s67, s53, 1
    s_lshl_b32 s67, s67, 8
    s_add_u32 s66, s66, s67
    s_add_u32 s66, s66, 158592
    v_add_u32 v40, s66, v40
    ds_read_b128 v[48:51], v40
    v_and_b32 v41, 15, v1
    v_lshlrev_b32 v41, 3, v41
    v_add_u32 v41, 158400, v41
    ds_read_b64 v[34:35], v41
    s_add_u32 m0, s74, 69760
    s_add_u32 s64, s71, 65536
    buffer_load_dwordx4 v14, s[40:43], s64 offen lds
    ds_read_b128 v[204:207], v10 offset:18432
    ds_read_b128 v[208:211], v10 offset:22528
    s_add_u32 m0, s74, 70784
    s_add_u32 s64, s71, 69632
    buffer_load_dwordx4 v14, s[40:43], s64 offen lds
    ds_read_b64_tr_b16 v[220:221], v2 offset:0
    ds_read_b64_tr_b16 v[222:223], v2 offset:512
    s_add_u32 m0, s74, 86144
    s_add_u32 s64, s71, 81920
    buffer_load_dwordx4 v14, s[40:43], s64 offen lds
    ds_read_b64_tr_b16 v[224:225], v4 offset:0
    ds_read_b64_tr_b16 v[226:227], v4 offset:512
    s_add_u32 m0, s74, 87168
    s_add_u32 s64, s71, 86016
    buffer_load_dwordx4 v14, s[40:43], s64 offen lds
    ds_read_b128 v[212:215], v11 offset:18432
    ds_read_b128 v[216:219], v11 offset:22528
    ds_read_b64_tr_b16 v[228:229], v2 offset:2048
    ds_read_b64_tr_b16 v[230:231], v2 offset:2560
    ds_read_b64_tr_b16 v[232:233], v4 offset:2048
    ds_read_b64_tr_b16 v[234:235], v4 offset:2560
    ds_read_b64_tr_b16 v[236:237], v6 offset:0
    ds_read_b64_tr_b16 v[238:239], v6 offset:512
    ds_read_b64_tr_b16 v[240:241], v6 offset:4096
    ds_read_b64_tr_b16 v[242:243], v6 offset:4608
    ds_read_b128 v[244:247], v13 offset:18432
    v_mfma_f32_32x32x16_bf16 v[64:79], v[176:179], v[160:163], v[64:79]
    v_mfma_f32_32x32x16_bf16 v[80:95], v[176:179], v[164:167], v[80:95]
    v_mfma_f32_32x32x16_bf16 v[96:111], v[180:183], v[160:163], v[96:111]
    v_mfma_f32_32x32x16_bf16 v[112:127], v[180:183], v[164:167], v[112:127]
    v_mfma_f32_16x16x32_bf16 v[128:131], v[192:195], v[200:203], v[128:131]
    v_mfma_f32_32x32x16_bf16 v[64:79], v[184:187], v[168:171], v[64:79]
    v_mfma_f32_32x32x16_bf16 v[80:95], v[184:187], v[172:175], v[80:95]
    v_mfma_f32_32x32x16_bf16 v[96:111], v[188:191], v[168:171], v[96:111]
    v_mfma_f32_16x16x32_bf16 v[132:135], v[196:199], v[200:203], v[132:135]
    v_mfma_f32_32x32x16_bf16 v[112:127], v[188:191], v[172:175], v[112:127]
    s_waitcnt lgkmcnt(0)
    s_barrier
    v_mfma_f32_32x32x16_bf16 v[64:79], v[220:223], v[204:207], v[64:79]
    v_sub_f32 v41, 0, v28
    v_cvt_pk_bf16_f32 v40, v41, v41
    v_and_b32 v40, 0xffff0000, v40
    v_sub_f32 v40, v41, v40
    v_cvt_pk_bf16_f32 v160, v41, v40
    v_mov_b32 v161, v160
    v_mov_b32 v162, 0
    v_mov_b32 v163, 0
    v_mfma_f32_32x32x16_bf16 v[80:95], v[220:223], v[208:211], v[80:95]
    v_sub_f32 v41, 0, v30
    v_cvt_pk_bf16_f32 v40, v41, v41
    v_and_b32 v40, 0xffff0000, v40
    v_sub_f32 v40, v41, v40
    v_cvt_pk_bf16_f32 v164, v41, v40
    v_mov_b32 v165, v164
    v_mov_b32 v166, 0
    v_mov_b32 v167, 0
    v_mfma_f32_32x32x16_bf16 v[96:111], v[224:227], v[204:207], v[96:111]
    v_cvt_pk_bf16_f32 v176, v24, v24
    v_and_b32 v40, 0xffff0000, v176
    v_sub_f32 v40, v24, v40
    v_cvt_pk_bf16_f32 v177, v40, v40
    v_mov_b32 v178, 0
    v_mov_b32 v179, 0
    v_mfma_f32_32x32x16_bf16 v[112:127], v[224:227], v[208:211], v[112:127]
    v_cvt_pk_bf16_f32 v180, v25, v25
    v_and_b32 v40, 0xffff0000, v180
    v_sub_f32 v40, v25, v40
    v_cvt_pk_bf16_f32 v181, v40, v40
    v_mov_b32 v182, 0
    v_mov_b32 v183, 0
    v_mfma_f32_16x16x32_bf16 v[128:131], v[236:239], v[244:247], v[128:131]
    v_mul_f32 v32, 0.5, v49
    v_mul_f32 v33, 0.5, v50
    v_mfma_f32_32x32x16_bf16 v[64:79], v[228:231], v[212:215], v[64:79]
    v_sub_f32 v41, 0, v34
    v_cvt_pk_bf16_f32 v40, v41, v41
    v_and_b32 v40, 0xffff0000, v40
    v_sub_f32 v40, v41, v40
    v_cvt_pk_bf16_f32 v200, v41, v40
    v_mov_b32 v201, v200
    v_mov_b32 v202, 0
    v_mov_b32 v203, 0
    v_mfma_f32_32x32x16_bf16 v[80:95], v[228:231], v[216:219], v[80:95]
    v_cvt_pk_bf16_f32 v192, v32, v32
    v_and_b32 v40, 0xffff0000, v192
    v_sub_f32 v40, v32, v40
    v_cvt_pk_bf16_f32 v193, v40, v40
    v_mov_b32 v194, 0
    v_mov_b32 v195, 0
    v_mfma_f32_32x32x16_bf16 v[96:111], v[232:235], v[212:215], v[96:111]
    v_cvt_pk_bf16_f32 v196, v33, v33
    v_and_b32 v40, 0xffff0000, v196
    v_sub_f32 v40, v33, v40
    v_cvt_pk_bf16_f32 v197, v40, v40
    v_mov_b32 v198, 0
    v_mov_b32 v199, 0
    v_mfma_f32_16x16x32_bf16 v[132:135], v[240:243], v[244:247], v[132:135]
    v_mfma_f32_32x32x16_bf16 v[112:127], v[232:235], v[216:219], v[112:127]
    v_mfma_f32_32x32x16_bf16 v[64:79], v[176:179], v[160:163], v[64:79]
    v_mfma_f32_32x32x16_bf16 v[80:95], v[176:179], v[164:167], v[80:95]
    v_mfma_f32_32x32x16_bf16 v[96:111], v[180:183], v[160:163], v[96:111]
    v_mfma_f32_32x32x16_bf16 v[112:127], v[180:183], v[164:167], v[112:127]
    v_mfma_f32_16x16x32_bf16 v[128:131], v[192:195], v[200:203], v[128:131]
    v_mfma_f32_16x16x32_bf16 v[132:135], v[196:199], v[200:203], v[132:135]
    v_lshrrev_b32 v16, 4, v1
    v_bfe_u32 v17, v1, 2, 2
    v_and_b32 v18, 3, v1
    v_lshrrev_b32 v5, 1, v16
    v_lshlrev_b32 v5, 3, v5
    v_add_u32 v5, v5, v17
    v_lshlrev_b32 v5, 7, v5
    v_lshrrev_b32 v17, 1, v17
    v_lshlrev_b32 v17, 6, v17
    v_add_u32 v5, v5, v17
    v_and_b32 v16, 1, v16
    v_lshlrev_b32 v16, 5, v16
    v_add_u32 v5, v5, v16
    v_lshlrev_b32 v18, 3, v18
    v_add_u32 v5, v5, v18
    v_add_u32 v2, s74, v5
    v_lshlrev_b32 v3, 4, v1
    s_lshl_b32 s64, s53, 17
    s_lshl_b32 s65, s70, 7
    s_add_u32 s75, s64, s65
    s_lshl_b32 s64, s53, 13
    s_add_u32 s76, s72, s64
    s_mul_i32 s64, s53, 20480
    s_add_u32 s72, s72, s64
    s_add_u32 s72, s72, 65536
    s_lshl_b32 s77, s69, 10
    s_add_u32 s77, s77, 0x990000
    s_lshl_b32 s64, s53, 8
    s_add_u32 s77, s77, s64
    v_and_b32 v12, 7, v1
    v_lshlrev_b32 v12, 2, v12
    v_bfe_u32 v13, v1, 3, 1
    v_lshlrev_b32 v13, 7, v13
    v_add_u32 v12, v12, v13
    s_lshl_b32 s65, s48, 2
    s_lshl_b32 s66, s51, 1
    s_add_u32 s65, s65, s66
    s_mul_i32 s65, s65, 147456
    s_lshl_b32 s66, s49, 2
    s_lshl_b32 s67, s52, 1
    s_add_u32 s66, s66, s67
    s_add_u32 s66, s66, 32
    s_lshl_b32 s66, s66, 10
    s_add_u32 s67, s65, s66
    v_mul_f32 v128, v128, v35
    v_mul_f32 v129, v129, v35
    v_mul_f32 v130, v130, v35
    v_mul_f32 v131, v131, v35
    v_cvt_pk_bf16_f32 v128, v128, v129
    v_cvt_pk_bf16_f32 v129, v130, v131
    v_mul_f32 v132, v132, v35
    v_mul_f32 v133, v133, v35
    v_mul_f32 v134, v134, v35
    v_mul_f32 v135, v135, v35
    v_cvt_pk_bf16_f32 v132, v132, v133
    v_cvt_pk_bf16_f32 v133, v134, v135
    v_bfe_u32 v46, v1, 3, 1
    v_and_b32 v47, 7, v1
    v_lshrrev_b32 v48, 4, v1
    s_lshr_b32 s64, s53, 1
    s_lshl_b32 s64, s64, 3
    s_and_b32 s66, s53, 1
    s_lshl_b32 s66, s66, 1
    s_add_u32 s64, s64, s66
    v_lshlrev_b32 v49, 2, v46
    v_and_b32 v50, 1, v48
    v_add_u32 v49, v49, v50
    v_add_u32 v49, s64, v49
    v_mul_u32_u24 v49, 1152, v49
    v_lshlrev_b32 v50, 4, v47
    v_add_u32 v49, v49, v50
    v_lshrrev_b32 v50, 1, v48
    v_lshlrev_b32 v50, 3, v50
    v_add_u32 v49, v49, v50
    ds_write_b64 v49, v[128:129] offset:0
    s_lshl_b32 s64, s64, 1
    v_lshlrev_b32 v49, 3, v46
    v_add_u32 v49, v49, v48
    v_add_u32 v49, s64, v49
    v_mul_u32_u24 v49, 576, v49
    v_lshlrev_b32 v50, 3, v47
    v_add_u32 v49, v49, v50
    v_add_u32 v49, 121472, v49
    ds_write_b64 v49, v[132:133]
    s_waitcnt vmcnt(0)
    v_add_u32 v6, 20608, v2
    v_xor_b32 v7, 64, v6
    ds_read_b64_tr_b16 v[160:161], v6 offset:0
    ds_read_b64_tr_b16 v[162:163], v6 offset:512
    ds_read_b64_tr_b16 v[164:165], v7 offset:0
    ds_read_b64_tr_b16 v[166:167], v7 offset:512
    v_add_u32 v6, 139904, v2
    v_xor_b32 v7, 64, v6
    ds_read_b64_tr_b16 v[168:169], v6 offset:0
    ds_read_b64_tr_b16 v[170:171], v6 offset:512
    ds_read_b64_tr_b16 v[172:173], v7 offset:0
    ds_read_b64_tr_b16 v[174:175], v7 offset:512
    v_add_u32 v6, 36992, v2
    v_xor_b32 v7, 64, v6
    ds_read_b64_tr_b16 v[176:177], v6 offset:0
    ds_read_b64_tr_b16 v[178:179], v6 offset:512
    ds_read_b64_tr_b16 v[180:181], v7 offset:0
    ds_read_b64_tr_b16 v[182:183], v7 offset:512
    v_add_u32 v6, 53376, v2
    v_xor_b32 v7, 64, v6
    ds_read_b64_tr_b16 v[184:185], v6 offset:0
    ds_read_b64_tr_b16 v[186:187], v6 offset:512
    ds_read_b64_tr_b16 v[188:189], v7 offset:0
    ds_read_b64_tr_b16 v[190:191], v7 offset:512
    v_add_u32 v6, 69760, v2
    v_xor_b32 v7, 64, v6
    ds_read_b64_tr_b16 v[192:193], v6 offset:0
    ds_read_b64_tr_b16 v[194:195], v6 offset:512
    ds_read_b64_tr_b16 v[196:197], v7 offset:0
    ds_read_b64_tr_b16 v[198:199], v7 offset:512
    v_add_u32 v6, 86144, v2
    v_xor_b32 v7, 64, v6
    ds_read_b64_tr_b16 v[200:201], v6 offset:0
    ds_read_b64_tr_b16 v[202:203], v6 offset:512
    ds_read_b64_tr_b16 v[204:205], v7 offset:0
    ds_read_b64_tr_b16 v[206:207], v7 offset:512
    s_waitcnt lgkmcnt(0)
    s_barrier
    s_setprio 2
    v_mul_f32 v40, v29, v29
    v_mul_f32 v42, v31, v31
    v_lshlrev_b32 v44, 4, v1
    v_pk_mul_f32 v[64:65], v[64:65], v[72:73]
    v_pk_mul_f32 v[66:67], v[66:67], v[74:75]
    v_pk_mul_f32 v[68:69], v[68:69], v[76:77]
    v_pk_mul_f32 v[70:71], v[70:71], v[78:79]
    v_pk_mul_f32 v[64:65], v[64:65], v[40:41] op_sel_hi:[1,0]
    v_pk_mul_f32 v[66:67], v[66:67], v[40:41] op_sel_hi:[1,0]
    v_pk_mul_f32 v[68:69], v[68:69], v[40:41] op_sel_hi:[1,0]
    v_pk_mul_f32 v[70:71], v[70:71], v[40:41] op_sel_hi:[1,0]
    v_cvt_pk_bf16_f32 v72, v64, v65
    v_cvt_pk_bf16_f32 v73, v66, v67
    v_cvt_pk_bf16_f32 v74, v68, v69
    v_cvt_pk_bf16_f32 v75, v70, v71
    s_add_u32 s64, s67, 0
    buffer_store_dwordx4 v[72:75], v44, s[32:35], s64 offen sc1
    v_pk_mul_f32 v[80:81], v[80:81], v[88:89]
    v_pk_mul_f32 v[82:83], v[82:83], v[90:91]
    v_pk_mul_f32 v[84:85], v[84:85], v[92:93]
    v_pk_mul_f32 v[86:87], v[86:87], v[94:95]
    v_pk_mul_f32 v[80:81], v[80:81], v[42:43] op_sel_hi:[1,0]
    v_pk_mul_f32 v[82:83], v[82:83], v[42:43] op_sel_hi:[1,0]
    v_pk_mul_f32 v[84:85], v[84:85], v[42:43] op_sel_hi:[1,0]
    v_pk_mul_f32 v[86:87], v[86:87], v[42:43] op_sel_hi:[1,0]
    v_cvt_pk_bf16_f32 v88, v80, v81
    v_cvt_pk_bf16_f32 v89, v82, v83
    v_cvt_pk_bf16_f32 v90, v84, v85
    v_cvt_pk_bf16_f32 v91, v86, v87
    s_add_u32 s64, s67, 147456
    buffer_store_dwordx4 v[88:91], v44, s[32:35], s64 offen sc1
    v_pk_mul_f32 v[96:97], v[96:97], v[104:105]
    v_pk_mul_f32 v[98:99], v[98:99], v[106:107]
    v_pk_mul_f32 v[100:101], v[100:101], v[108:109]
    v_pk_mul_f32 v[102:103], v[102:103], v[110:111]
    v_pk_mul_f32 v[96:97], v[96:97], v[40:41] op_sel_hi:[1,0]
    v_pk_mul_f32 v[98:99], v[98:99], v[40:41] op_sel_hi:[1,0]
    v_pk_mul_f32 v[100:101], v[100:101], v[40:41] op_sel_hi:[1,0]
    v_pk_mul_f32 v[102:103], v[102:103], v[40:41] op_sel_hi:[1,0]
    v_cvt_pk_bf16_f32 v104, v96, v97
    v_cvt_pk_bf16_f32 v105, v98, v99
    v_cvt_pk_bf16_f32 v106, v100, v101
    v_cvt_pk_bf16_f32 v107, v102, v103
    s_add_u32 s64, s67, 1024
    buffer_store_dwordx4 v[104:107], v44, s[32:35], s64 offen sc1
    v_pk_mul_f32 v[112:113], v[112:113], v[120:121]
    v_pk_mul_f32 v[114:115], v[114:115], v[122:123]
    v_pk_mul_f32 v[116:117], v[116:117], v[124:125]
    v_pk_mul_f32 v[118:119], v[118:119], v[126:127]
    v_pk_mul_f32 v[112:113], v[112:113], v[42:43] op_sel_hi:[1,0]
    v_pk_mul_f32 v[114:115], v[114:115], v[42:43] op_sel_hi:[1,0]
    v_pk_mul_f32 v[116:117], v[116:117], v[42:43] op_sel_hi:[1,0]
    v_pk_mul_f32 v[118:119], v[118:119], v[42:43] op_sel_hi:[1,0]
    v_cvt_pk_bf16_f32 v120, v112, v113
    v_cvt_pk_bf16_f32 v121, v114, v115
    v_cvt_pk_bf16_f32 v122, v116, v117
    v_cvt_pk_bf16_f32 v123, v118, v119
    s_add_u32 s64, s67, 148480
    buffer_store_dwordx4 v[120:123], v44, s[32:35], s64 offen sc1
    s_add_u32 m0, s74, 20608
    s_add_u32 s64, s71, 98304
    buffer_load_dwordx4 v14, s[40:43], s64 offen lds
    s_add_u32 m0, s74, 21632
    s_add_u32 s64, s71, 102400
    buffer_load_dwordx4 v14, s[40:43], s64 offen lds
    s_add_u32 m0, s74, 139904
    s_add_u32 s64, s71, 114688
    buffer_load_dwordx4 v14, s[40:43], s64 offen lds
    s_add_u32 m0, s74, 140928
    s_add_u32 s64, s71, 118784
    buffer_load_dwordx4 v14, s[40:43], s64 offen lds
    s_add_u32 m0, s74, 36992
    s_add_u32 s64, s71, 131072
    buffer_load_dwordx4 v14, s[40:43], s64 offen lds
    s_add_u32 m0, s74, 38016
    s_add_u32 s64, s71, 135168
    buffer_load_dwordx4 v14, s[40:43], s64 offen lds
    s_add_u32 m0, s74, 53376
    s_add_u32 s64, s71, 147456
    buffer_load_dwordx4 v14, s[40:43], s64 offen lds
    s_add_u32 m0, s74, 54400
    s_add_u32 s64, s71, 151552
    buffer_load_dwordx4 v14, s[40:43], s64 offen lds
    s_add_u32 m0, s74, 69760
    s_add_u32 s64, s71, 163840
    buffer_load_dwordx4 v14, s[40:43], s64 offen lds
    s_add_u32 m0, s74, 70784
    s_add_u32 s64, s71, 167936
    buffer_load_dwordx4 v14, s[40:43], s64 offen lds
    s_add_u32 m0, s74, 86144
    s_add_u32 s64, s71, 180224
    buffer_load_dwordx4 v14, s[40:43], s64 offen lds
    s_add_u32 m0, s74, 87168
    s_add_u32 s64, s71, 184320
    buffer_load_dwordx4 v14, s[40:43], s64 offen lds
    v_and_b32 v4, 31, v1
    v_lshlrev_b32 v4, 11, v4
    v_lshrrev_b32 v5, 5, v1
    v_lshlrev_b32 v5, 4, v5
    v_add_u32 v4, v4, v5
    s_lshl_b32 s73, s69, 16
    s_and_b32 s64, s50, 1
    s_lshl_b32 s64, s64, 10
    s_add_u32 s73, s73, s64
    s_lshl_b32 s64, s70, 7
    s_add_u32 s73, s73, s64
    s_lshr_b32 s64, s50, 1
    s_lshl_b32 s64, s64, 5
    s_add_u32 s73, s73, s64
    buffer_load_dwordx4 v[8:11], v4, s[16:19], s73 offen
    s_waitcnt vmcnt(13)
    s_lshl_b32 s64, s48, 1
    s_add_u32 s64, s64, s51
    s_lshl_b32 s64, s64, 3
    s_add_u32 s64, s64, s49
    s_lshl_b32 s64, s64, 5
    s_add_u32 s64, s64, s52
    s_lshl_b32 s64, s64, 2
    s_add_u32 s64, s64, 0x990018
    v_mov_b32 v15, s55
    s_mov_b64 exec, 1
    buffer_store_dword v15, off, s[32:35], s64 sc1
    s_mov_b64 exec, -1
    s_setprio 0
    s_mov_b64 exec, 0xffff
    buffer_load_dword v13, v12, s[32:35], s77 offen sc1
    s_mov_b64 exec, -1
    s_waitcnt vmcnt(3)
    v_add_u32 v6, 20608, v2
    v_xor_b32 v7, 64, v6
    ds_read_b64_tr_b16 v[80:81], v6 offset:0
    ds_read_b64_tr_b16 v[82:83], v6 offset:512
    ds_read_b64_tr_b16 v[84:85], v7 offset:0
    ds_read_b64_tr_b16 v[86:87], v7 offset:512
    v_add_u32 v6, 139904, v2
    v_xor_b32 v7, 64, v6
    ds_read_b64_tr_b16 v[88:89], v6 offset:0
    ds_read_b64_tr_b16 v[90:91], v6 offset:512
    ds_read_b64_tr_b16 v[92:93], v7 offset:0
    ds_read_b64_tr_b16 v[94:95], v7 offset:512
    v_add_u32 v6, 36992, v2
    v_xor_b32 v7, 64, v6
    ds_read_b64_tr_b16 v[96:97], v6 offset:0
    ds_read_b64_tr_b16 v[98:99], v6 offset:512
    ds_read_b64_tr_b16 v[100:101], v7 offset:0
    ds_read_b64_tr_b16 v[102:103], v7 offset:512
    v_add_u32 v6, 53376, v2
    v_xor_b32 v7, 64, v6
    ds_read_b64_tr_b16 v[104:105], v6 offset:0
    ds_read_b64_tr_b16 v[106:107], v6 offset:512
    ds_read_b64_tr_b16 v[108:109], v7 offset:0
    ds_read_b64_tr_b16 v[110:111], v7 offset:512
    v_add_u32 v6, 69760, v2
    v_xor_b32 v7, 64, v6
    ds_read_b64_tr_b16 v[112:113], v6 offset:0
    ds_read_b64_tr_b16 v[114:115], v6 offset:512
    ds_read_b64_tr_b16 v[116:117], v7 offset:0
    ds_read_b64_tr_b16 v[118:119], v7 offset:512
    v_add_u32 v6, 86144, v2
    v_xor_b32 v7, 64, v6
    ds_read_b64_tr_b16 v[120:121], v6 offset:0
    ds_read_b64_tr_b16 v[122:123], v6 offset:512
    ds_read_b64_tr_b16 v[124:125], v7 offset:0
    ds_read_b64_tr_b16 v[126:127], v7 offset:512
    s_waitcnt lgkmcnt(0)
    s_add_u32 m0, s74, 20608
    s_add_u32 s64, s71, 196608
    buffer_load_dwordx4 v14, s[40:43], s64 offen lds
    s_add_u32 m0, s74, 21632
    s_add_u32 s64, s71, 200704
    buffer_load_dwordx4 v14, s[40:43], s64 offen lds
    s_add_u32 m0, s74, 139904
    s_add_u32 s64, s71, 212992
    buffer_load_dwordx4 v14, s[40:43], s64 offen lds
    s_add_u32 m0, s74, 140928
    s_add_u32 s64, s71, 217088
    buffer_load_dwordx4 v14, s[40:43], s64 offen lds
    s_add_u32 m0, s74, 36992
    s_add_u32 s64, s71, 229376
    buffer_load_dwordx4 v14, s[40:43], s64 offen lds
    s_add_u32 m0, s74, 38016
    s_add_u32 s64, s71, 233472
    buffer_load_dwordx4 v14, s[40:43], s64 offen lds
    s_add_u32 m0, s74, 53376
    s_add_u32 s64, s71, 245760
    buffer_load_dwordx4 v14, s[40:43], s64 offen lds
    s_add_u32 m0, s74, 54400
    s_add_u32 s64, s71, 249856
    buffer_load_dwordx4 v14, s[40:43], s64 offen lds
    s_add_u32 m0, s74, 69760
    s_add_u32 s64, s71, 262144
    buffer_load_dwordx4 v14, s[40:43], s64 offen lds
    s_add_u32 m0, s74, 70784
    s_add_u32 s64, s71, 266240
    buffer_load_dwordx4 v14, s[40:43], s64 offen lds
    s_add_u32 m0, s74, 86144
    s_add_u32 s64, s71, 278528
    buffer_load_dwordx4 v14, s[40:43], s64 offen lds
    s_add_u32 m0, s74, 87168
    s_add_u32 s64, s71, 282624
    buffer_load_dwordx4 v14, s[40:43], s64 offen lds
    s_waitcnt vmcnt(12)
    v_cmp_eq_u32 vcc, s55, v13
    s_and_b32 s64, vcc_lo, 0xf0f
    s_cmp_lg_u32 s64, 0xf0f
    s_cbranch_scc1 RattB_psp_54
RattB_pok_53:
    s_add_u32 s64, s72, 0
    buffer_load_dwordx4 v[144:147], v3, s[32:35], s64 offen sc1
    s_add_u32 s64, s72, 147456
    buffer_load_dwordx4 v[148:151], v3, s[32:35], s64 offen sc1
    s_add_u32 s64, s72, 1024
    buffer_load_dwordx4 v[152:155], v3, s[32:35], s64 offen sc1
    s_add_u32 s64, s72, 148480
    buffer_load_dwordx4 v[156:159], v3, s[32:35], s64 offen sc1
    s_add_u32 s64, s72, 2048
    buffer_load_dwordx4 v[208:211], v3, s[32:35], s64 offen sc1
    s_add_u32 s64, s72, 149504
    buffer_load_dwordx4 v[212:215], v3, s[32:35], s64 offen sc1
    s_add_u32 s64, s72, 3072
    buffer_load_dwordx4 v[216:219], v3, s[32:35], s64 offen sc1
    s_add_u32 s64, s72, 150528
    buffer_load_dwordx4 v[220:223], v3, s[32:35], s64 offen sc1
    s_add_u32 s64, s72, 4096
    buffer_load_dwordx4 v[224:227], v3, s[32:35], s64 offen sc1
    s_add_u32 s64, s72, 151552
    buffer_load_dwordx4 v[228:231], v3, s[32:35], s64 offen sc1
    s_add_u32 s64, s72, 5120
    buffer_load_dwordx4 v[232:235], v3, s[32:35], s64 offen sc1
    s_add_u32 s64, s72, 152576
    buffer_load_dwordx4 v[236:239], v3, s[32:35], s64 offen sc1
    s_add_u32 s64, s72, 6144
    buffer_load_dwordx4 v[240:243], v3, s[32:35], s64 offen sc1
    s_add_u32 s64, s72, 153600
    buffer_load_dwordx4 v[244:247], v3, s[32:35], s64 offen sc1
    s_add_u32 s64, s72, 7168
    buffer_load_dwordx4 v[248:251], v3, s[32:35], s64 offen sc1
    s_add_u32 s64, s72, 154624
    buffer_load_dwordx4 v[252:255], v3, s[32:35], s64 offen sc1
    s_waitcnt vmcnt(15)
    v_mfma_f32_32x32x16_bf16 v[16:31], v[160:163], v[144:147], 0
    v_mfma_f32_32x32x16_bf16 v[32:47], v[164:167], v[144:147], 0
    s_add_u32 s64, s72, 8192
    buffer_load_dwordx4 v[144:147], v3, s[32:35], s64 offen sc1
    s_waitcnt vmcnt(15)
    v_mfma_f32_32x32x16_bf16 v[48:63], v[160:163], v[148:151], 0
    v_mfma_f32_32x32x16_bf16 v[64:79], v[164:167], v[148:151], 0
    s_add_u32 s64, s72, 155648
    buffer_load_dwordx4 v[148:151], v3, s[32:35], s64 offen sc1
    s_waitcnt vmcnt(15)
    v_mfma_f32_32x32x16_bf16 v[16:31], v[168:171], v[152:155], v[16:31]
    v_mfma_f32_32x32x16_bf16 v[32:47], v[172:175], v[152:155], v[32:47]
    s_add_u32 s64, s72, 9216
    buffer_load_dwordx4 v[152:155], v3, s[32:35], s64 offen sc1
    s_waitcnt vmcnt(15)
    v_mfma_f32_32x32x16_bf16 v[48:63], v[168:171], v[156:159], v[48:63]
    v_mfma_f32_32x32x16_bf16 v[64:79], v[172:175], v[156:159], v[64:79]
    s_add_u32 s64, s72, 156672
    buffer_load_dwordx4 v[156:159], v3, s[32:35], s64 offen sc1
    s_waitcnt vmcnt(15)
    v_mfma_f32_32x32x16_bf16 v[16:31], v[176:179], v[208:211], v[16:31]
    v_mfma_f32_32x32x16_bf16 v[32:47], v[180:183], v[208:211], v[32:47]
    s_add_u32 s64, s72, 10240
    buffer_load_dwordx4 v[208:211], v3, s[32:35], s64 offen sc1
    s_waitcnt vmcnt(15)
    v_mfma_f32_32x32x16_bf16 v[48:63], v[176:179], v[212:215], v[48:63]
    v_mfma_f32_32x32x16_bf16 v[64:79], v[180:183], v[212:215], v[64:79]
    s_add_u32 s64, s72, 157696
    buffer_load_dwordx4 v[212:215], v3, s[32:35], s64 offen sc1
    s_waitcnt vmcnt(15)
    v_mfma_f32_32x32x16_bf16 v[16:31], v[184:187], v[216:219], v[16:31]
    v_mfma_f32_32x32x16_bf16 v[32:47], v[188:191], v[216:219], v[32:47]
    s_add_u32 s64, s72, 11264
    buffer_load_dwordx4 v[216:219], v3, s[32:35], s64 offen sc1
    s_waitcnt vmcnt(15)
    v_mfma_f32_32x32x16_bf16 v[48:63], v[184:187], v[220:223], v[48:63]
    v_mfma_f32_32x32x16_bf16 v[64:79], v[188:191], v[220:223], v[64:79]
    s_add_u32 s64, s72, 158720
    buffer_load_dwordx4 v[220:223], v3, s[32:35], s64 offen sc1
    s_waitcnt vmcnt(15)
    v_mfma_f32_32x32x16_bf16 v[16:31], v[192:195], v[224:227], v[16:31]
    v_mfma_f32_32x32x16_bf16 v[32:47], v[196:199], v[224:227], v[32:47]
    s_add_u32 s64, s72, 12288
    buffer_load_dwordx4 v[224:227], v3, s[32:35], s64 offen sc1
    s_waitcnt vmcnt(15)
    v_mfma_f32_32x32x16_bf16 v[48:63], v[192:195], v[228:231], v[48:63]
    v_mfma_f32_32x32x16_bf16 v[64:79], v[196:199], v[228:231], v[64:79]
    s_add_u32 s64, s72, 159744
    buffer_load_dwordx4 v[228:231], v3, s[32:35], s64 offen sc1
    s_waitcnt vmcnt(15)
    v_mfma_f32_32x32x16_bf16 v[16:31], v[200:203], v[232:235], v[16:31]
    v_mfma_f32_32x32x16_bf16 v[32:47], v[204:207], v[232:235], v[32:47]
    s_add_u32 s64, s72, 13312
    buffer_load_dwordx4 v[232:235], v3, s[32:35], s64 offen sc1
    s_waitcnt vmcnt(15)
    v_mfma_f32_32x32x16_bf16 v[48:63], v[200:203], v[236:239], v[48:63]
    v_mfma_f32_32x32x16_bf16 v[64:79], v[204:207], v[236:239], v[64:79]
    s_add_u32 s64, s72, 160768
    buffer_load_dwordx4 v[236:239], v3, s[32:35], s64 offen sc1
    s_waitcnt vmcnt(15)
    v_mfma_f32_32x32x16_bf16 v[16:31], v[80:83], v[240:243], v[16:31]
    v_mfma_f32_32x32x16_bf16 v[32:47], v[84:87], v[240:243], v[32:47]
    s_add_u32 s64, s72, 14336
    buffer_load_dwordx4 v[240:243], v3, s[32:35], s64 offen sc1
    s_waitcnt vmcnt(15)
    v_mfma_f32_32x32x16_bf16 v[48:63], v[80:83], v[244:247], v[48:63]
    v_mfma_f32_32x32x16_bf16 v[64:79], v[84:87], v[244:247], v[64:79]
    s_add_u32 s64, s72, 161792
    buffer_load_dwordx4 v[244:247], v3, s[32:35], s64 offen sc1
    s_waitcnt vmcnt(15)
    v_mfma_f32_32x32x16_bf16 v[16:31], v[88:91], v[248:251], v[16:31]
    v_mfma_f32_32x32x16_bf16 v[32:47], v[92:95], v[248:251], v[32:47]
    s_add_u32 s64, s72, 15360
    buffer_load_dwordx4 v[248:251], v3, s[32:35], s64 offen sc1
    s_waitcnt vmcnt(15)
    v_mfma_f32_32x32x16_bf16 v[48:63], v[88:91], v[252:255], v[48:63]
    v_mfma_f32_32x32x16_bf16 v[64:79], v[92:95], v[252:255], v[64:79]
    s_add_u32 s64, s72, 162816
    buffer_load_dwordx4 v[252:255], v3, s[32:35], s64 offen sc1
    s_waitcnt vmcnt(15)
    s_mov_b64 exec, 0xffff
    buffer_load_dword v13, v12, s[32:35], s77 offen sc1
    s_mov_b64 exec, -1
    v_mfma_f32_32x32x16_bf16 v[16:31], v[96:99], v[144:147], v[16:31]
    v_mfma_f32_32x32x16_bf16 v[32:47], v[100:103], v[144:147], v[32:47]
    s_add_u32 s64, s72, 16384
    buffer_load_dwordx4 v[144:147], v3, s[32:35], s64 offen sc1
    s_waitcnt vmcnt(16)
    v_mfma_f32_32x32x16_bf16 v[48:63], v[96:99], v[148:151], v[48:63]
    v_mfma_f32_32x32x16_bf16 v[64:79], v[100:103], v[148:151], v[64:79]
    s_add_u32 s64, s72, 163840
    buffer_load_dwordx4 v[148:151], v3, s[32:35], s64 offen sc1
    s_waitcnt vmcnt(16)
    v_mfma_f32_32x32x16_bf16 v[16:31], v[104:107], v[152:155], v[16:31]
    v_mfma_f32_32x32x16_bf16 v[32:47], v[108:111], v[152:155], v[32:47]
    s_add_u32 s64, s72, 17408
    buffer_load_dwordx4 v[152:155], v3, s[32:35], s64 offen sc1
    s_waitcnt vmcnt(16)
    v_mfma_f32_32x32x16_bf16 v[48:63], v[104:107], v[156:159], v[48:63]
    v_mfma_f32_32x32x16_bf16 v[64:79], v[108:111], v[156:159], v[64:79]
    s_add_u32 s64, s72, 164864
    buffer_load_dwordx4 v[156:159], v3, s[32:35], s64 offen sc1
    s_waitcnt vmcnt(16)
    v_mfma_f32_32x32x16_bf16 v[16:31], v[112:115], v[208:211], v[16:31]
    v_mfma_f32_32x32x16_bf16 v[32:47], v[116:119], v[208:211], v[32:47]
    s_add_u32 s64, s72, 18432
    buffer_load_dwordx4 v[208:211], v3, s[32:35], s64 offen sc1
    s_waitcnt vmcnt(16)
    v_mfma_f32_32x32x16_bf16 v[48:63], v[112:115], v[212:215], v[48:63]
    v_mfma_f32_32x32x16_bf16 v[64:79], v[116:119], v[212:215], v[64:79]
    s_add_u32 s64, s72, 165888
    buffer_load_dwordx4 v[212:215], v3, s[32:35], s64 offen sc1
    s_waitcnt vmcnt(16)
    v_add_u32 v6, 20608, v2
    v_xor_b32 v7, 64, v6
    ds_read_b64_tr_b16 v[128:129], v6 offset:0
    ds_read_b64_tr_b16 v[130:131], v6 offset:512
    ds_read_b64_tr_b16 v[132:133], v7 offset:0
    ds_read_b64_tr_b16 v[134:135], v7 offset:512
    v_mfma_f32_32x32x16_bf16 v[16:31], v[120:123], v[216:219], v[16:31]
    v_mfma_f32_32x32x16_bf16 v[32:47], v[124:127], v[216:219], v[32:47]
    s_add_u32 s64, s72, 19456
    buffer_load_dwordx4 v[216:219], v3, s[32:35], s64 offen sc1
    s_waitcnt vmcnt(16)
    v_mfma_f32_32x32x16_bf16 v[48:63], v[120:123], v[220:223], v[48:63]
    v_mfma_f32_32x32x16_bf16 v[64:79], v[124:127], v[220:223], v[64:79]
    s_add_u32 s64, s72, 166912
    buffer_load_dwordx4 v[220:223], v3, s[32:35], s64 offen sc1
    s_waitcnt vmcnt(16) lgkmcnt(0)
    s_waitcnt vmcnt(8)
    v_cmp_eq_u32 vcc, s55, v13
    s_and_b32 s64, vcc_lo, 0xc0c0
    s_cmp_lg_u32 s64, 0xc0c0
    s_cbranch_scc1 RattB_psp_56
RattB_pok_55:
    s_add_u32 m0, s74, 20608
    s_add_u32 s64, s71, 294912
    buffer_load_dwordx4 v14, s[40:43], s64 offen lds
    s_add_u32 m0, s74, 21632
    s_add_u32 s64, s71, 299008
    buffer_load_dwordx4 v14, s[40:43], s64 offen lds
    v_add_u32 v6, 139904, v2
    v_xor_b32 v7, 64, v6
    ds_read_b64_tr_b16 v[136:137], v6 offset:0
    ds_read_b64_tr_b16 v[138:139], v6 offset:512
    ds_read_b64_tr_b16 v[140:141], v7 offset:0
    ds_read_b64_tr_b16 v[142:143], v7 offset:512
    v_mfma_f32_32x32x16_bf16 v[16:31], v[128:131], v[224:227], v[16:31]
    v_mfma_f32_32x32x16_bf16 v[32:47], v[132:135], v[224:227], v[32:47]
    s_add_u32 s64, s76, 32768
    buffer_load_dwordx4 v[224:227], v3, s[32:35], s64 offen sc1
    v_mfma_f32_32x32x16_bf16 v[48:63], v[128:131], v[228:231], v[48:63]
    v_mfma_f32_32x32x16_bf16 v[64:79], v[132:135], v[228:231], v[64:79]
    s_add_u32 s64, s76, 180224
    buffer_load_dwordx4 v[228:231], v3, s[32:35], s64 offen sc1
    s_waitcnt lgkmcnt(0)
    s_add_u32 m0, s74, 139904
    s_add_u32 s64, s71, 311296
    buffer_load_dwordx4 v14, s[40:43], s64 offen lds
    s_add_u32 m0, s74, 140928
    s_add_u32 s64, s71, 315392
    buffer_load_dwordx4 v14, s[40:43], s64 offen lds
    v_add_u32 v6, 36992, v2
    v_xor_b32 v7, 64, v6
    ds_read_b64_tr_b16 v[128:129], v6 offset:0
    ds_read_b64_tr_b16 v[130:131], v6 offset:512
    ds_read_b64_tr_b16 v[132:133], v7 offset:0
    ds_read_b64_tr_b16 v[134:135], v7 offset:512
    v_mfma_f32_32x32x16_bf16 v[16:31], v[136:139], v[232:235], v[16:31]
    v_mfma_f32_32x32x16_bf16 v[32:47], v[140:143], v[232:235], v[32:47]
    s_add_u32 s64, s76, 33792
    buffer_load_dwordx4 v[232:235], v3, s[32:35], s64 offen sc1
    v_mfma_f32_32x32x16_bf16 v[48:63], v[136:139], v[236:239], v[48:63]
    v_mfma_f32_32x32x16_bf16 v[64:79], v[140:143], v[236:239], v[64:79]
    s_add_u32 s64, s76, 181248
    buffer_load_dwordx4 v[236:239], v3, s[32:35], s64 offen sc1
    s_waitcnt lgkmcnt(0)
    s_add_u32 m0, s74, 36992
    s_add_u32 s64, s75, 0
    buffer_load_dwordx4 v14, s[40:43], s64 offen lds
    s_add_u32 m0, s74, 38016
    s_add_u32 s64, s75, 4096
    buffer_load_dwordx4 v14, s[40:43], s64 offen lds
    v_add_u32 v6, 53376, v2
    v_xor_b32 v7, 64, v6
    ds_read_b64_tr_b16 v[136:137], v6 offset:0
    ds_read_b64_tr_b16 v[138:139], v6 offset:512
    ds_read_b64_tr_b16 v[140:141], v7 offset:0
    ds_read_b64_tr_b16 v[142:143], v7 offset:512
    v_mfma_f32_32x32x16_bf16 v[16:31], v[128:131], v[240:243], v[16:31]
    v_mfma_f32_32x32x16_bf16 v[32:47], v[132:135], v[240:243], v[32:47]
    s_add_u32 s64, s76, 34816
    buffer_load_dwordx4 v[240:243], v3, s[32:35], s64 offen sc1
    v_mfma_f32_32x32x16_bf16 v[48:63], v[128:131], v[244:247], v[48:63]
    v_mfma_f32_32x32x16_bf16 v[64:79], v[132:135], v[244:247], v[64:79]
    s_add_u32 s64, s76, 182272
    buffer_load_dwordx4 v[244:247], v3, s[32:35], s64 offen sc1
    s_waitcnt lgkmcnt(0)
    s_add_u32 m0, s74, 53376
    s_add_u32 s64, s75, 16384
    buffer_load_dwordx4 v14, s[40:43], s64 offen lds
    s_add_u32 m0, s74, 54400
    s_add_u32 s64, s75, 20480
    buffer_load_dwordx4 v14, s[40:43], s64 offen lds
    v_add_u32 v6, 69760, v2
    v_xor_b32 v7, 64, v6
    ds_read_b64_tr_b16 v[128:129], v6 offset:0
    ds_read_b64_tr_b16 v[130:131], v6 offset:512
    ds_read_b64_tr_b16 v[132:133], v7 offset:0
    ds_read_b64_tr_b16 v[134:135], v7 offset:512
    v_mfma_f32_32x32x16_bf16 v[16:31], v[136:139], v[248:251], v[16:31]
    v_mfma_f32_32x32x16_bf16 v[32:47], v[140:143], v[248:251], v[32:47]
    s_add_u32 s64, s76, 35840
    buffer_load_dwordx4 v[248:251], v3, s[32:35], s64 offen sc1
    v_mfma_f32_32x32x16_bf16 v[48:63], v[136:139], v[252:255], v[48:63]
    v_mfma_f32_32x32x16_bf16 v[64:79], v[140:143], v[252:255], v[64:79]
    s_add_u32 s64, s76, 183296
    buffer_load_dwordx4 v[252:255], v3, s[32:35], s64 offen sc1
    s_waitcnt vmcnt(23) lgkmcnt(0)
    s_add_u32 m0, s74, 69760
    s_add_u32 s64, s75, 32768
    buffer_load_dwordx4 v14, s[40:43], s64 offen lds
    s_add_u32 m0, s74, 70784
    s_add_u32 s64, s75, 36864
    buffer_load_dwordx4 v14, s[40:43], s64 offen lds
    v_add_u32 v6, 86144, v2
    v_xor_b32 v7, 64, v6
    ds_read_b64_tr_b16 v[136:137], v6 offset:0
    ds_read_b64_tr_b16 v[138:139], v6 offset:512
    ds_read_b64_tr_b16 v[140:141], v7 offset:0
    ds_read_b64_tr_b16 v[142:143], v7 offset:512
    v_mfma_f32_32x32x16_bf16 v[16:31], v[128:131], v[144:147], v[16:31]
    v_mfma_f32_32x32x16_bf16 v[32:47], v[132:135], v[144:147], v[32:47]
    s_add_u32 s64, s76, 36864
    buffer_load_dwordx4 v[144:147], v3, s[32:35], s64 offen sc1
    s_waitcnt vmcnt(25)
    v_mfma_f32_32x32x16_bf16 v[48:63], v[128:131], v[148:151], v[48:63]
    v_mfma_f32_32x32x16_bf16 v[64:79], v[132:135], v[148:151], v[64:79]
    s_add_u32 s64, s76, 184320
    buffer_load_dwordx4 v[148:151], v3, s[32:35], s64 offen sc1
    s_waitcnt vmcnt(25) lgkmcnt(0)
    s_add_u32 m0, s74, 86144
    s_add_u32 s64, s75, 49152
    buffer_load_dwordx4 v14, s[40:43], s64 offen lds
    s_add_u32 m0, s74, 87168
    s_add_u32 s64, s75, 53248
    buffer_load_dwordx4 v14, s[40:43], s64 offen lds
    s_waitcnt vmcnt(20)
    v_add_u32 v6, 20608, v2
    v_xor_b32 v7, 64, v6
    ds_read_b64_tr_b16 v[128:129], v6 offset:0
    ds_read_b64_tr_b16 v[130:131], v6 offset:512
    ds_read_b64_tr_b16 v[132:133], v7 offset:0
    ds_read_b64_tr_b16 v[134:135], v7 offset:512
    v_mfma_f32_32x32x16_bf16 v[16:31], v[136:139], v[152:155], v[16:31]
    v_mfma_f32_32x32x16_bf16 v[32:47], v[140:143], v[152:155], v[32:47]
    s_add_u32 s64, s76, 37888
    buffer_load_dwordx4 v[152:155], v3, s[32:35], s64 offen sc1
    v_mfma_f32_32x32x16_bf16 v[48:63], v[136:139], v[156:159], v[48:63]
    v_mfma_f32_32x32x16_bf16 v[64:79], v[140:143], v[156:159], v[64:79]
    s_add_u32 s64, s76, 185344
    buffer_load_dwordx4 v[156:159], v3, s[32:35], s64 offen sc1
    s_waitcnt lgkmcnt(0)
    s_add_u32 m0, s74, 20608
    s_add_u32 s64, s75, 65536
    buffer_load_dwordx4 v14, s[40:43], s64 offen lds
    s_add_u32 m0, s74, 21632
    s_add_u32 s64, s75, 69632
    buffer_load_dwordx4 v14, s[40:43], s64 offen lds
    s_waitcnt vmcnt(20)
    v_add_u32 v6, 139904, v2
    v_xor_b32 v7, 64, v6
    ds_read_b64_tr_b16 v[136:137], v6 offset:0
    ds_read_b64_tr_b16 v[138:139], v6 offset:512
    ds_read_b64_tr_b16 v[140:141], v7 offset:0
    ds_read_b64_tr_b16 v[142:143], v7 offset:512
    v_mfma_f32_32x32x16_bf16 v[16:31], v[128:131], v[208:211], v[16:31]
    v_mfma_f32_32x32x16_bf16 v[32:47], v[132:135], v[208:211], v[32:47]
    s_add_u32 s64, s76, 38912
    buffer_load_dwordx4 v[208:211], v3, s[32:35], s64 offen sc1
    v_mfma_f32_32x32x16_bf16 v[48:63], v[128:131], v[212:215], v[48:63]
    v_mfma_f32_32x32x16_bf16 v[64:79], v[132:135], v[212:215], v[64:79]
    s_add_u32 s64, s76, 186368
    buffer_load_dwordx4 v[212:215], v3, s[32:35], s64 offen sc1
    s_waitcnt lgkmcnt(0)
    s_add_u32 m0, s74, 139904
    s_add_u32 s64, s75, 81920
    buffer_load_dwordx4 v14, s[40:43], s64 offen lds
    s_add_u32 m0, s74, 140928
    s_add_u32 s64, s75, 86016
    buffer_load_dwordx4 v14, s[40:43], s64 offen lds
    s_waitcnt vmcnt(20)
    v_add_u32 v6, 36992, v2
    v_xor_b32 v7, 64, v6
    ds_read_b64_tr_b16 v[128:129], v6 offset:0
    ds_read_b64_tr_b16 v[130:131], v6 offset:512
    ds_read_b64_tr_b16 v[132:133], v7 offset:0
    ds_read_b64_tr_b16 v[134:135], v7 offset:512
    v_mfma_f32_32x32x16_bf16 v[16:31], v[136:139], v[216:219], v[16:31]
    v_mfma_f32_32x32x16_bf16 v[32:47], v[140:143], v[216:219], v[32:47]
    s_add_u32 s64, s76, 39936
    buffer_load_dwordx4 v[216:219], v3, s[32:35], s64 offen sc1
    v_mfma_f32_32x32x16_bf16 v[48:63], v[136:139], v[220:223], v[48:63]
    v_mfma_f32_32x32x16_bf16 v[64:79], v[140:143], v[220:223], v[64:79]
    s_add_u32 s64, s76, 187392
    buffer_load_dwordx4 v[220:223], v3, s[32:35], s64 offen sc1
    s_waitcnt lgkmcnt(0)
    s_add_u32 m0, s74, 36992
    s_add_u32 s64, s75, 98304
    buffer_load_dwordx4 v14, s[40:43], s64 offen lds
    s_add_u32 m0, s74, 38016
    s_add_u32 s64, s75, 102400
    buffer_load_dwordx4 v14, s[40:43], s64 offen lds
    s_waitcnt vmcnt(20)
    v_add_u32 v6, 53376, v2
    v_xor_b32 v7, 64, v6
    ds_read_b64_tr_b16 v[136:137], v6 offset:0
    ds_read_b64_tr_b16 v[138:139], v6 offset:512
    ds_read_b64_tr_b16 v[140:141], v7 offset:0
    ds_read_b64_tr_b16 v[142:143], v7 offset:512
    v_mfma_f32_32x32x16_bf16 v[16:31], v[128:131], v[224:227], v[16:31]
    v_mfma_f32_32x32x16_bf16 v[32:47], v[132:135], v[224:227], v[32:47]
    v_mfma_f32_32x32x16_bf16 v[48:63], v[128:131], v[228:231], v[48:63]
    v_mfma_f32_32x32x16_bf16 v[64:79], v[132:135], v[228:231], v[64:79]
    s_waitcnt lgkmcnt(0)
    s_add_u32 m0, s74, 53376
    s_add_u32 s64, s75, 114688
    buffer_load_dwordx4 v14, s[40:43], s64 offen lds
    s_add_u32 m0, s74, 54400
    s_add_u32 s64, s75, 118784
    buffer_load_dwordx4 v14, s[40:43], s64 offen lds
    s_waitcnt vmcnt(18)
    v_add_u32 v6, 69760, v2
    v_xor_b32 v7, 64, v6
    ds_read_b64_tr_b16 v[128:129], v6 offset:0
    ds_read_b64_tr_b16 v[130:131], v6 offset:512
    ds_read_b64_tr_b16 v[132:133], v7 offset:0
    ds_read_b64_tr_b16 v[134:135], v7 offset:512
    v_mfma_f32_32x32x16_bf16 v[16:31], v[136:139], v[232:235], v[16:31]
    v_mfma_f32_32x32x16_bf16 v[32:47], v[140:143], v[232:235], v[32:47]
    v_mfma_f32_32x32x16_bf16 v[48:63], v[136:139], v[236:239], v[48:63]
    v_mfma_f32_32x32x16_bf16 v[64:79], v[140:143], v[236:239], v[64:79]
    s_waitcnt lgkmcnt(0)
    s_waitcnt vmcnt(14)
    v_add_u32 v6, 86144, v2
    v_xor_b32 v7, 64, v6
    ds_read_b64_tr_b16 v[136:137], v6 offset:0
    ds_read_b64_tr_b16 v[138:139], v6 offset:512
    ds_read_b64_tr_b16 v[140:141], v7 offset:0
    ds_read_b64_tr_b16 v[142:143], v7 offset:512
    v_mfma_f32_32x32x16_bf16 v[16:31], v[128:131], v[240:243], v[16:31]
    v_mfma_f32_32x32x16_bf16 v[32:47], v[132:135], v[240:243], v[32:47]
    v_mfma_f32_32x32x16_bf16 v[48:63], v[128:131], v[244:247], v[48:63]
    v_mfma_f32_32x32x16_bf16 v[64:79], v[132:135], v[244:247], v[64:79]
    s_waitcnt lgkmcnt(0)
    s_waitcnt vmcnt(10)
    v_add_u32 v6, 20608, v2
    v_xor_b32 v7, 64, v6
    ds_read_b64_tr_b16 v[128:129], v6 offset:0
    ds_read_b64_tr_b16 v[130:131], v6 offset:512
    ds_read_b64_tr_b16 v[132:133], v7 offset:0
    ds_read_b64_tr_b16 v[134:135], v7 offset:512
    v_mfma_f32_32x32x16_bf16 v[16:31], v[136:139], v[248:251], v[16:31]
    v_mfma_f32_32x32x16_bf16 v[32:47], v[140:143], v[248:251], v[32:47]
    v_mfma_f32_32x32x16_bf16 v[48:63], v[136:139], v[252:255], v[48:63]
    v_mfma_f32_32x32x16_bf16 v[64:79], v[140:143], v[252:255], v[64:79]
    s_waitcnt lgkmcnt(0)
    s_waitcnt vmcnt(6)
    v_add_u32 v6, 139904, v2
    v_xor_b32 v7, 64, v6
    ds_read_b64_tr_b16 v[136:137], v6 offset:0
    ds_read_b64_tr_b16 v[138:139], v6 offset:512
    ds_read_b64_tr_b16 v[140:141], v7 offset:0
    ds_read_b64_tr_b16 v[142:143], v7 offset:512
    v_mfma_f32_32x32x16_bf16 v[16:31], v[128:131], v[144:147], v[16:31]
    v_mfma_f32_32x32x16_bf16 v[32:47], v[132:135], v[144:147], v[32:47]
    v_mfma_f32_32x32x16_bf16 v[48:63], v[128:131], v[148:151], v[48:63]
    v_mfma_f32_32x32x16_bf16 v[64:79], v[132:135], v[148:151], v[64:79]
    s_waitcnt lgkmcnt(0)
    s_waitcnt vmcnt(2)
    v_add_u32 v6, 36992, v2
    v_xor_b32 v7, 64, v6
    ds_read_b64_tr_b16 v[128:129], v6 offset:0
    ds_read_b64_tr_b16 v[130:131], v6 offset:512
    ds_read_b64_tr_b16 v[132:133], v7 offset:0
    ds_read_b64_tr_b16 v[134:135], v7 offset:512
    v_mfma_f32_32x32x16_bf16 v[16:31], v[136:139], v[152:155], v[16:31]
    v_mfma_f32_32x32x16_bf16 v[32:47], v[140:143], v[152:155], v[32:47]
    v_mfma_f32_32x32x16_bf16 v[48:63], v[136:139], v[156:159], v[48:63]
    v_mfma_f32_32x32x16_bf16 v[64:79], v[140:143], v[156:159], v[64:79]
    s_waitcnt lgkmcnt(0)
    s_waitcnt vmcnt(0)
    v_add_u32 v6, 53376, v2
    v_xor_b32 v7, 64, v6
    ds_read_b64_tr_b16 v[136:137], v6 offset:0
    ds_read_b64_tr_b16 v[138:139], v6 offset:512
    ds_read_b64_tr_b16 v[140:141], v7 offset:0
    ds_read_b64_tr_b16 v[142:143], v7 offset:512
    v_mfma_f32_32x32x16_bf16 v[16:31], v[128:131], v[208:211], v[16:31]
    v_mfma_f32_32x32x16_bf16 v[32:47], v[132:135], v[208:211], v[32:47]
    v_mfma_f32_32x32x16_bf16 v[48:63], v[128:131], v[212:215], v[48:63]
    v_mfma_f32_32x32x16_bf16 v[64:79], v[132:135], v[212:215], v[64:79]
    s_waitcnt lgkmcnt(0)
    v_mfma_f32_32x32x16_bf16 v[16:31], v[136:139], v[216:219], v[16:31]
    v_mfma_f32_32x32x16_bf16 v[32:47], v[140:143], v[216:219], v[32:47]
    v_mfma_f32_32x32x16_bf16 v[48:63], v[136:139], v[220:223], v[48:63]
    v_mfma_f32_32x32x16_bf16 v[64:79], v[140:143], v[220:223], v[64:79]
    v_lshlrev_b32 v12, 4, v1
    s_lshl_b32 s64, s50, 11
    v_add_u32 v12, s64, v12
    v_add_u32 v13, 0x10000, v12
    v_add_u32 v14, 0x20000, v12
    v_mov_b32 v5, 158336
    s_mov_b32 s65, 0
RattB_cs_57:
    ds_read_b32 v15, v5
    s_waitcnt lgkmcnt(0)
    v_readfirstlane_b32 s64, v15
    s_add_u32 s65, s65, 1
    s_cmp_gt_u32 s65, 4000000
    s_cbranch_scc1 RattB_co_58
    s_cmp_lg_u32 s64, 4
    s_cbranch_scc1 RattB_cs_57
RattB_co_58:
    ds_write_b128 v12, v[16:19] offset:20608
    ds_write_b128 v12, v[20:23] offset:21632
    ds_write_b128 v14, v[24:27] offset:8832
    ds_write_b128 v14, v[28:31] offset:9856
    ds_write_b128 v12, v[32:35] offset:36992
    ds_write_b128 v12, v[36:39] offset:38016
    ds_write_b128 v12, v[40:43] offset:53376
    ds_write_b128 v12, v[44:47] offset:54400
    ds_write_b128 v13, v[48:51] offset:4224
    ds_write_b128 v13, v[52:55] offset:5248
    ds_write_b128 v13, v[56:59] offset:20608
    ds_write_b128 v13, v[60:63] offset:21632
    ds_write_b128 v13, v[64:67] offset:36992
    ds_write_b128 v13, v[68:71] offset:38016
    ds_write_b128 v12, v[72:75] offset:0
    ds_write_b128 v12, v[76:79] offset:1024
    s_mov_b32 s64, 36992
    s_cmp_eq_u32 s53, 1
    s_cselect_b32 s64, 102528, s64
    s_cmp_eq_u32 s53, 2
    s_cselect_b32 s64, 53376, s64
    s_cmp_eq_u32 s53, 3
    s_cselect_b32 s64, 0, s64
    v_and_b32 v12, 31, v1
    v_lshlrev_b32 v12, 4, v12
    v_lshrrev_b32 v13, 5, v1
    v_lshlrev_b32 v13, 10, v13
    v_add_u32 v12, v12, v13
    v_add_u32 v12, s64, v12
    s_waitcnt lgkmcnt(0)
    s_barrier
    ds_read_b128 v[80:83], v12 offset:0
    ds_read_b128 v[84:87], v12 offset:512
    ds_read_b128 v[88:91], v12 offset:2048
    ds_read_b128 v[92:95], v12 offset:2560
    ds_read_b128 v[96:99], v12 offset:4096
    ds_read_b128 v[100:103], v12 offset:4608
    ds_read_b128 v[104:107], v12 offset:6144
    ds_read_b128 v[108:111], v12 offset:6656
    ds_read_b128 v[112:115], v12 offset:8192
    ds_read_b128 v[116:119], v12 offset:8704
    ds_read_b128 v[120:123], v12 offset:10240
    ds_read_b128 v[124:127], v12 offset:10752
    ds_read_b128 v[128:131], v12 offset:12288
    ds_read_b128 v[132:135], v12 offset:12800
    ds_read_b128 v[136:139], v12 offset:14336
    ds_read_b128 v[140:143], v12 offset:14848
    v_lshlrev_b32 v16, 16, v8
    v_and_b32 v17, 0xffff0000, v8
    v_lshlrev_b32 v18, 16, v9
    v_and_b32 v19, 0xffff0000, v9
    v_lshlrev_b32 v20, 16, v10
    v_and_b32 v21, 0xffff0000, v10
    v_lshlrev_b32 v22, 16, v11
    v_and_b32 v23, 0xffff0000, v11
    s_waitcnt lgkmcnt(14)
    v_pk_add_f32 v[16:17], v[16:17], v[80:81]
    v_pk_add_f32 v[18:19], v[18:19], v[82:83]
    v_pk_add_f32 v[20:21], v[20:21], v[84:85]
    v_pk_add_f32 v[22:23], v[22:23], v[86:87]
    s_waitcnt lgkmcnt(12)
    v_pk_add_f32 v[16:17], v[16:17], v[88:89]
    v_pk_add_f32 v[18:19], v[18:19], v[90:91]
    v_pk_add_f32 v[20:21], v[20:21], v[92:93]
    v_pk_add_f32 v[22:23], v[22:23], v[94:95]
    s_waitcnt lgkmcnt(10)
    v_pk_add_f32 v[16:17], v[16:17], v[96:97]
    v_pk_add_f32 v[18:19], v[18:19], v[98:99]
    v_pk_add_f32 v[20:21], v[20:21], v[100:101]
    v_pk_add_f32 v[22:23], v[22:23], v[102:103]
    s_waitcnt lgkmcnt(8)
    v_pk_add_f32 v[16:17], v[16:17], v[104:105]
    v_pk_add_f32 v[18:19], v[18:19], v[106:107]
    v_pk_add_f32 v[20:21], v[20:21], v[108:109]
    v_pk_add_f32 v[22:23], v[22:23], v[110:111]
    s_waitcnt lgkmcnt(6)
    v_pk_add_f32 v[16:17], v[16:17], v[112:113]
    v_pk_add_f32 v[18:19], v[18:19], v[114:115]
    v_pk_add_f32 v[20:21], v[20:21], v[116:117]
    v_pk_add_f32 v[22:23], v[22:23], v[118:119]
    s_waitcnt lgkmcnt(4)
    v_pk_add_f32 v[16:17], v[16:17], v[120:121]
    v_pk_add_f32 v[18:19], v[18:19], v[122:123]
    v_pk_add_f32 v[20:21], v[20:21], v[124:125]
    v_pk_add_f32 v[22:23], v[22:23], v[126:127]
    s_waitcnt lgkmcnt(2)
    v_pk_add_f32 v[16:17], v[16:17], v[128:129]
    v_pk_add_f32 v[18:19], v[18:19], v[130:131]
    v_pk_add_f32 v[20:21], v[20:21], v[132:133]
    v_pk_add_f32 v[22:23], v[22:23], v[134:135]
    s_waitcnt lgkmcnt(0)
    v_pk_add_f32 v[16:17], v[16:17], v[136:137]
    v_pk_add_f32 v[18:19], v[18:19], v[138:139]
    v_pk_add_f32 v[20:21], v[20:21], v[140:141]
    v_pk_add_f32 v[22:23], v[22:23], v[142:143]
    v_cvt_pk_bf16_f32 v24, v16, v17
    v_cvt_pk_bf16_f32 v25, v18, v19
    v_cvt_pk_bf16_f32 v26, v20, v21
    v_cvt_pk_bf16_f32 v27, v22, v23
    buffer_store_dwordx4 v[24:27], v4, s[44:47], s73 offen
    s_endpgm
RattB_retry:
    s_mov_b32 s67, 0
RattB_rl_59:
    buffer_load_dwordx4 v[24:27], v15, s[32:35], s12 offen offset:0 sc1
    buffer_load_dwordx4 v[28:31], v15, s[32:35], s12 offen offset:512 sc1
    buffer_load_dwordx4 v[32:35], v15, s[32:35], s12 offen offset:1024 sc1
    buffer_load_dwordx4 v[36:39], v15, s[32:35], s12 offen offset:1536 sc1
    buffer_load_dwordx4 v[56:59], v60, s[32:35], s14 offen sc1
    s_waitcnt vmcnt(0)
    s_add_u32 s67, s67, 1
    s_cmp_gt_u32 s67, 400000
    s_cbranch_scc1 RattB_recok
    v_cmp_ne_u32 s[10:11], s56, v27
    v_cmp_ne_u32 vcc, s56, v31
    s_or_b64 s[10:11], s[10:11], vcc
    v_cmp_ne_u32 vcc, s56, v35
    s_or_b64 s[10:11], s[10:11], vcc
    v_cmp_ne_u32 vcc, s56, v39
    s_or_b64 s[10:11], s[10:11], vcc
    v_cmp_ne_u32 vcc, s55, v59
    s_or_b64 s[10:11], s[10:11], vcc
    s_cmp_lg_u64 s[10:11], 0
    s_cbranch_scc1 RattB_rl_59
RattB_rok_60:
    s_branch RattB_recok
RattB_psp_54:
RattB_pl_61:
    s_sleep 4
    s_mov_b64 exec, 0xffff
    buffer_load_dword v13, v12, s[32:35], s77 offen sc1
    s_mov_b64 exec, -1
    s_waitcnt vmcnt(0)
    v_cmp_eq_u32 vcc, s55, v13
    s_add_u32 s3, s3, 1
    s_cmp_gt_u32 s3, 400000
    s_cbranch_scc1 RattB_pok_53
    s_and_b32 s64, vcc_lo, 0xf0f
    s_cmp_lg_u32 s64, 0xf0f
    s_cbranch_scc1 RattB_pl_61
    s_branch RattB_pok_53
RattB_psp_56:
RattB_pl_62:
    s_sleep 4
    s_mov_b64 exec, 0xffff
    buffer_load_dword v13, v12, s[32:35], s77 offen sc1
    s_mov_b64 exec, -1
    s_waitcnt vmcnt(0)
    v_cmp_eq_u32 vcc, s55, v13
    s_add_u32 s3, s3, 1
    s_cmp_gt_u32 s3, 400000
    s_cbranch_scc1 RattB_pok_55
    s_and_b32 s64, vcc_lo, 0xc0c0
    s_cmp_lg_u32 s64, 0xc0c0
    s_cbranch_scc1 RattB_pl_62
    s_branch RattB_pok_55
RffnA:
    s_mov_b32 s3, 0
    v_lshrrev_b32 v40, 3, v1
    v_and_b32 v41, 7, v1
    v_lshrrev_b32 v42, 4, v1
    v_xor_b32 v43, v41, v42
    v_lshlrev_b32 v43, 4, v43
    v_lshlrev_b32 v44, 11, v40
    v_add_u32 v21, v44, v43
    v_xor_b32 v22, 64, v21
    s_lshl_b32 s61, s48, 17
    s_lshr_b32 s64, s53, 1
    s_lshl_b32 s64, s64, 16
    s_add_u32 s61, s61, s64
    s_and_b32 s64, s53, 1
    s_lshl_b32 s64, s64, 10
    s_add_u32 s61, s61, s64
    s_lshl_b32 s58, s53, 12
    s_add_u32 s58, s58, 103040
    s_lshr_b32 s64, s48, 3
    s_xor_b32 s65, s64, 1
    s_lshl_b32 s64, s64, 9
    s_add_u32 s62, s61, s64
    s_lshl_b32 s65, s65, 9
    s_add_u32 s63, s61, s65
    v_lshrrev_b32 v40, 5, v1
    v_lshlrev_b32 v40, 10, v40
    v_and_b32 v41, 31, v1
    v_lshlrev_b32 v41, 4, v41
    v_add_u32 v40, v40, v41
    s_lshl_b32 s66, s48, 7
    s_lshl_b32 s64, s54, 3
    s_add_u32 s66, s66, s64
    s_lshl_b32 s64, s53, 1
    s_add_u32 s66, s66, s64
    s_lshl_b32 s67, s66, 10
    s_waitcnt lgkmcnt(0)
    s_mov_b32 s16, s4
    s_mov_b32 s17, s5
    s_mov_b32 s18, 0x200000
    s_mov_b32 s19, 0x00020000
    s_mov_b32 s32, s12
    s_mov_b32 s33, s13
    s_mov_b32 s34, 0x1000000
    s_mov_b32 s35, 0x00020000
    s_add_u32 m0, s58, 0
    s_nop 0
    buffer_load_dwordx4 v21, s[16:19], s62 offen lds
    s_add_u32 m0, s58, 1024
    s_add_u32 s64, s62, 16384
    buffer_load_dwordx4 v22, s[16:19], s64 offen lds
    s_add_u32 m0, s58, 2048
    s_add_u32 s64, s62, 32768
    buffer_load_dwordx4 v21, s[16:19], s64 offen lds
    s_add_u32 m0, s58, 3072
    s_add_u32 s64, s62, 49152
    buffer_load_dwordx4 v22, s[16:19], s64 offen lds
    s_lshl_b32 s64, s48, 7
    s_add_u32 s64, s64, 0x998000
    s_lshl_b32 s65, s54, 7
    s_add_u32 s65, s65, 0x999000
    buffer_load_dword v62, off, s[32:35], s64 sc1
    buffer_load_dword v63, off, s[32:35], s65 sc1
    buffer_load_dwordx4 v[160:163], v40, s[16:19], s67 offen
    buffer_load_dwordx4 v[164:167], v40, s[16:19], s67 offen offset:512
    s_add_u32 m0, s58, 18432
    s_add_u32 s64, s62, 128
    buffer_load_dwordx4 v21, s[16:19], s64 offen lds
    s_add_u32 m0, s58, 19456
    s_add_u32 s64, s62, 16512
    buffer_load_dwordx4 v22, s[16:19], s64 offen lds
    s_add_u32 m0, s58, 20480
    s_add_u32 s64, s62, 32896
    buffer_load_dwordx4 v21, s[16:19], s64 offen lds
    s_add_u32 m0, s58, 21504
    s_add_u32 s64, s62, 49280
    buffer_load_dwordx4 v22, s[16:19], s64 offen lds
    s_add_u32 m0, s58, 36864
    s_add_u32 s64, s62, 256
    buffer_load_dwordx4 v21, s[16:19], s64 offen lds
    s_add_u32 m0, s58, 37888
    s_add_u32 s64, s62, 16640
    buffer_load_dwordx4 v22, s[16:19], s64 offen lds
    s_add_u32 m0, s58, 38912
    s_add_u32 s64, s62, 33024
    buffer_load_dwordx4 v21, s[16:19], s64 offen lds
    s_add_u32 m0, s58, 39936
    s_add_u32 s64, s62, 49408
    buffer_load_dwordx4 v22, s[16:19], s64 offen lds
    s_lshl_b32 s59, s66, 4
    s_add_u32 s59, s59, 0x900000
    s_mov_b32 s36, s14
    s_mov_b32 s37, s15
    s_mov_b32 s38, 0x80000
    s_mov_b32 s39, 0x00020000
    s_mov_b32 s40, s44
    s_mov_b32 s41, s45
    s_mov_b32 s42, 0x1c0000
    s_mov_b32 s43, 0x00020000
    s_mov_b32 s44, s46
    s_mov_b32 s45, s47
    s_mov_b32 s46, 0x200000
    s_mov_b32 s47, 0x00020000
    v_lshrrev_b32 v46, 4, v1
    v_bfe_u32 v47, v1, 2, 2
    v_and_b32 v48, 3, v1
    v_lshrrev_b32 v49, 1, v46
    v_and_b32 v50, 1, v46
    v_lshlrev_b32 v51, 3, v49
    v_add_u32 v51, v51, v47
    v_lshrrev_b32 v52, 1, v47
    v_mul_u32_u24 v53, 10272, v50
    v_mul_u32_u24 v54, 320, v51
    v_add_u32 v53, v53, v54
    v_lshlrev_b32 v55, 3, v48
    v_add_u32 v53, v53, v55
    s_mul_i32 s64, s52, 96
    v_add_u32 v2, s64, v53
    v_add_u32 v3, 61824, v2
    v_and_b32 v53, 31, v1
    v_lshrrev_b32 v54, 5, v1
    v_bfe_u32 v55, v1, 1, 3
    v_xor_b32 v55, v55, v54
    v_lshlrev_b32 v55, 4, v55
    v_lshlrev_b32 v53, 7, v53
    v_add_u32 v53, v53, v55
    s_lshl_b32 s64, s51, 13
    s_add_u32 s64, s64, 103040
    v_add_u32 v8, s64, v53
    v_xor_b32 v9, 32, v8
    v_xor_b32 v10, 64, v8
    v_xor_b32 v11, 96, v8
    v_lshrrev_b32 v53, 3, v1
    v_and_b32 v54, 3, v53
    v_lshrrev_b32 v55, 2, v53
    v_lshlrev_b32 v55, 3, v55
    v_add_u32 v54, v54, v55
    v_lshlrev_b32 v54, 10, v54
    v_bfe_u32 v55, v53, 1, 1
    v_lshlrev_b32 v55, 2, v55
    v_and_b32 v56, 7, v1
    v_xor_b32 v55, v55, v56
    v_lshlrev_b32 v55, 4, v55
    v_add_u32 v14, v54, v55
    s_and_b32 s64, s2, 7
    s_lshr_b32 s64, s64, 1
    s_and_b32 s65, s64, 1
    s_lshl_b32 s69, s48, 1
    s_add_u32 s69, s69, s65
    s_lshr_b32 s64, s64, 1
    s_lshl_b32 s64, s64, 2
    s_add_u32 s70, s64, s79
    s_mov_b32 s15, s50
    s_mul_i32 s71, s15, 163840
    s_add_u32 s71, s71, 524288
    s_lshl_b32 s64, s70, 7
    s_add_u32 s71, s71, s64
    s_lshl_b32 s74, s50, 11
    s_mul_i32 s72, s69, 294912
    s_and_b32 s68, s48, 7
    s_cmp_eq_u32 s51, 0
    s_cselect_b32 s68, s68, 99
    s_waitcnt vmcnt(8)
    v_readfirstlane_b32 s55, v62
    v_readfirstlane_b32 s56, v63
    s_mul_i32 s55, s55, 0x9e3779b1
    s_add_u32 s55, s55, 0x7f4a7c15
    s_mul_i32 s56, s56, 0x9e3779b1
    s_add_u32 s56, s56, 0x7f4a7c15
    v_lshlrev_b32 v208, 16, v160
    v_and_b32 v209, 0xffff0000, v160
    v_lshlrev_b32 v210, 16, v161
    v_and_b32 v211, 0xffff0000, v161
    v_lshlrev_b32 v212, 16, v162
    v_and_b32 v213, 0xffff0000, v162
    v_lshlrev_b32 v214, 16, v163
    v_and_b32 v215, 0xffff0000, v163
    v_lshlrev_b32 v216, 16, v164
    v_and_b32 v217, 0xffff0000, v164
    v_lshlrev_b32 v218, 16, v165
    v_and_b32 v219, 0xffff0000, v165
    v_lshlrev_b32 v220, 16, v166
    v_and_b32 v221, 0xffff0000, v166
    v_lshlrev_b32 v222, 16, v167
    v_and_b32 v223, 0xffff0000, v167
    v_pk_add_f32 v[202:203], v[208:209], v[210:211]
    v_pk_add_f32 v[202:203], v[202:203], v[212:213]
    v_pk_add_f32 v[202:203], v[202:203], v[214:215]
    v_pk_add_f32 v[202:203], v[202:203], v[216:217]
    v_pk_add_f32 v[202:203], v[202:203], v[218:219]
    v_pk_add_f32 v[202:203], v[202:203], v[220:221]
    v_pk_add_f32 v[202:203], v[202:203], v[222:223]
    v_add_f32 v200, v202, v203
    s_nop 1
    v_add_f32_dpp v200, v200, v200 row_ror:8 row_mask:0xf bank_mask:0xf
    s_nop 1
    v_add_f32_dpp v200, v200, v200 row_ror:4 row_mask:0xf bank_mask:0xf
    s_nop 1
    v_add_f32_dpp v200, v200, v200 row_ror:2 row_mask:0xf bank_mask:0xf
    s_nop 1
    v_add_f32_dpp v200, v200, v200 row_ror:1 row_mask:0xf bank_mask:0xf
    v_mov_b32 v202, v200
    s_nop 1
    v_permlane16_swap_b32 v200, v202
    v_add_f32 v200, v200, v202
    v_mul_f32 v200, 0x3b000000, v200
    v_pk_add_f32 v[208:209], v[208:209], v[200:201] op_sel_hi:[1,0] neg_lo:[0,1] neg_hi:[0,1]
    v_pk_add_f32 v[210:211], v[210:211], v[200:201] op_sel_hi:[1,0] neg_lo:[0,1] neg_hi:[0,1]
    v_pk_add_f32 v[212:213], v[212:213], v[200:201] op_sel_hi:[1,0] neg_lo:[0,1] neg_hi:[0,1]
    v_pk_add_f32 v[214:215], v[214:215], v[200:201] op_sel_hi:[1,0] neg_lo:[0,1] neg_hi:[0,1]
    v_pk_add_f32 v[216:217], v[216:217], v[200:201] op_sel_hi:[1,0] neg_lo:[0,1] neg_hi:[0,1]
    v_pk_add_f32 v[218:219], v[218:219], v[200:201] op_sel_hi:[1,0] neg_lo:[0,1] neg_hi:[0,1]
    v_pk_add_f32 v[220:221], v[220:221], v[200:201] op_sel_hi:[1,0] neg_lo:[0,1] neg_hi:[0,1]
    v_pk_add_f32 v[222:223], v[222:223], v[200:201] op_sel_hi:[1,0] neg_lo:[0,1] neg_hi:[0,1]
    v_pk_mul_f32 v[202:203], v[208:209], v[208:209]
    v_pk_fma_f32 v[202:203], v[210:211], v[210:211], v[202:203]
    v_pk_fma_f32 v[202:203], v[212:213], v[212:213], v[202:203]
    v_pk_fma_f32 v[202:203], v[214:215], v[214:215], v[202:203]
    v_pk_fma_f32 v[202:203], v[216:217], v[216:217], v[202:203]
    v_pk_fma_f32 v[202:203], v[218:219], v[218:219], v[202:203]
    v_pk_fma_f32 v[202:203], v[220:221], v[220:221], v[202:203]
    v_pk_fma_f32 v[202:203], v[222:223], v[222:223], v[202:203]
    v_add_f32 v201, v202, v203
    s_nop 1
    v_add_f32_dpp v201, v201, v201 row_ror:8 row_mask:0xf bank_mask:0xf
    s_nop 1
    v_add_f32_dpp v201, v201, v201 row_ror:4 row_mask:0xf bank_mask:0xf
    s_nop 1
    v_add_f32_dpp v201, v201, v201 row_ror:2 row_mask:0xf bank_mask:0xf
    s_nop 1
    v_add_f32_dpp v201, v201, v201 row_ror:1 row_mask:0xf bank_mask:0xf
    v_mov_b32 v202, v201
    s_nop 1
    v_permlane16_swap_b32 v201, v202
    v_add_f32 v201, v201, v202
    v_mov_b32 v202, 0x3727c5ac
    v_fmac_f32 v202, 0x3b000000, v201
    v_rsq_f32 v201, v202
    v_mov_b32 v202, s55
    v_mov_b32 v203, s55
    v_lshrrev_b32 v53, 5, v1
    v_lshlrev_b32 v53, 4, v53
    s_mov_b32 exec_lo, 1
    s_mov_b32 exec_hi, 1
    buffer_store_dwordx4 v[200:203], v53, s[32:35], s59 offen sc1
    s_mov_b64 exec, -1
    s_waitcnt lgkmcnt(0)
    s_barrier
    ds_read_b128 v[160:163], v8 offset:0
    ds_read_b128 v[164:167], v8 offset:4096
    ds_read_b64_tr_b16 v[176:177], v2 offset:0
    ds_read_b64_tr_b16 v[178:179], v2 offset:1280
    ds_read_b64_tr_b16 v[180:181], v2 offset:32
    ds_read_b64_tr_b16 v[182:183], v2 offset:1312
    ds_read_b64_tr_b16 v[184:185], v2 offset:64
    ds_read_b64_tr_b16 v[186:187], v2 offset:1344
    ds_read_b128 v[168:171], v9 offset:0
    ds_read_b128 v[172:175], v9 offset:4096
    ds_read_b64_tr_b16 v[188:189], v2 offset:5120
    ds_read_b64_tr_b16 v[190:191], v2 offset:6400
    ds_read_b64_tr_b16 v[192:193], v2 offset:5152
    ds_read_b64_tr_b16 v[194:195], v2 offset:6432
    ds_read_b64_tr_b16 v[196:197], v2 offset:5184
    ds_read_b64_tr_b16 v[198:199], v2 offset:6464
    s_waitcnt lgkmcnt(0)
    s_barrier
    v_mfma_f32_32x32x16_bf16 v[64:79], v[176:179], v[160:163], 0
    ds_read_b128 v[200:203], v10 offset:0
    ds_read_b128 v[204:207], v10 offset:4096
    v_mfma_f32_32x32x16_bf16 v[80:95], v[176:179], v[164:167], 0
    ds_read_b64_tr_b16 v[216:217], v2 offset:20608
    v_mfma_f32_32x32x16_bf16 v[96:111], v[180:183], v[160:163], 0
    ds_read_b64_tr_b16 v[218:219], v2 offset:21888
    ds_read_b64_tr_b16 v[220:221], v2 offset:20640
    v_mfma_f32_32x32x16_bf16 v[112:127], v[180:183], v[164:167], 0
    ds_read_b64_tr_b16 v[222:223], v2 offset:21920
    v_mfma_f32_32x32x16_bf16 v[128:143], v[184:187], v[160:163], 0
    ds_read_b64_tr_b16 v[224:225], v2 offset:20672
    ds_read_b64_tr_b16 v[226:227], v2 offset:21952
    v_mfma_f32_32x32x16_bf16 v[144:159], v[184:187], v[164:167], 0
    ds_read_b128 v[208:211], v11 offset:0
    v_mfma_f32_32x32x16_bf16 v[64:79], v[188:191], v[168:171], v[64:79]
    ds_read_b128 v[212:215], v11 offset:4096
    ds_read_b64_tr_b16 v[228:229], v2 offset:25728
    v_mfma_f32_32x32x16_bf16 v[80:95], v[188:191], v[172:175], v[80:95]
    ds_read_b64_tr_b16 v[230:231], v2 offset:27008
    v_mfma_f32_32x32x16_bf16 v[96:111], v[192:195], v[168:171], v[96:111]
    ds_read_b64_tr_b16 v[232:233], v2 offset:25760
    ds_read_b64_tr_b16 v[234:235], v2 offset:27040
    v_mfma_f32_32x32x16_bf16 v[112:127], v[192:195], v[172:175], v[112:127]
    ds_read_b64_tr_b16 v[236:237], v2 offset:25792
    v_mfma_f32_32x32x16_bf16 v[128:143], v[196:199], v[168:171], v[128:143]
    ds_read_b64_tr_b16 v[238:239], v2 offset:27072
    v_mfma_f32_32x32x16_bf16 v[144:159], v[196:199], v[172:175], v[144:159]
    s_cmp_lg_u32 s68, 0
    s_cbranch_scc1 RffnA_nocs_63
    v_bfe_u32 v40, v1, 4, 1
    v_and_b32 v41, 1, v1
    v_cmp_eq_u32 vcc, v40, v41
    v_mov_b32 v42, 0x3f803f80
    s_nop 0
    v_cndmask_b32 v40, 0, v42, vcc
    v_mov_b32 v41, v40
    v_mov_b32 v42, v40
    v_mov_b32 v43, v40
    s_nop 1
    v_mfma_f32_16x16x32_bf16 v[44:47], v[40:43], v[176:179], 0
    v_mfma_f32_16x16x32_bf16 v[48:51], v[40:43], v[180:183], 0
    v_mfma_f32_16x16x32_bf16 v[52:55], v[40:43], v[184:187], 0
    v_mfma_f32_16x16x32_bf16 v[44:47], v[40:43], v[188:191], v[44:47]
    v_mfma_f32_16x16x32_bf16 v[48:51], v[40:43], v[192:195], v[48:51]
    v_mfma_f32_16x16x32_bf16 v[52:55], v[40:43], v[196:199], v[52:55]
    v_bfe_u32 v28, v1, 4, 1
    v_cmp_eq_u32 vcc, 1, v28
    s_nop 3
    v_cndmask_b32 v24, v44, v45, vcc
    v_cndmask_b32 v25, v48, v49, vcc
    v_cndmask_b32 v26, v52, v53, vcc
    v_mov_b32 v27, s56
    s_lshl_b32 s64, s54, 2
    s_add_u32 s64, s64, s52
    s_add_u32 s64, s64, 0
    s_lshl_b32 s64, s64, 4
    s_add_u32 s64, s64, s48
    s_lshl_b32 s64, s64, 9
    s_add_u32 s64, s64, 0x910000
    v_lshlrev_b32 v28, 4, v1
    s_mov_b32 exec_hi, 0
    buffer_store_dwordx4 v[24:27], v28, s[32:35], s64 offen sc1
    s_mov_b32 exec_hi, -1
RffnA_nocs_63:
    s_waitcnt vmcnt(5) lgkmcnt(0)
    s_barrier
    v_mfma_f32_32x32x16_bf16 v[64:79], v[216:219], v[200:203], v[64:79]
    ds_read_b128 v[160:163], v8 offset:18432
    ds_read_b128 v[164:167], v8 offset:22528
    v_mfma_f32_32x32x16_bf16 v[80:95], v[216:219], v[204:207], v[80:95]
    ds_read_b64_tr_b16 v[176:177], v2 offset:41216
    v_mfma_f32_32x32x16_bf16 v[96:111], v[220:223], v[200:203], v[96:111]
    ds_read_b64_tr_b16 v[178:179], v2 offset:42496
    ds_read_b64_tr_b16 v[180:181], v2 offset:41248
    v_mfma_f32_32x32x16_bf16 v[112:127], v[220:223], v[204:207], v[112:127]
    ds_read_b64_tr_b16 v[182:183], v2 offset:42528
    v_mfma_f32_32x32x16_bf16 v[128:143], v[224:227], v[200:203], v[128:143]
    ds_read_b64_tr_b16 v[184:185], v2 offset:41280
    ds_read_b64_tr_b16 v[186:187], v2 offset:42560
    v_mfma_f32_32x32x16_bf16 v[144:159], v[224:227], v[204:207], v[144:159]
    ds_read_b128 v[168:171], v9 offset:18432
    v_mfma_f32_32x32x16_bf16 v[64:79], v[228:231], v[208:211], v[64:79]
    ds_read_b128 v[172:175], v9 offset:22528
    ds_read_b64_tr_b16 v[188:189], v2 offset:46336
    v_mfma_f32_32x32x16_bf16 v[80:95], v[228:231], v[212:215], v[80:95]
    ds_read_b64_tr_b16 v[190:191], v2 offset:47616
    v_mfma_f32_32x32x16_bf16 v[96:111], v[232:235], v[208:211], v[96:111]
    ds_read_b64_tr_b16 v[192:193], v2 offset:46368
    ds_read_b64_tr_b16 v[194:195], v2 offset:47648
    v_mfma_f32_32x32x16_bf16 v[112:127], v[232:235], v[212:215], v[112:127]
    ds_read_b64_tr_b16 v[196:197], v2 offset:46400
    v_mfma_f32_32x32x16_bf16 v[128:143], v[236:239], v[208:211], v[128:143]
    ds_read_b64_tr_b16 v[198:199], v2 offset:47680
    v_mfma_f32_32x32x16_bf16 v[144:159], v[236:239], v[212:215], v[144:159]
    s_add_u32 m0, s58, 0
    s_add_u32 s64, s62, 384
    buffer_load_dwordx4 v21, s[16:19], s64 offen lds
    s_add_u32 m0, s58, 1024
    s_add_u32 s64, s62, 16768
    buffer_load_dwordx4 v22, s[16:19], s64 offen lds
    s_add_u32 m0, s58, 2048
    s_add_u32 s64, s62, 33152
    buffer_load_dwordx4 v21, s[16:19], s64 offen lds
    s_add_u32 m0, s58, 3072
    s_add_u32 s64, s62, 49536
    buffer_load_dwordx4 v22, s[16:19], s64 offen lds
    s_cmp_lg_u32 s68, 1
    s_cbranch_scc1 RffnA_nocs_64
    v_bfe_u32 v40, v1, 4, 1
    v_and_b32 v41, 1, v1
    v_cmp_eq_u32 vcc, v40, v41
    v_mov_b32 v42, 0x3f803f80
    s_nop 0
    v_cndmask_b32 v40, 0, v42, vcc
    v_mov_b32 v41, v40
    v_mov_b32 v42, v40
    v_mov_b32 v43, v40
    s_nop 1
    v_mfma_f32_16x16x32_bf16 v[44:47], v[40:43], v[216:219], 0
    v_mfma_f32_16x16x32_bf16 v[48:51], v[40:43], v[220:223], 0
    v_mfma_f32_16x16x32_bf16 v[52:55], v[40:43], v[224:227], 0
    v_mfma_f32_16x16x32_bf16 v[44:47], v[40:43], v[228:231], v[44:47]
    v_mfma_f32_16x16x32_bf16 v[48:51], v[40:43], v[232:235], v[48:51]
    v_mfma_f32_16x16x32_bf16 v[52:55], v[40:43], v[236:239], v[52:55]
    v_bfe_u32 v28, v1, 4, 1
    v_cmp_eq_u32 vcc, 1, v28
    s_nop 3
    v_cndmask_b32 v24, v44, v45, vcc
    v_cndmask_b32 v25, v48, v49, vcc
    v_cndmask_b32 v26, v52, v53, vcc
    v_mov_b32 v27, s56
    s_lshl_b32 s64, s54, 2
    s_add_u32 s64, s64, s52
    s_add_u32 s64, s64, 0
    s_lshl_b32 s64, s64, 4
    s_add_u32 s64, s64, s48
    s_lshl_b32 s64, s64, 9
    s_add_u32 s64, s64, 0x910000
    v_lshlrev_b32 v28, 4, v1
    s_mov_b32 exec_hi, 0
    buffer_store_dwordx4 v[24:27], v28, s[32:35], s64 offen sc1
    s_mov_b32 exec_hi, -1
RffnA_nocs_64:
    s_waitcnt lgkmcnt(0)
    s_barrier
    v_mfma_f32_32x32x16_bf16 v[64:79], v[176:179], v[160:163], v[64:79]
    ds_read_b128 v[200:203], v10 offset:18432
    ds_read_b128 v[204:207], v10 offset:22528
    v_mfma_f32_32x32x16_bf16 v[80:95], v[176:179], v[164:167], v[80:95]
    ds_read_b64_tr_b16 v[216:217], v3 offset:0
    v_mfma_f32_32x32x16_bf16 v[96:111], v[180:183], v[160:163], v[96:111]
    ds_read_b64_tr_b16 v[218:219], v3 offset:1280
    ds_read_b64_tr_b16 v[220:221], v3 offset:32
    v_mfma_f32_32x32x16_bf16 v[112:127], v[180:183], v[164:167], v[112:127]
    ds_read_b64_tr_b16 v[222:223], v3 offset:1312
    v_mfma_f32_32x32x16_bf16 v[128:143], v[184:187], v[160:163], v[128:143]
    ds_read_b64_tr_b16 v[224:225], v3 offset:64
    ds_read_b64_tr_b16 v[226:227], v3 offset:1344
    v_mfma_f32_32x32x16_bf16 v[144:159], v[184:187], v[164:167], v[144:159]
    ds_read_b128 v[208:211], v11 offset:18432
    v_mfma_f32_32x32x16_bf16 v[64:79], v[188:191], v[168:171], v[64:79]
    ds_read_b128 v[212:215], v11 offset:22528
    ds_read_b64_tr_b16 v[228:229], v3 offset:5120
    v_mfma_f32_32x32x16_bf16 v[80:95], v[188:191], v[172:175], v[80:95]
    ds_read_b64_tr_b16 v[230:231], v3 offset:6400
    v_mfma_f32_32x32x16_bf16 v[96:111], v[192:195], v[168:171], v[96:111]
    ds_read_b64_tr_b16 v[232:233], v3 offset:5152
    ds_read_b64_tr_b16 v[234:235], v3 offset:6432
    v_mfma_f32_32x32x16_bf16 v[112:127], v[192:195], v[172:175], v[112:127]
    ds_read_b64_tr_b16 v[236:237], v3 offset:5184
    v_mfma_f32_32x32x16_bf16 v[128:143], v[196:199], v[168:171], v[128:143]
    ds_read_b64_tr_b16 v[238:239], v3 offset:6464
    v_mfma_f32_32x32x16_bf16 v[144:159], v[196:199], v[172:175], v[144:159]
    s_cmp_lg_u32 s68, 2
    s_cbranch_scc1 RffnA_nocs_65
    v_bfe_u32 v40, v1, 4, 1
    v_and_b32 v41, 1, v1
    v_cmp_eq_u32 vcc, v40, v41
    v_mov_b32 v42, 0x3f803f80
    s_nop 0
    v_cndmask_b32 v40, 0, v42, vcc
    v_mov_b32 v41, v40
    v_mov_b32 v42, v40
    v_mov_b32 v43, v40
    s_nop 1
    v_mfma_f32_16x16x32_bf16 v[44:47], v[40:43], v[176:179], 0
    v_mfma_f32_16x16x32_bf16 v[48:51], v[40:43], v[180:183], 0
    v_mfma_f32_16x16x32_bf16 v[52:55], v[40:43], v[184:187], 0
    v_mfma_f32_16x16x32_bf16 v[44:47], v[40:43], v[188:191], v[44:47]
    v_mfma_f32_16x16x32_bf16 v[48:51], v[40:43], v[192:195], v[48:51]
    v_mfma_f32_16x16x32_bf16 v[52:55], v[40:43], v[196:199], v[52:55]
    v_bfe_u32 v28, v1, 4, 1
    v_cmp_eq_u32 vcc, 1, v28
    s_nop 3
    v_cndmask_b32 v24, v44, v45, vcc
    v_cndmask_b32 v25, v48, v49, vcc
    v_cndmask_b32 v26, v52, v53, vcc
    v_mov_b32 v27, s56
    s_lshl_b32 s64, s54, 2
    s_add_u32 s64, s64, s52
    s_add_u32 s64, s64, 0
    s_lshl_b32 s64, s64, 4
    s_add_u32 s64, s64, s48
    s_lshl_b32 s64, s64, 9
    s_add_u32 s64, s64, 0x910000
    v_lshlrev_b32 v28, 4, v1
    s_mov_b32 exec_hi, 0
    buffer_store_dwordx4 v[24:27], v28, s[32:35], s64 offen sc1
    s_mov_b32 exec_hi, -1
RffnA_nocs_65:
    s_waitcnt vmcnt(5) lgkmcnt(0)
    s_barrier
    v_mfma_f32_32x32x16_bf16 v[64:79], v[216:219], v[200:203], v[64:79]
    ds_read_b128 v[160:163], v8 offset:36864
    ds_read_b128 v[164:167], v8 offset:40960
    v_mfma_f32_32x32x16_bf16 v[80:95], v[216:219], v[204:207], v[80:95]
    ds_read_b64_tr_b16 v[176:177], v3 offset:20608
    v_mfma_f32_32x32x16_bf16 v[96:111], v[220:223], v[200:203], v[96:111]
    ds_read_b64_tr_b16 v[178:179], v3 offset:21888
    ds_read_b64_tr_b16 v[180:181], v3 offset:20640
    v_mfma_f32_32x32x16_bf16 v[112:127], v[220:223], v[204:207], v[112:127]
    ds_read_b64_tr_b16 v[182:183], v3 offset:21920
    v_mfma_f32_32x32x16_bf16 v[128:143], v[224:227], v[200:203], v[128:143]
    ds_read_b64_tr_b16 v[184:185], v3 offset:20672
    ds_read_b64_tr_b16 v[186:187], v3 offset:21952
    v_mfma_f32_32x32x16_bf16 v[144:159], v[224:227], v[204:207], v[144:159]
    ds_read_b128 v[168:171], v9 offset:36864
    v_mfma_f32_32x32x16_bf16 v[64:79], v[228:231], v[208:211], v[64:79]
    ds_read_b128 v[172:175], v9 offset:40960
    ds_read_b64_tr_b16 v[188:189], v3 offset:25728
    v_mfma_f32_32x32x16_bf16 v[80:95], v[228:231], v[212:215], v[80:95]
    ds_read_b64_tr_b16 v[190:191], v3 offset:27008
    v_mfma_f32_32x32x16_bf16 v[96:111], v[232:235], v[208:211], v[96:111]
    ds_read_b64_tr_b16 v[192:193], v3 offset:25760
    ds_read_b64_tr_b16 v[194:195], v3 offset:27040
    v_mfma_f32_32x32x16_bf16 v[112:127], v[232:235], v[212:215], v[112:127]
    ds_read_b64_tr_b16 v[196:197], v3 offset:25792
    v_mfma_f32_32x32x16_bf16 v[128:143], v[236:239], v[208:211], v[128:143]
    ds_read_b64_tr_b16 v[198:199], v3 offset:27072
    v_mfma_f32_32x32x16_bf16 v[144:159], v[236:239], v[212:215], v[144:159]
    s_add_u32 m0, s58, 18432
    s_nop 0
    buffer_load_dwordx4 v21, s[16:19], s63 offen lds
    s_add_u32 m0, s58, 19456
    s_add_u32 s64, s63, 16384
    buffer_load_dwordx4 v22, s[16:19], s64 offen lds
    s_add_u32 m0, s58, 20480
    s_add_u32 s64, s63, 32768
    buffer_load_dwordx4 v21, s[16:19], s64 offen lds
    s_add_u32 m0, s58, 21504
    s_add_u32 s64, s63, 49152
    buffer_load_dwordx4 v22, s[16:19], s64 offen lds
    s_cmp_lg_u32 s68, 3
    s_cbranch_scc1 RffnA_nocs_66
    v_bfe_u32 v40, v1, 4, 1
    v_and_b32 v41, 1, v1
    v_cmp_eq_u32 vcc, v40, v41
    v_mov_b32 v42, 0x3f803f80
    s_nop 0
    v_cndmask_b32 v40, 0, v42, vcc
    v_mov_b32 v41, v40
    v_mov_b32 v42, v40
    v_mov_b32 v43, v40
    s_nop 1
    v_mfma_f32_16x16x32_bf16 v[44:47], v[40:43], v[216:219], 0
    v_mfma_f32_16x16x32_bf16 v[48:51], v[40:43], v[220:223], 0
    v_mfma_f32_16x16x32_bf16 v[52:55], v[40:43], v[224:227], 0
    v_mfma_f32_16x16x32_bf16 v[44:47], v[40:43], v[228:231], v[44:47]
    v_mfma_f32_16x16x32_bf16 v[48:51], v[40:43], v[232:235], v[48:51]
    v_mfma_f32_16x16x32_bf16 v[52:55], v[40:43], v[236:239], v[52:55]
    v_bfe_u32 v28, v1, 4, 1
    v_cmp_eq_u32 vcc, 1, v28
    s_nop 3
    v_cndmask_b32 v24, v44, v45, vcc
    v_cndmask_b32 v25, v48, v49, vcc
    v_cndmask_b32 v26, v52, v53, vcc
    v_mov_b32 v27, s56
    s_lshl_b32 s64, s54, 2
    s_add_u32 s64, s64, s52
    s_add_u32 s64, s64, 0
    s_lshl_b32 s64, s64, 4
    s_add_u32 s64, s64, s48
    s_lshl_b32 s64, s64, 9
    s_add_u32 s64, s64, 0x910000
    v_lshlrev_b32 v28, 4, v1
    s_mov_b32 exec_hi, 0
    buffer_store_dwordx4 v[24:27], v28, s[32:35], s64 offen sc1
    s_mov_b32 exec_hi, -1
RffnA_nocs_66:
    s_waitcnt lgkmcnt(0)
    s_barrier
    v_mfma_f32_32x32x16_bf16 v[64:79], v[176:179], v[160:163], v[64:79]
    ds_read_b128 v[200:203], v10 offset:36864
    ds_read_b128 v[204:207], v10 offset:40960
    v_mfma_f32_32x32x16_bf16 v[80:95], v[176:179], v[164:167], v[80:95]
    ds_read_b64_tr_b16 v[216:217], v2 offset:0
    v_mfma_f32_32x32x16_bf16 v[96:111], v[180:183], v[160:163], v[96:111]
    ds_read_b64_tr_b16 v[218:219], v2 offset:1280
    ds_read_b64_tr_b16 v[220:221], v2 offset:32
    v_mfma_f32_32x32x16_bf16 v[112:127], v[180:183], v[164:167], v[112:127]
    ds_read_b64_tr_b16 v[222:223], v2 offset:1312
    v_mfma_f32_32x32x16_bf16 v[128:143], v[184:187], v[160:163], v[128:143]
    ds_read_b64_tr_b16 v[224:225], v2 offset:64
    ds_read_b64_tr_b16 v[226:227], v2 offset:1344
    v_mfma_f32_32x32x16_bf16 v[144:159], v[184:187], v[164:167], v[144:159]
    ds_read_b128 v[208:211], v11 offset:36864
    v_mfma_f32_32x32x16_bf16 v[64:79], v[188:191], v[168:171], v[64:79]
    ds_read_b128 v[212:215], v11 offset:40960
    ds_read_b64_tr_b16 v[228:229], v2 offset:5120
    v_mfma_f32_32x32x16_bf16 v[80:95], v[188:191], v[172:175], v[80:95]
    ds_read_b64_tr_b16 v[230:231], v2 offset:6400
    v_mfma_f32_32x32x16_bf16 v[96:111], v[192:195], v[168:171], v[96:111]
    ds_read_b64_tr_b16 v[232:233], v2 offset:5152
    ds_read_b64_tr_b16 v[234:235], v2 offset:6432
    v_mfma_f32_32x32x16_bf16 v[112:127], v[192:195], v[172:175], v[112:127]
    ds_read_b64_tr_b16 v[236:237], v2 offset:5184
    v_mfma_f32_32x32x16_bf16 v[128:143], v[196:199], v[168:171], v[128:143]
    ds_read_b64_tr_b16 v[238:239], v2 offset:6464
    v_mfma_f32_32x32x16_bf16 v[144:159], v[196:199], v[172:175], v[144:159]
    s_cmp_lg_u32 s68, 4
    s_cbranch_scc1 RffnA_nocs_67
    v_bfe_u32 v40, v1, 4, 1
    v_and_b32 v41, 1, v1
    v_cmp_eq_u32 vcc, v40, v41
    v_mov_b32 v42, 0x3f803f80
    s_nop 0
    v_cndmask_b32 v40, 0, v42, vcc
    v_mov_b32 v41, v40
    v_mov_b32 v42, v40
    v_mov_b32 v43, v40
    s_nop 1
    v_mfma_f32_16x16x32_bf16 v[44:47], v[40:43], v[176:179], 0
    v_mfma_f32_16x16x32_bf16 v[48:51], v[40:43], v[180:183], 0
    v_mfma_f32_16x16x32_bf16 v[52:55], v[40:43], v[184:187], 0
    v_mfma_f32_16x16x32_bf16 v[44:47], v[40:43], v[188:191], v[44:47]
    v_mfma_f32_16x16x32_bf16 v[48:51], v[40:43], v[192:195], v[48:51]
    v_mfma_f32_16x16x32_bf16 v[52:55], v[40:43], v[196:199], v[52:55]
    v_bfe_u32 v28, v1, 4, 1
    v_cmp_eq_u32 vcc, 1, v28
    s_nop 3
    v_cndmask_b32 v24, v44, v45, vcc
    v_cndmask_b32 v25, v48, v49, vcc
    v_cndmask_b32 v26, v52, v53, vcc
    v_mov_b32 v27, s56
    s_lshl_b32 s64, s54, 2
    s_add_u32 s64, s64, s52
    s_add_u32 s64, s64, 0
    s_lshl_b32 s64, s64, 4
    s_add_u32 s64, s64, s48
    s_lshl_b32 s64, s64, 9
    s_add_u32 s64, s64, 0x910000
    v_lshlrev_b32 v28, 4, v1
    s_mov_b32 exec_hi, 0
    buffer_store_dwordx4 v[24:27], v28, s[32:35], s64 offen sc1
    s_mov_b32 exec_hi, -1
RffnA_nocs_67:
    s_waitcnt vmcnt(4) lgkmcnt(0)
    s_barrier
    v_mfma_f32_32x32x16_bf16 v[64:79], v[216:219], v[200:203], v[64:79]
    ds_read_b128 v[160:163], v8 offset:0
    ds_read_b128 v[164:167], v8 offset:4096
    v_mfma_f32_32x32x16_bf16 v[80:95], v[216:219], v[204:207], v[80:95]
    ds_read_b64_tr_b16 v[176:177], v2 offset:20608
    v_mfma_f32_32x32x16_bf16 v[96:111], v[220:223], v[200:203], v[96:111]
    ds_read_b64_tr_b16 v[178:179], v2 offset:21888
    ds_read_b64_tr_b16 v[180:181], v2 offset:20640
    v_mfma_f32_32x32x16_bf16 v[112:127], v[220:223], v[204:207], v[112:127]
    ds_read_b64_tr_b16 v[182:183], v2 offset:21920
    v_mfma_f32_32x32x16_bf16 v[128:143], v[224:227], v[200:203], v[128:143]
    ds_read_b64_tr_b16 v[184:185], v2 offset:20672
    ds_read_b64_tr_b16 v[186:187], v2 offset:21952
    v_mfma_f32_32x32x16_bf16 v[144:159], v[224:227], v[204:207], v[144:159]
    ds_read_b128 v[168:171], v9 offset:0
    v_mfma_f32_32x32x16_bf16 v[64:79], v[228:231], v[208:211], v[64:79]
    ds_read_b128 v[172:175], v9 offset:4096
    ds_read_b64_tr_b16 v[188:189], v2 offset:25728
    v_mfma_f32_32x32x16_bf16 v[80:95], v[228:231], v[212:215], v[80:95]
    ds_read_b64_tr_b16 v[190:191], v2 offset:27008
    v_mfma_f32_32x32x16_bf16 v[96:111], v[232:235], v[208:211], v[96:111]
    ds_read_b64_tr_b16 v[192:193], v2 offset:25760
    ds_read_b64_tr_b16 v[194:195], v2 offset:27040
    v_mfma_f32_32x32x16_bf16 v[112:127], v[232:235], v[212:215], v[112:127]
    ds_read_b64_tr_b16 v[196:197], v2 offset:25792
    v_mfma_f32_32x32x16_bf16 v[128:143], v[236:239], v[208:211], v[128:143]
    ds_read_b64_tr_b16 v[198:199], v2 offset:27072
    v_mfma_f32_32x32x16_bf16 v[144:159], v[236:239], v[212:215], v[144:159]
    s_add_u32 m0, s58, 36864
    s_add_u32 s64, s63, 128
    buffer_load_dwordx4 v21, s[16:19], s64 offen lds
    s_add_u32 m0, s58, 37888
    s_add_u32 s64, s63, 16512
    buffer_load_dwordx4 v22, s[16:19], s64 offen lds
    s_add_u32 m0, s58, 38912
    s_add_u32 s64, s63, 32896
    buffer_load_dwordx4 v21, s[16:19], s64 offen lds
    s_add_u32 m0, s58, 39936
    s_add_u32 s64, s63, 49280
    buffer_load_dwordx4 v22, s[16:19], s64 offen lds
    s_cmp_lg_u32 s68, 5
    s_cbranch_scc1 RffnA_nocs_68
    v_bfe_u32 v40, v1, 4, 1
    v_and_b32 v41, 1, v1
    v_cmp_eq_u32 vcc, v40, v41
    v_mov_b32 v42, 0x3f803f80
    s_nop 0
    v_cndmask_b32 v40, 0, v42, vcc
    v_mov_b32 v41, v40
    v_mov_b32 v42, v40
    v_mov_b32 v43, v40
    s_nop 1
    v_mfma_f32_16x16x32_bf16 v[44:47], v[40:43], v[216:219], 0
    v_mfma_f32_16x16x32_bf16 v[48:51], v[40:43], v[220:223], 0
    v_mfma_f32_16x16x32_bf16 v[52:55], v[40:43], v[224:227], 0
    v_mfma_f32_16x16x32_bf16 v[44:47], v[40:43], v[228:231], v[44:47]
    v_mfma_f32_16x16x32_bf16 v[48:51], v[40:43], v[232:235], v[48:51]
    v_mfma_f32_16x16x32_bf16 v[52:55], v[40:43], v[236:239], v[52:55]
    v_bfe_u32 v28, v1, 4, 1
    v_cmp_eq_u32 vcc, 1, v28
    s_nop 3
    v_cndmask_b32 v24, v44, v45, vcc
    v_cndmask_b32 v25, v48, v49, vcc
    v_cndmask_b32 v26, v52, v53, vcc
    v_mov_b32 v27, s56
    s_lshl_b32 s64, s54, 2
    s_add_u32 s64, s64, s52
    s_add_u32 s64, s64, 0
    s_lshl_b32 s64, s64, 4
    s_add_u32 s64, s64, s48
    s_lshl_b32 s64, s64, 9
    s_add_u32 s64, s64, 0x910000
    v_lshlrev_b32 v28, 4, v1
    s_mov_b32 exec_hi, 0
    buffer_store_dwordx4 v[24:27], v28, s[32:35], s64 offen sc1
    s_mov_b32 exec_hi, -1
RffnA_nocs_68:
    s_waitcnt lgkmcnt(0)
    s_barrier
    v_mfma_f32_32x32x16_bf16 v[64:79], v[176:179], v[160:163], v[64:79]
    ds_read_b128 v[200:203], v10 offset:0
    ds_read_b128 v[204:207], v10 offset:4096
    v_mfma_f32_32x32x16_bf16 v[80:95], v[176:179], v[164:167], v[80:95]
    ds_read_b64_tr_b16 v[216:217], v2 offset:41216
    v_mfma_f32_32x32x16_bf16 v[96:111], v[180:183], v[160:163], v[96:111]
    ds_read_b64_tr_b16 v[218:219], v2 offset:42496
    ds_read_b64_tr_b16 v[220:221], v2 offset:41248
    v_mfma_f32_32x32x16_bf16 v[112:127], v[180:183], v[164:167], v[112:127]
    ds_read_b64_tr_b16 v[222:223], v2 offset:42528
    v_mfma_f32_32x32x16_bf16 v[128:143], v[184:187], v[160:163], v[128:143]
    ds_read_b64_tr_b16 v[224:225], v2 offset:41280
    ds_read_b64_tr_b16 v[226:227], v2 offset:42560
    v_mfma_f32_32x32x16_bf16 v[144:159], v[184:187], v[164:167], v[144:159]
    ds_read_b128 v[208:211], v11 offset:0
    v_mfma_f32_32x32x16_bf16 v[64:79], v[188:191], v[168:171], v[64:79]
    ds_read_b128 v[212:215], v11 offset:4096
    ds_read_b64_tr_b16 v[228:229], v2 offset:46336
    v_mfma_f32_32x32x16_bf16 v[80:95], v[188:191], v[172:175], v[80:95]
    ds_read_b64_tr_b16 v[230:231], v2 offset:47616
    v_mfma_f32_32x32x16_bf16 v[96:111], v[192:195], v[168:171], v[96:111]
    ds_read_b64_tr_b16 v[232:233], v2 offset:46368
    ds_read_b64_tr_b16 v[234:235], v2 offset:47648
    v_mfma_f32_32x32x16_bf16 v[112:127], v[192:195], v[172:175], v[112:127]
    ds_read_b64_tr_b16 v[236:237], v2 offset:46400
    v_mfma_f32_32x32x16_bf16 v[128:143], v[196:199], v[168:171], v[128:143]
    ds_read_b64_tr_b16 v[238:239], v2 offset:47680
    v_mfma_f32_32x32x16_bf16 v[144:159], v[196:199], v[172:175], v[144:159]
    v_lshrrev_b32 v63, 2, v1
    v_lshlrev_b32 v63, 10, v63
    v_and_b32 v62, 3, v1
    v_lshlrev_b32 v62, 7, v62
    v_add_u32 v63, v63, v62
    s_and_b32 s64, s2, 4
    s_lshl_b32 s64, s64, 7
    v_add_u32 v63, s64, v63
    s_lshr_b32 s64, s2, 3
    s_lshl_b32 s64, s64, 2
    s_add_u32 s64, s64, s53
    s_lshl_b32 s64, s64, 14
    s_mov_b32 exec_lo, 0xff
    s_mov_b32 exec_hi, 0x0
    buffer_load_dword v62, v63, s[40:43], s64 offen
    s_mov_b64 exec, -1
    s_cmp_lg_u32 s68, 6
    s_cbranch_scc1 RffnA_nocs_69
    v_bfe_u32 v40, v1, 4, 1
    v_and_b32 v41, 1, v1
    v_cmp_eq_u32 vcc, v40, v41
    v_mov_b32 v42, 0x3f803f80
    s_nop 0
    v_cndmask_b32 v40, 0, v42, vcc
    v_mov_b32 v41, v40
    v_mov_b32 v42, v40
    v_mov_b32 v43, v40
    s_nop 1
    v_mfma_f32_16x16x32_bf16 v[44:47], v[40:43], v[176:179], 0
    v_mfma_f32_16x16x32_bf16 v[48:51], v[40:43], v[180:183], 0
    v_mfma_f32_16x16x32_bf16 v[52:55], v[40:43], v[184:187], 0
    v_mfma_f32_16x16x32_bf16 v[44:47], v[40:43], v[188:191], v[44:47]
    v_mfma_f32_16x16x32_bf16 v[48:51], v[40:43], v[192:195], v[48:51]
    v_mfma_f32_16x16x32_bf16 v[52:55], v[40:43], v[196:199], v[52:55]
    v_bfe_u32 v28, v1, 4, 1
    v_cmp_eq_u32 vcc, 1, v28
    s_nop 3
    v_cndmask_b32 v24, v44, v45, vcc
    v_cndmask_b32 v25, v48, v49, vcc
    v_cndmask_b32 v26, v52, v53, vcc
    v_mov_b32 v27, s56
    s_lshl_b32 s64, s54, 2
    s_add_u32 s64, s64, s52
    s_add_u32 s64, s64, 0
    s_lshl_b32 s64, s64, 4
    s_add_u32 s64, s64, s48
    s_lshl_b32 s64, s64, 9
    s_add_u32 s64, s64, 0x910000
    v_lshlrev_b32 v28, 4, v1
    s_mov_b32 exec_hi, 0
    buffer_store_dwordx4 v[24:27], v28, s[32:35], s64 offen sc1
    s_mov_b32 exec_hi, -1
RffnA_nocs_69:
    s_waitcnt vmcnt(5) lgkmcnt(0)
    s_barrier
    v_mfma_f32_32x32x16_bf16 v[64:79], v[216:219], v[200:203], v[64:79]
    ds_read_b128 v[160:163], v8 offset:18432
    ds_read_b128 v[164:167], v8 offset:22528
    v_mfma_f32_32x32x16_bf16 v[80:95], v[216:219], v[204:207], v[80:95]
    ds_read_b64_tr_b16 v[176:177], v3 offset:0
    v_mfma_f32_32x32x16_bf16 v[96:111], v[220:223], v[200:203], v[96:111]
    ds_read_b64_tr_b16 v[178:179], v3 offset:1280
    ds_read_b64_tr_b16 v[180:181], v3 offset:32
    v_mfma_f32_32x32x16_bf16 v[112:127], v[220:223], v[204:207], v[112:127]
    ds_read_b64_tr_b16 v[182:183], v3 offset:1312
    v_mfma_f32_32x32x16_bf16 v[128:143], v[224:227], v[200:203], v[128:143]
    ds_read_b64_tr_b16 v[184:185], v3 offset:64
    ds_read_b64_tr_b16 v[186:187], v3 offset:1344
    v_mfma_f32_32x32x16_bf16 v[144:159], v[224:227], v[204:207], v[144:159]
    ds_read_b128 v[168:171], v9 offset:18432
    v_mfma_f32_32x32x16_bf16 v[64:79], v[228:231], v[208:211], v[64:79]
    ds_read_b128 v[172:175], v9 offset:22528
    ds_read_b64_tr_b16 v[188:189], v3 offset:5120
    v_mfma_f32_32x32x16_bf16 v[80:95], v[228:231], v[212:215], v[80:95]
    ds_read_b64_tr_b16 v[190:191], v3 offset:6400
    v_mfma_f32_32x32x16_bf16 v[96:111], v[232:235], v[208:211], v[96:111]
    ds_read_b64_tr_b16 v[192:193], v3 offset:5152
    ds_read_b64_tr_b16 v[194:195], v3 offset:6432
    v_mfma_f32_32x32x16_bf16 v[112:127], v[232:235], v[212:215], v[112:127]
    ds_read_b64_tr_b16 v[196:197], v3 offset:5184
    v_mfma_f32_32x32x16_bf16 v[128:143], v[236:239], v[208:211], v[128:143]
    ds_read_b64_tr_b16 v[198:199], v3 offset:6464
    v_mfma_f32_32x32x16_bf16 v[144:159], v[236:239], v[212:215], v[144:159]
    s_add_u32 m0, s58, 0
    s_add_u32 s64, s63, 256
    buffer_load_dwordx4 v21, s[16:19], s64 offen lds
    s_add_u32 m0, s58, 1024
    s_add_u32 s64, s63, 16640
    buffer_load_dwordx4 v22, s[16:19], s64 offen lds
    s_add_u32 m0, s58, 2048
    s_add_u32 s64, s63, 33024
    buffer_load_dwordx4 v21, s[16:19], s64 offen lds
    s_add_u32 m0, s58, 3072
    s_add_u32 s64, s63, 49408
    buffer_load_dwordx4 v22, s[16:19], s64 offen lds
    s_lshr_b32 s64, s2, 3
    s_lshl_b32 s64, s64, 2
    s_add_u32 s64, s64, s53
    s_lshl_b32 s64, s64, 14
    s_mov_b32 exec_lo, 0xff00
    s_mov_b32 exec_hi, 0x0
    buffer_load_dword v62, v63, s[40:43], s64 offen
    s_mov_b64 exec, -1
    s_cmp_lg_u32 s68, 7
    s_cbranch_scc1 RffnA_nocs_70
    v_bfe_u32 v40, v1, 4, 1
    v_and_b32 v41, 1, v1
    v_cmp_eq_u32 vcc, v40, v41
    v_mov_b32 v42, 0x3f803f80
    s_nop 0
    v_cndmask_b32 v40, 0, v42, vcc
    v_mov_b32 v41, v40
    v_mov_b32 v42, v40
    v_mov_b32 v43, v40
    s_nop 1
    v_mfma_f32_16x16x32_bf16 v[44:47], v[40:43], v[216:219], 0
    v_mfma_f32_16x16x32_bf16 v[48:51], v[40:43], v[220:223], 0
    v_mfma_f32_16x16x32_bf16 v[52:55], v[40:43], v[224:227], 0
    v_mfma_f32_16x16x32_bf16 v[44:47], v[40:43], v[228:231], v[44:47]
    v_mfma_f32_16x16x32_bf16 v[48:51], v[40:43], v[232:235], v[48:51]
    v_mfma_f32_16x16x32_bf16 v[52:55], v[40:43], v[236:239], v[52:55]
    v_bfe_u32 v28, v1, 4, 1
    v_cmp_eq_u32 vcc, 1, v28
    s_nop 3
    v_cndmask_b32 v24, v44, v45, vcc
    v_cndmask_b32 v25, v48, v49, vcc
    v_cndmask_b32 v26, v52, v53, vcc
    v_mov_b32 v27, s56
    s_lshl_b32 s64, s54, 2
    s_add_u32 s64, s64, s52
    s_add_u32 s64, s64, 0
    s_lshl_b32 s64, s64, 4
    s_add_u32 s64, s64, s48
    s_lshl_b32 s64, s64, 9
    s_add_u32 s64, s64, 0x910000
    v_lshlrev_b32 v28, 4, v1
    s_mov_b32 exec_hi, 0
    buffer_store_dwordx4 v[24:27], v28, s[32:35], s64 offen sc1
    s_mov_b32 exec_hi, -1
RffnA_nocs_70:
    s_waitcnt lgkmcnt(0)
    s_barrier
    v_mfma_f32_32x32x16_bf16 v[64:79], v[176:179], v[160:163], v[64:79]
    ds_read_b128 v[200:203], v10 offset:18432
    ds_read_b128 v[204:207], v10 offset:22528
    v_mfma_f32_32x32x16_bf16 v[80:95], v[176:179], v[164:167], v[80:95]
    ds_read_b64_tr_b16 v[216:217], v3 offset:20608
    v_mfma_f32_32x32x16_bf16 v[96:111], v[180:183], v[160:163], v[96:111]
    ds_read_b64_tr_b16 v[218:219], v3 offset:21888
    ds_read_b64_tr_b16 v[220:221], v3 offset:20640
    v_mfma_f32_32x32x16_bf16 v[112:127], v[180:183], v[164:167], v[112:127]
    ds_read_b64_tr_b16 v[222:223], v3 offset:21920
    v_mfma_f32_32x32x16_bf16 v[128:143], v[184:187], v[160:163], v[128:143]
    ds_read_b64_tr_b16 v[224:225], v3 offset:20672
    ds_read_b64_tr_b16 v[226:227], v3 offset:21952
    v_mfma_f32_32x32x16_bf16 v[144:159], v[184:187], v[164:167], v[144:159]
    ds_read_b128 v[208:211], v11 offset:18432
    v_mfma_f32_32x32x16_bf16 v[64:79], v[188:191], v[168:171], v[64:79]
    ds_read_b128 v[212:215], v11 offset:22528
    ds_read_b64_tr_b16 v[228:229], v3 offset:25728
    v_mfma_f32_32x32x16_bf16 v[80:95], v[188:191], v[172:175], v[80:95]
    ds_read_b64_tr_b16 v[230:231], v3 offset:27008
    v_mfma_f32_32x32x16_bf16 v[96:111], v[192:195], v[168:171], v[96:111]
    ds_read_b64_tr_b16 v[232:233], v3 offset:25760
    ds_read_b64_tr_b16 v[234:235], v3 offset:27040
    v_mfma_f32_32x32x16_bf16 v[112:127], v[192:195], v[172:175], v[112:127]
    ds_read_b64_tr_b16 v[236:237], v3 offset:25792
    v_mfma_f32_32x32x16_bf16 v[128:143], v[196:199], v[168:171], v[128:143]
    ds_read_b64_tr_b16 v[238:239], v3 offset:27072
    v_mfma_f32_32x32x16_bf16 v[144:159], v[196:199], v[172:175], v[144:159]
    s_lshr_b32 s64, s2, 3
    s_lshl_b32 s64, s64, 2
    s_add_u32 s64, s64, s53
    s_lshl_b32 s64, s64, 14
    s_mov_b32 exec_lo, 0xff0000
    s_mov_b32 exec_hi, 0x0
    buffer_load_dword v62, v63, s[40:43], s64 offen
    s_mov_b64 exec, -1
    s_waitcnt vmcnt(7) lgkmcnt(0)
    s_barrier
    v_mfma_f32_32x32x16_bf16 v[64:79], v[216:219], v[200:203], v[64:79]
    ds_read_b128 v[160:163], v8 offset:36864
    ds_read_b128 v[164:167], v8 offset:40960
    v_mfma_f32_32x32x16_bf16 v[80:95], v[216:219], v[204:207], v[80:95]
    ds_read_b64_tr_b16 v[176:177], v2 offset:0
    ds_read_b64_tr_b16 v[178:179], v2 offset:1280
    v_mfma_f32_32x32x16_bf16 v[96:111], v[220:223], v[200:203], v[96:111]
    ds_read_b64_tr_b16 v[180:181], v2 offset:32
    ds_read_b64_tr_b16 v[182:183], v2 offset:1312
    v_mfma_f32_32x32x16_bf16 v[112:127], v[220:223], v[204:207], v[112:127]
    ds_read_b64_tr_b16 v[184:185], v2 offset:64
    ds_read_b64_tr_b16 v[186:187], v2 offset:1344
    v_mfma_f32_32x32x16_bf16 v[128:143], v[224:227], v[200:203], v[128:143]
    ds_read_b128 v[168:171], v9 offset:36864
    ds_read_b128 v[172:175], v9 offset:40960
    v_mfma_f32_32x32x16_bf16 v[144:159], v[224:227], v[204:207], v[144:159]
    ds_read_b64_tr_b16 v[188:189], v2 offset:5120
    v_mfma_f32_32x32x16_bf16 v[64:79], v[228:231], v[208:211], v[64:79]
    ds_read_b64_tr_b16 v[190:191], v2 offset:6400
    ds_read_b64_tr_b16 v[192:193], v2 offset:5152
    v_mfma_f32_32x32x16_bf16 v[80:95], v[228:231], v[212:215], v[80:95]
    ds_read_b64_tr_b16 v[194:195], v2 offset:6432
    ds_read_b64_tr_b16 v[196:197], v2 offset:5184
    v_mfma_f32_32x32x16_bf16 v[96:111], v[232:235], v[208:211], v[96:111]
    ds_read_b64_tr_b16 v[198:199], v2 offset:6464
    v_and_b32 v15, 31, v1
    v_lshlrev_b32 v15, 4, v15
    v_lshrrev_b32 v60, 5, v1
    v_lshlrev_b32 v61, 11, v60
    v_add_u32 v15, v15, v61
    v_mfma_f32_32x32x16_bf16 v[112:127], v[232:235], v[212:215], v[112:127]
    s_lshl_b32 s12, s54, 2
    s_add_u32 s12, s12, s52
    s_add_u32 s12, s12, 0
    s_lshl_b32 s12, s12, 1
    s_add_u32 s12, s12, s51
    s_lshl_b32 s12, s12, 12
    s_add_u32 s12, s12, 0x910000
    v_and_b32 v61, 31, v1
    v_lshlrev_b32 v61, 5, v61
    v_lshlrev_b32 v60, 4, v60
    v_add_u32 v60, v60, v61
    v_mfma_f32_32x32x16_bf16 v[128:143], v[236:239], v[208:211], v[128:143]
    s_lshl_b32 s14, s48, 11
    s_lshl_b32 s13, s51, 10
    s_add_u32 s14, s14, s13
    s_add_u32 s14, s14, 0x900000
    v_mfma_f32_32x32x16_bf16 v[144:159], v[236:239], v[212:215], v[144:159]
    s_add_u32 m0, s58, 18432
    s_add_u32 s64, s63, 384
    buffer_load_dwordx4 v21, s[16:19], s64 offen lds
    s_add_u32 m0, s58, 19456
    s_add_u32 s64, s63, 16768
    buffer_load_dwordx4 v22, s[16:19], s64 offen lds
    s_add_u32 m0, s58, 20480
    s_add_u32 s64, s63, 33152
    buffer_load_dwordx4 v21, s[16:19], s64 offen lds
    s_add_u32 m0, s58, 21504
    s_add_u32 s64, s63, 49536
    buffer_load_dwordx4 v22, s[16:19], s64 offen lds
    s_lshr_b32 s64, s2, 3
    s_lshl_b32 s64, s64, 2
    s_add_u32 s64, s64, s53
    s_lshl_b32 s64, s64, 14
    s_mov_b32 exec_lo, 0xff000000
    s_mov_b32 exec_hi, 0x0
    buffer_load_dword v62, v63, s[40:43], s64 offen
    s_mov_b64 exec, -1
    s_waitcnt lgkmcnt(0)
    s_barrier
    v_mfma_f32_32x32x16_bf16 v[64:79], v[176:179], v[160:163], v[64:79]
    ds_read_b128 v[200:203], v10 offset:36864
    ds_read_b128 v[204:207], v10 offset:40960
    v_mfma_f32_32x32x16_bf16 v[80:95], v[176:179], v[164:167], v[80:95]
    ds_read_b64_tr_b16 v[216:217], v2 offset:20608
    v_mfma_f32_32x32x16_bf16 v[96:111], v[180:183], v[160:163], v[96:111]
    ds_read_b64_tr_b16 v[218:219], v2 offset:21888
    ds_read_b64_tr_b16 v[220:221], v2 offset:20640
    v_mfma_f32_32x32x16_bf16 v[112:127], v[180:183], v[164:167], v[112:127]
    ds_read_b64_tr_b16 v[222:223], v2 offset:21920
    v_mfma_f32_32x32x16_bf16 v[128:143], v[184:187], v[160:163], v[128:143]
    ds_read_b64_tr_b16 v[224:225], v2 offset:20672
    ds_read_b64_tr_b16 v[226:227], v2 offset:21952
    v_mfma_f32_32x32x16_bf16 v[144:159], v[184:187], v[164:167], v[144:159]
    ds_read_b128 v[208:211], v11 offset:36864
    v_mfma_f32_32x32x16_bf16 v[64:79], v[188:191], v[168:171], v[64:79]
    ds_read_b128 v[212:215], v11 offset:40960
    ds_read_b64_tr_b16 v[228:229], v2 offset:25728
    v_mfma_f32_32x32x16_bf16 v[80:95], v[188:191], v[172:175], v[80:95]
    ds_read_b64_tr_b16 v[230:231], v2 offset:27008
    v_mfma_f32_32x32x16_bf16 v[96:111], v[192:195], v[168:171], v[96:111]
    ds_read_b64_tr_b16 v[232:233], v2 offset:25760
    ds_read_b64_tr_b16 v[234:235], v2 offset:27040
    v_mfma_f32_32x32x16_bf16 v[112:127], v[192:195], v[172:175], v[112:127]
    ds_read_b64_tr_b16 v[236:237], v2 offset:25792
    v_mfma_f32_32x32x16_bf16 v[128:143], v[196:199], v[168:171], v[128:143]
    ds_read_b64_tr_b16 v[238:239], v2 offset:27072
    v_mfma_f32_32x32x16_bf16 v[144:159], v[196:199], v[172:175], v[144:159]
    buffer_load_dwordx4 v[24:27], v15, s[32:35], s12 offen offset:0 sc1
    buffer_load_dwordx4 v[28:31], v15, s[32:35], s12 offen offset:512 sc1
    buffer_load_dwordx4 v[32:35], v15, s[32:35], s12 offen offset:1024 sc1
    buffer_load_dwordx4 v[36:39], v15, s[32:35], s12 offen offset:1536 sc1
    buffer_load_dwordx4 v[56:59], v60, s[32:35], s14 offen sc1
    s_lshr_b32 s64, s2, 3
    s_lshl_b32 s64, s64, 2
    s_add_u32 s64, s64, s53
    s_lshl_b32 s64, s64, 14
    s_mov_b32 exec_lo, 0x0
    s_mov_b32 exec_hi, 0xff
    buffer_load_dword v62, v63, s[40:43], s64 offen
    s_mov_b64 exec, -1
    s_waitcnt vmcnt(13) lgkmcnt(0)
    s_barrier
    v_mfma_f32_32x32x16_bf16 v[64:79], v[216:219], v[200:203], v[64:79]
    ds_read_b128 v[160:163], v8 offset:0
    ds_read_b128 v[164:167], v8 offset:4096
    v_mfma_f32_32x32x16_bf16 v[80:95], v[216:219], v[204:207], v[80:95]
    ds_read_b64_tr_b16 v[176:177], v2 offset:41216
    v_mfma_f32_32x32x16_bf16 v[96:111], v[220:223], v[200:203], v[96:111]
    ds_read_b64_tr_b16 v[178:179], v2 offset:42496
    ds_read_b64_tr_b16 v[180:181], v2 offset:41248
    v_mfma_f32_32x32x16_bf16 v[112:127], v[220:223], v[204:207], v[112:127]
    ds_read_b64_tr_b16 v[182:183], v2 offset:42528
    v_mfma_f32_32x32x16_bf16 v[128:143], v[224:227], v[200:203], v[128:143]
    ds_read_b64_tr_b16 v[184:185], v2 offset:41280
    ds_read_b64_tr_b16 v[186:187], v2 offset:42560
    v_mfma_f32_32x32x16_bf16 v[144:159], v[224:227], v[204:207], v[144:159]
    ds_read_b128 v[168:171], v9 offset:0
    v_mfma_f32_32x32x16_bf16 v[64:79], v[228:231], v[208:211], v[64:79]
    ds_read_b128 v[172:175], v9 offset:4096
    ds_read_b64_tr_b16 v[188:189], v2 offset:46336
    v_mfma_f32_32x32x16_bf16 v[80:95], v[228:231], v[212:215], v[80:95]
    ds_read_b64_tr_b16 v[190:191], v2 offset:47616
    v_mfma_f32_32x32x16_bf16 v[96:111], v[232:235], v[208:211], v[96:111]
    ds_read_b64_tr_b16 v[192:193], v2 offset:46368
    ds_read_b64_tr_b16 v[194:195], v2 offset:47648
    v_mfma_f32_32x32x16_bf16 v[112:127], v[232:235], v[212:215], v[112:127]
    ds_read_b64_tr_b16 v[196:197], v2 offset:46400
    v_mfma_f32_32x32x16_bf16 v[128:143], v[236:239], v[208:211], v[128:143]
    ds_read_b64_tr_b16 v[198:199], v2 offset:47680
    v_mfma_f32_32x32x16_bf16 v[144:159], v[236:239], v[212:215], v[144:159]
    s_add_u32 m0, s74, 20608
    s_add_u32 s64, s71, 0
    buffer_load_dwordx4 v14, s[40:43], s64 offen lds
    s_add_u32 m0, s74, 21632
    s_add_u32 s64, s71, 4096
    buffer_load_dwordx4 v14, s[40:43], s64 offen lds
    s_add_u32 m0, s74, 139904
    s_add_u32 s64, s71, 16384
    buffer_load_dwordx4 v14, s[40:43], s64 offen lds
    s_add_u32 m0, s74, 140928
    s_add_u32 s64, s71, 20480
    buffer_load_dwordx4 v14, s[40:43], s64 offen lds
    s_lshr_b32 s64, s2, 3
    s_lshl_b32 s64, s64, 2
    s_add_u32 s64, s64, s53
    s_lshl_b32 s64, s64, 14
    s_mov_b32 exec_lo, 0x0
    s_mov_b32 exec_hi, 0xff00
    buffer_load_dword v62, v63, s[40:43], s64 offen
    s_mov_b64 exec, -1
    s_waitcnt lgkmcnt(0)
    s_barrier
    v_mfma_f32_32x32x16_bf16 v[64:79], v[176:179], v[160:163], v[64:79]
    ds_read_b128 v[200:203], v10 offset:0
    ds_read_b128 v[204:207], v10 offset:4096
    v_mfma_f32_32x32x16_bf16 v[80:95], v[176:179], v[164:167], v[80:95]
    ds_read_b64_tr_b16 v[216:217], v3 offset:0
    v_mfma_f32_32x32x16_bf16 v[96:111], v[180:183], v[160:163], v[96:111]
    ds_read_b64_tr_b16 v[218:219], v3 offset:1280
    ds_read_b64_tr_b16 v[220:221], v3 offset:32
    v_mfma_f32_32x32x16_bf16 v[112:127], v[180:183], v[164:167], v[112:127]
    ds_read_b64_tr_b16 v[222:223], v3 offset:1312
    v_mfma_f32_32x32x16_bf16 v[128:143], v[184:187], v[160:163], v[128:143]
    ds_read_b64_tr_b16 v[224:225], v3 offset:64
    ds_read_b64_tr_b16 v[226:227], v3 offset:1344
    v_mfma_f32_32x32x16_bf16 v[144:159], v[184:187], v[164:167], v[144:159]
    ds_read_b128 v[208:211], v11 offset:0
    v_mfma_f32_32x32x16_bf16 v[64:79], v[188:191], v[168:171], v[64:79]
    ds_read_b128 v[212:215], v11 offset:4096
    ds_read_b64_tr_b16 v[228:229], v3 offset:5120
    v_mfma_f32_32x32x16_bf16 v[80:95], v[188:191], v[172:175], v[80:95]
    ds_read_b64_tr_b16 v[230:231], v3 offset:6400
    v_mfma_f32_32x32x16_bf16 v[96:111], v[192:195], v[168:171], v[96:111]
    ds_read_b64_tr_b16 v[232:233], v3 offset:5152
    ds_read_b64_tr_b16 v[234:235], v3 offset:6432
    v_mfma_f32_32x32x16_bf16 v[112:127], v[192:195], v[172:175], v[112:127]
    ds_read_b64_tr_b16 v[236:237], v3 offset:5184
    v_mfma_f32_32x32x16_bf16 v[128:143], v[196:199], v[168:171], v[128:143]
    ds_read_b64_tr_b16 v[238:239], v3 offset:6464
    v_mfma_f32_32x32x16_bf16 v[144:159], v[196:199], v[172:175], v[144:159]
    s_add_u32 m0, s74, 36992
    s_add_u32 s64, s71, 32768
    buffer_load_dwordx4 v14, s[40:43], s64 offen lds
    s_add_u32 m0, s74, 38016
    s_add_u32 s64, s71, 36864
    buffer_load_dwordx4 v14, s[40:43], s64 offen lds
    s_lshr_b32 s64, s2, 3
    s_lshl_b32 s64, s64, 2
    s_add_u32 s64, s64, s53
    s_lshl_b32 s64, s64, 14
    s_mov_b32 exec_lo, 0x0
    s_mov_b32 exec_hi, 0xff0000
    buffer_load_dword v62, v63, s[40:43], s64 offen
    s_mov_b64 exec, -1
    s_waitcnt vmcnt(15) lgkmcnt(0)
    s_barrier
    v_mfma_f32_32x32x16_bf16 v[64:79], v[216:219], v[200:203], v[64:79]
    ds_read_b128 v[160:163], v8 offset:18432
    ds_read_b128 v[164:167], v8 offset:22528
    ds_read_b64_tr_b16 v[176:177], v3 offset:20608
    v_mfma_f32_32x32x16_bf16 v[80:95], v[216:219], v[204:207], v[80:95]
    ds_read_b64_tr_b16 v[178:179], v3 offset:21888
    ds_read_b64_tr_b16 v[180:181], v3 offset:20640
    v_mfma_f32_32x32x16_bf16 v[96:111], v[220:223], v[200:203], v[96:111]
    ds_read_b64_tr_b16 v[182:183], v3 offset:21920
    ds_read_b64_tr_b16 v[184:185], v3 offset:20672
    ds_read_b64_tr_b16 v[186:187], v3 offset:21952
    v_mfma_f32_32x32x16_bf16 v[112:127], v[220:223], v[204:207], v[112:127]
    ds_read_b128 v[168:171], v9 offset:18432
    ds_read_b128 v[172:175], v9 offset:22528
    v_mfma_f32_32x32x16_bf16 v[128:143], v[224:227], v[200:203], v[128:143]
    ds_read_b64_tr_b16 v[188:189], v3 offset:25728
    ds_read_b64_tr_b16 v[190:191], v3 offset:27008
    v_mfma_f32_32x32x16_bf16 v[144:159], v[224:227], v[204:207], v[144:159]
    ds_read_b64_tr_b16 v[192:193], v3 offset:25760
    ds_read_b64_tr_b16 v[194:195], v3 offset:27040
    ds_read_b64_tr_b16 v[196:197], v3 offset:25792
    v_mfma_f32_32x32x16_bf16 v[64:79], v[228:231], v[208:211], v[64:79]
    ds_read_b64_tr_b16 v[198:199], v3 offset:27072
    s_waitcnt vmcnt(9)
    v_cmp_ne_u32 s[10:11], s56, v27
    v_cmp_ne_u32 vcc, s56, v31
    s_or_b64 s[10:11], s[10:11], vcc
    v_cmp_ne_u32 vcc, s56, v35
    s_or_b64 s[10:11], s[10:11], vcc
    v_cmp_ne_u32 vcc, s56, v39
    s_or_b64 s[10:11], s[10:11], vcc
    v_cmp_ne_u32 vcc, s55, v59
    s_or_b64 s[10:11], s[10:11], vcc
    s_cmp_lg_u64 s[10:11], 0
    s_cbranch_scc1 RffnA_retry
RffnA_recok:
    v_mfma_f32_32x32x16_bf16 v[80:95], v[228:231], v[212:215], v[80:95]
    v_add_f32 v24, v24, v28
    v_add_f32 v32, v32, v36
    v_add_f32 v25, v25, v29
    v_add_f32 v33, v33, v37
    v_add_f32 v26, v26, v30
    v_add_f32 v34, v34, v38
    v_mfma_f32_32x32x16_bf16 v[96:111], v[232:235], v[208:211], v[96:111]
    v_add_f32 v24, v24, v32
    v_add_f32 v25, v25, v33
    v_add_f32 v26, v26, v34
    v_mov_b32 v28, v24
    v_mov_b32 v29, v25
    v_mov_b32 v30, v26
    s_add_u32 s66, s52, 0
    s_lshl_b32 s66, s66, 10
    s_lshl_b32 s67, s51, 9
    s_add_u32 s67, s67, s66
    s_add_u32 s67, s67, 158592
    v_permlane32_swap_b32 v24, v28
    v_permlane32_swap_b32 v25, v29
    v_permlane32_swap_b32 v26, v30
    v_and_b32 v40, 31, v1
    v_lshlrev_b32 v40, 4, v40
    v_mfma_f32_32x32x16_bf16 v[112:127], v[232:235], v[212:215], v[112:127]
    v_add_f32 v24, v24, v28
    v_add_f32 v25, v25, v29
    v_add_f32 v26, v26, v30
    v_add_u32 v41, s67, v40
    ds_write_b128 v41, v[24:27]
    v_lshrrev_b32 v42, 5, v1
    v_lshlrev_b32 v42, 9, v42
    v_add_u32 v42, v42, v40
    s_add_u32 s66, s66, 158592
    v_add_u32 v42, s66, v42
    v_mfma_f32_32x32x16_bf16 v[128:143], v[236:239], v[208:211], v[128:143]
    v_mov_b32 v28, v56
    v_mov_b32 v29, v57
    v_mov_b32 v30, v56
    v_mov_b32 v31, v57
    s_nop 0
    v_permlane32_swap_b32 v28, v30
    v_permlane32_swap_b32 v29, v31
    v_mfma_f32_32x32x16_bf16 v[144:159], v[236:239], v[212:215], v[144:159]
    s_add_u32 m0, s74, 53376
    s_add_u32 s64, s71, 49152
    buffer_load_dwordx4 v14, s[40:43], s64 offen lds
    s_add_u32 m0, s74, 54400
    s_add_u32 s64, s71, 53248
    buffer_load_dwordx4 v14, s[40:43], s64 offen lds
    s_lshr_b32 s64, s2, 3
    s_lshl_b32 s64, s64, 2
    s_add_u32 s64, s64, s53
    s_lshl_b32 s64, s64, 14
    s_mov_b32 exec_lo, 0x0
    s_mov_b32 exec_hi, 0xff000000
    buffer_load_dword v62, v63, s[40:43], s64 offen
    s_mov_b64 exec, -1
    s_waitcnt lgkmcnt(0)
    s_barrier
    v_mfma_f32_32x32x16_bf16 v[64:79], v[176:179], v[160:163], v[64:79]
    ds_read_b128 v[200:203], v10 offset:18432
    ds_read_b128 v[204:207], v10 offset:22528
    v_mfma_f32_32x32x16_bf16 v[80:95], v[176:179], v[164:167], v[80:95]
    ds_read_b64_tr_b16 v[216:217], v2 offset:0
    ds_read_b64_tr_b16 v[218:219], v2 offset:1280
    v_mfma_f32_32x32x16_bf16 v[96:111], v[180:183], v[160:163], v[96:111]
    ds_read_b64_tr_b16 v[220:221], v2 offset:32
    v_mfma_f32_32x32x16_bf16 v[112:127], v[180:183], v[164:167], v[112:127]
    ds_read_b64_tr_b16 v[222:223], v2 offset:1312
    ds_read_b64_tr_b16 v[224:225], v2 offset:64
    v_mfma_f32_32x32x16_bf16 v[128:143], v[184:187], v[160:163], v[128:143]
    ds_read_b64_tr_b16 v[226:227], v2 offset:1344
    v_mfma_f32_32x32x16_bf16 v[144:159], v[184:187], v[164:167], v[144:159]
    ds_read_b128 v[208:211], v11 offset:18432
    ds_read_b128 v[212:215], v11 offset:22528
    v_mfma_f32_32x32x16_bf16 v[64:79], v[188:191], v[168:171], v[64:79]
    ds_read_b64_tr_b16 v[228:229], v2 offset:5120
    v_mfma_f32_32x32x16_bf16 v[80:95], v[188:191], v[172:175], v[80:95]
    ds_read_b64_tr_b16 v[230:231], v2 offset:6400
    ds_read_b64_tr_b16 v[232:233], v2 offset:5152
    v_mfma_f32_32x32x16_bf16 v[96:111], v[192:195], v[168:171], v[96:111]
    ds_read_b64_tr_b16 v[234:235], v2 offset:6432
    v_mfma_f32_32x32x16_bf16 v[112:127], v[192:195], v[172:175], v[112:127]
    ds_read_b64_tr_b16 v[236:237], v2 offset:5184
    ds_read_b64_tr_b16 v[238:239], v2 offset:6464
    v_mfma_f32_32x32x16_bf16 v[128:143], v[196:199], v[168:171], v[128:143]
    ds_read_b128 v[24:27], v42
    v_mfma_f32_32x32x16_bf16 v[144:159], v[196:199], v[172:175], v[144:159]
    s_add_u32 m0, s74, 69760
    s_add_u32 s64, s71, 65536
    buffer_load_dwordx4 v14, s[40:43], s64 offen lds
    s_add_u32 m0, s74, 70784
    s_add_u32 s64, s71, 69632
    buffer_load_dwordx4 v14, s[40:43], s64 offen lds
    s_add_u32 m0, s74, 86144
    s_add_u32 s64, s71, 81920
    buffer_load_dwordx4 v14, s[40:43], s64 offen lds
    s_add_u32 m0, s74, 87168
    s_add_u32 s64, s71, 86016
    buffer_load_dwordx4 v14, s[40:43], s64 offen lds
    s_lshr_b32 s64, s2, 3
    s_lshl_b32 s64, s64, 14
    s_lshl_b32 s65, s53, 4
    s_lshl_b64 exec, 0xffff, s65
    buffer_load_dword v62, v63, s[36:39], s64 offen
    s_mov_b64 exec, -1
    s_or_b32 s64, s48, s50
    s_cmp_lg_u32 s64, 0
    s_cbranch_scc1 RffnA_nobump_71
    s_lshl_b32 s64, s54, 7
    s_add_u32 s64, s64, 0x999000
    v_mov_b32 v15, s56
    s_mov_b64 exec, 1
    buffer_store_dword v15, off, s[32:35], s64 sc1
    s_mov_b64 exec, -1
RffnA_nobump_71:
    s_waitcnt lgkmcnt(0)
    s_barrier
    v_mfma_f32_32x32x16_bf16 v[64:79], v[216:219], v[200:203], v[64:79]
    v_sub_f32 v41, 0, v28
    v_cvt_pk_bf16_f32 v40, v41, v41
    v_and_b32 v40, 0xffff0000, v40
    v_sub_f32 v40, v41, v40
    v_cvt_pk_bf16_f32 v160, v41, v40
    v_mov_b32 v161, v160
    v_mov_b32 v162, 0
    v_mov_b32 v163, 0
    v_mfma_f32_32x32x16_bf16 v[80:95], v[216:219], v[204:207], v[80:95]
    v_mfma_f32_32x32x16_bf16 v[96:111], v[220:223], v[200:203], v[96:111]
    v_sub_f32 v41, 0, v30
    v_cvt_pk_bf16_f32 v40, v41, v41
    v_and_b32 v40, 0xffff0000, v40
    v_sub_f32 v40, v41, v40
    v_cvt_pk_bf16_f32 v164, v41, v40
    v_mov_b32 v165, v164
    v_mov_b32 v166, 0
    v_mov_b32 v167, 0
    v_mfma_f32_32x32x16_bf16 v[112:127], v[220:223], v[204:207], v[112:127]
    v_mfma_f32_32x32x16_bf16 v[128:143], v[224:227], v[200:203], v[128:143]
    v_cvt_pk_bf16_f32 v176, v24, v24
    v_and_b32 v40, 0xffff0000, v176
    v_sub_f32 v40, v24, v40
    v_cvt_pk_bf16_f32 v177, v40, v40
    v_mov_b32 v178, 0
    v_mov_b32 v179, 0
    v_mfma_f32_32x32x16_bf16 v[144:159], v[224:227], v[204:207], v[144:159]
    v_mfma_f32_32x32x16_bf16 v[64:79], v[228:231], v[208:211], v[64:79]
    v_cvt_pk_bf16_f32 v180, v25, v25
    v_and_b32 v40, 0xffff0000, v180
    v_sub_f32 v40, v25, v40
    v_cvt_pk_bf16_f32 v181, v40, v40
    v_mov_b32 v182, 0
    v_mov_b32 v183, 0
    v_mfma_f32_32x32x16_bf16 v[80:95], v[228:231], v[212:215], v[80:95]
    v_mfma_f32_32x32x16_bf16 v[96:111], v[232:235], v[208:211], v[96:111]
    v_cvt_pk_bf16_f32 v184, v26, v26
    v_and_b32 v40, 0xffff0000, v184
    v_sub_f32 v40, v26, v40
    v_cvt_pk_bf16_f32 v185, v40, v40
    v_mov_b32 v186, 0
    v_mov_b32 v187, 0
    v_mfma_f32_32x32x16_bf16 v[112:127], v[232:235], v[212:215], v[112:127]
    v_mfma_f32_32x32x16_bf16 v[128:143], v[236:239], v[208:211], v[128:143]
    v_mfma_f32_32x32x16_bf16 v[144:159], v[236:239], v[212:215], v[144:159]
    s_add_u32 m0, s74, 102528
    s_add_u32 s64, s71, 98304
    buffer_load_dwordx4 v14, s[40:43], s64 offen lds
    s_add_u32 m0, s74, 103552
    s_add_u32 s64, s71, 102400
    buffer_load_dwordx4 v14, s[40:43], s64 offen lds
    s_setprio 3
    v_mfma_f32_32x32x16_bf16 v[64:79], v[176:179], v[160:163], v[64:79]
    v_mfma_f32_32x32x16_bf16 v[80:95], v[176:179], v[164:167], v[80:95]
    v_mfma_f32_32x32x16_bf16 v[96:111], v[180:183], v[160:163], v[96:111]
    v_mfma_f32_32x32x16_bf16 v[112:127], v[180:183], v[164:167], v[112:127]
    v_mfma_f32_32x32x16_bf16 v[128:143], v[184:187], v[160:163], v[128:143]
    v_mfma_f32_32x32x16_bf16 v[144:159], v[184:187], v[164:167], v[144:159]
    v_lshrrev_b32 v16, 4, v1
    v_bfe_u32 v17, v1, 2, 2
    v_and_b32 v18, 3, v1
    v_lshrrev_b32 v5, 1, v16
    v_lshlrev_b32 v5, 3, v5
    v_add_u32 v5, v5, v17
    v_lshlrev_b32 v5, 7, v5
    v_lshrrev_b32 v17, 1, v17
    v_lshlrev_b32 v17, 6, v17
    v_add_u32 v5, v5, v17
    v_and_b32 v16, 1, v16
    v_lshlrev_b32 v16, 5, v16
    v_add_u32 v5, v5, v16
    v_lshlrev_b32 v18, 3, v18
    v_add_u32 v5, v5, v18
    v_add_u32 v2, s74, v5
    v_lshlrev_b32 v3, 4, v1
    s_lshl_b32 s64, s15, 16
    s_lshl_b32 s65, s70, 7
    s_add_u32 s75, s64, s65
    s_lshl_b32 s64, s15, 12
    s_add_u32 s76, s72, s64
    s_mul_i32 s64, s15, 10240
    s_add_u32 s72, s72, s64
    s_add_u32 s72, s72, 65536
    s_lshl_b32 s77, s69, 10
    s_add_u32 s77, s77, 0x990000
    s_lshl_b32 s64, s15, 7
    s_add_u32 s77, s77, s64
    v_and_b32 v12, 7, v1
    v_lshlrev_b32 v12, 2, v12
    v_bfe_u32 v13, v1, 3, 1
    v_lshlrev_b32 v13, 7, v13
    v_add_u32 v12, v12, v13
    s_lshl_b32 s65, s48, 2
    s_lshl_b32 s66, s51, 1
    s_add_u32 s65, s65, s66
    s_mul_i32 s65, s65, 147456
    s_mul_i32 s66, s49, 10
    s_add_u32 s66, s66, 64
    s_mul_i32 s67, s52, 3
    s_add_u32 s66, s66, s67
    s_lshl_b32 s66, s66, 10
    s_add_u32 s67, s65, s66
    v_mul_f32 v40, v29, v29
    v_mul_f32 v42, v31, v31
    v_lshlrev_b32 v44, 4, v1
    v_pk_mul_f32 v[64:65], v[64:65], v[72:73]
    v_pk_mul_f32 v[66:67], v[66:67], v[74:75]
    v_pk_mul_f32 v[68:69], v[68:69], v[76:77]
    v_pk_mul_f32 v[70:71], v[70:71], v[78:79]
    v_pk_mul_f32 v[64:65], v[64:65], v[40:41] op_sel_hi:[1,0]
    v_pk_mul_f32 v[66:67], v[66:67], v[40:41] op_sel_hi:[1,0]
    v_pk_mul_f32 v[68:69], v[68:69], v[40:41] op_sel_hi:[1,0]
    v_pk_mul_f32 v[70:71], v[70:71], v[40:41] op_sel_hi:[1,0]
    v_cvt_pk_bf16_f32 v72, v64, v65
    v_cvt_pk_bf16_f32 v73, v66, v67
    v_cvt_pk_bf16_f32 v74, v68, v69
    v_cvt_pk_bf16_f32 v75, v70, v71
    s_add_u32 s64, s67, 0
    buffer_store_dwordx4 v[72:75], v44, s[32:35], s64 offen sc1
    v_pk_mul_f32 v[80:81], v[80:81], v[88:89]
    v_pk_mul_f32 v[82:83], v[82:83], v[90:91]
    v_pk_mul_f32 v[84:85], v[84:85], v[92:93]
    v_pk_mul_f32 v[86:87], v[86:87], v[94:95]
    v_pk_mul_f32 v[80:81], v[80:81], v[42:43] op_sel_hi:[1,0]
    v_pk_mul_f32 v[82:83], v[82:83], v[42:43] op_sel_hi:[1,0]
    v_pk_mul_f32 v[84:85], v[84:85], v[42:43] op_sel_hi:[1,0]
    v_pk_mul_f32 v[86:87], v[86:87], v[42:43] op_sel_hi:[1,0]
    v_cvt_pk_bf16_f32 v88, v80, v81
    v_cvt_pk_bf16_f32 v89, v82, v83
    v_cvt_pk_bf16_f32 v90, v84, v85
    v_cvt_pk_bf16_f32 v91, v86, v87
    s_add_u32 s64, s67, 147456
    buffer_store_dwordx4 v[88:91], v44, s[32:35], s64 offen sc1
    v_pk_mul_f32 v[96:97], v[96:97], v[104:105]
    v_pk_mul_f32 v[98:99], v[98:99], v[106:107]
    v_pk_mul_f32 v[100:101], v[100:101], v[108:109]
    v_pk_mul_f32 v[102:103], v[102:103], v[110:111]
    v_pk_mul_f32 v[96:97], v[96:97], v[40:41] op_sel_hi:[1,0]
    v_pk_mul_f32 v[98:99], v[98:99], v[40:41] op_sel_hi:[1,0]
    v_pk_mul_f32 v[100:101], v[100:101], v[40:41] op_sel_hi:[1,0]
    v_pk_mul_f32 v[102:103], v[102:103], v[40:41] op_sel_hi:[1,0]
    v_cvt_pk_bf16_f32 v104, v96, v97
    v_cvt_pk_bf16_f32 v105, v98, v99
    v_cvt_pk_bf16_f32 v106, v100, v101
    v_cvt_pk_bf16_f32 v107, v102, v103
    s_add_u32 s64, s67, 1024
    buffer_store_dwordx4 v[104:107], v44, s[32:35], s64 offen sc1
    v_pk_mul_f32 v[112:113], v[112:113], v[120:121]
    v_pk_mul_f32 v[114:115], v[114:115], v[122:123]
    v_pk_mul_f32 v[116:117], v[116:117], v[124:125]
    v_pk_mul_f32 v[118:119], v[118:119], v[126:127]
    v_pk_mul_f32 v[112:113], v[112:113], v[42:43] op_sel_hi:[1,0]
    v_pk_mul_f32 v[114:115], v[114:115], v[42:43] op_sel_hi:[1,0]
    v_pk_mul_f32 v[116:117], v[116:117], v[42:43] op_sel_hi:[1,0]
    v_pk_mul_f32 v[118:119], v[118:119], v[42:43] op_sel_hi:[1,0]
    v_cvt_pk_bf16_f32 v120, v112, v113
    v_cvt_pk_bf16_f32 v121, v114, v115
    v_cvt_pk_bf16_f32 v122, v116, v117
    v_cvt_pk_bf16_f32 v123, v118, v119
    s_add_u32 s64, s67, 148480
    buffer_store_dwordx4 v[120:123], v44, s[32:35], s64 offen sc1
    v_pk_mul_f32 v[128:129], v[128:129], v[136:137]
    v_pk_mul_f32 v[130:131], v[130:131], v[138:139]
    v_pk_mul_f32 v[132:133], v[132:133], v[140:141]
    v_pk_mul_f32 v[134:135], v[134:135], v[142:143]
    v_pk_mul_f32 v[128:129], v[128:129], v[40:41] op_sel_hi:[1,0]
    v_pk_mul_f32 v[130:131], v[130:131], v[40:41] op_sel_hi:[1,0]
    v_pk_mul_f32 v[132:133], v[132:133], v[40:41] op_sel_hi:[1,0]
    v_pk_mul_f32 v[134:135], v[134:135], v[40:41] op_sel_hi:[1,0]
    v_cvt_pk_bf16_f32 v136, v128, v129
    v_cvt_pk_bf16_f32 v137, v130, v131
    v_cvt_pk_bf16_f32 v138, v132, v133
    v_cvt_pk_bf16_f32 v139, v134, v135
    s_add_u32 s64, s67, 2048
    buffer_store_dwordx4 v[136:139], v44, s[32:35], s64 offen sc1
    v_pk_mul_f32 v[144:145], v[144:145], v[152:153]
    v_pk_mul_f32 v[146:147], v[146:147], v[154:155]
    v_pk_mul_f32 v[148:149], v[148:149], v[156:157]
    v_pk_mul_f32 v[150:151], v[150:151], v[158:159]
    v_pk_mul_f32 v[144:145], v[144:145], v[42:43] op_sel_hi:[1,0]
    v_pk_mul_f32 v[146:147], v[146:147], v[42:43] op_sel_hi:[1,0]
    v_pk_mul_f32 v[148:149], v[148:149], v[42:43] op_sel_hi:[1,0]
    v_pk_mul_f32 v[150:151], v[150:151], v[42:43] op_sel_hi:[1,0]
    v_cvt_pk_bf16_f32 v152, v144, v145
    v_cvt_pk_bf16_f32 v153, v146, v147
    v_cvt_pk_bf16_f32 v154, v148, v149
    v_cvt_pk_bf16_f32 v155, v150, v151
    s_add_u32 s64, s67, 149504
    buffer_store_dwordx4 v[152:155], v44, s[32:35], s64 offen sc1
    s_waitcnt vmcnt(6)
    v_add_u32 v6, 20608, v2
    v_xor_b32 v7, 64, v6
    ds_read_b64_tr_b16 v[80:81], v6 offset:0
    ds_read_b64_tr_b16 v[82:83], v6 offset:512
    ds_read_b64_tr_b16 v[84:85], v7 offset:0
    ds_read_b64_tr_b16 v[86:87], v7 offset:512
    v_add_u32 v6, 139904, v2
    v_xor_b32 v7, 64, v6
    ds_read_b64_tr_b16 v[88:89], v6 offset:0
    ds_read_b64_tr_b16 v[90:91], v6 offset:512
    ds_read_b64_tr_b16 v[92:93], v7 offset:0
    ds_read_b64_tr_b16 v[94:95], v7 offset:512
    v_add_u32 v6, 36992, v2
    v_xor_b32 v7, 64, v6
    ds_read_b64_tr_b16 v[96:97], v6 offset:0
    ds_read_b64_tr_b16 v[98:99], v6 offset:512
    ds_read_b64_tr_b16 v[100:101], v7 offset:0
    ds_read_b64_tr_b16 v[102:103], v7 offset:512
    v_add_u32 v6, 53376, v2
    v_xor_b32 v7, 64, v6
    ds_read_b64_tr_b16 v[104:105], v6 offset:0
    ds_read_b64_tr_b16 v[106:107], v6 offset:512
    ds_read_b64_tr_b16 v[108:109], v7 offset:0
    ds_read_b64_tr_b16 v[110:111], v7 offset:512
    v_add_u32 v6, 69760, v2
    v_xor_b32 v7, 64, v6
    ds_read_b64_tr_b16 v[112:113], v6 offset:0
    ds_read_b64_tr_b16 v[114:115], v6 offset:512
    ds_read_b64_tr_b16 v[116:117], v7 offset:0
    ds_read_b64_tr_b16 v[118:119], v7 offset:512
    v_add_u32 v6, 86144, v2
    v_xor_b32 v7, 64, v6
    ds_read_b64_tr_b16 v[120:121], v6 offset:0
    ds_read_b64_tr_b16 v[122:123], v6 offset:512
    ds_read_b64_tr_b16 v[124:125], v7 offset:0
    ds_read_b64_tr_b16 v[126:127], v7 offset:512
    v_add_u32 v6, 102528, v2
    v_xor_b32 v7, 64, v6
    ds_read_b64_tr_b16 v[128:129], v6 offset:0
    ds_read_b64_tr_b16 v[130:131], v6 offset:512
    ds_read_b64_tr_b16 v[132:133], v7 offset:0
    ds_read_b64_tr_b16 v[134:135], v7 offset:512
    s_waitcnt lgkmcnt(0)
    s_barrier
    v_and_b32 v4, 31, v1
    v_lshlrev_b32 v4, 11, v4
    v_lshrrev_b32 v5, 5, v1
    v_lshlrev_b32 v5, 4, v5
    v_add_u32 v4, v4, v5
    s_lshl_b32 s73, s69, 16
    s_and_b32 s64, s50, 1
    s_lshl_b32 s64, s64, 10
    s_add_u32 s73, s73, s64
    s_lshl_b32 s64, s70, 7
    s_add_u32 s73, s73, s64
    s_lshr_b32 s64, s50, 1
    s_lshl_b32 s64, s64, 5
    s_add_u32 s73, s73, s64
    buffer_load_dwordx4 v[8:11], v4, s[16:19], s73 offen
    v_lshlrev_b32 v0, 11, v1
    v_add_u32 v0, 149488, v0
    s_waitcnt vmcnt(1)
    s_lshl_b32 s64, s48, 1
    s_add_u32 s64, s64, s51
    s_lshl_b32 s64, s64, 3
    s_add_u32 s64, s64, s49
    s_lshl_b32 s64, s64, 5
    s_add_u32 s64, s64, s52
    s_lshl_b32 s64, s64, 2
    s_add_u32 s64, s64, 0x990000
    v_mov_b32 v15, s55
    s_mov_b64 exec, 1
    buffer_store_dword v15, off, s[32:35], s64 sc1
    s_mov_b64 exec, -1
    s_setprio 0
    s_add_u32 m0, s74, 20608
    s_add_u32 s64, s71, 114688
    buffer_load_dwordx4 v14, s[40:43], s64 offen lds
    s_add_u32 m0, s74, 21632
    s_add_u32 s64, s71, 118784
    buffer_load_dwordx4 v14, s[40:43], s64 offen lds
    s_add_u32 m0, s74, 139904
    s_add_u32 s64, s71, 131072
    buffer_load_dwordx4 v14, s[40:43], s64 offen lds
    s_add_u32 m0, s74, 140928
    s_add_u32 s64, s71, 135168
    buffer_load_dwordx4 v14, s[40:43], s64 offen lds
    s_add_u32 m0, s74, 36992
    s_add_u32 s64, s71, 147456
    buffer_load_dwordx4 v14, s[40:43], s64 offen lds
    s_add_u32 m0, s74, 38016
    s_add_u32 s64, s71, 151552
    buffer_load_dwordx4 v14, s[40:43], s64 offen lds
    s_add_u32 m0, s74, 53376
    s_add_u32 s64, s75, 0
    buffer_load_dwordx4 v14, s[40:43], s64 offen lds
    s_add_u32 m0, s74, 54400
    s_add_u32 s64, s75, 4096
    buffer_load_dwordx4 v14, s[40:43], s64 offen lds
    s_add_u32 m0, s74, 69760
    s_add_u32 s64, s75, 16384
    buffer_load_dwordx4 v14, s[40:43], s64 offen lds
    s_add_u32 m0, s74, 70784
    s_add_u32 s64, s75, 20480
    buffer_load_dwordx4 v14, s[40:43], s64 offen lds
    s_add_u32 m0, s74, 86144
    s_add_u32 s64, s75, 32768
    buffer_load_dwordx4 v14, s[40:43], s64 offen lds
    s_add_u32 m0, s74, 87168
    s_add_u32 s64, s75, 36864
    buffer_load_dwordx4 v14, s[40:43], s64 offen lds
    s_add_u32 m0, s74, 102528
    s_add_u32 s64, s75, 49152
    buffer_load_dwordx4 v14, s[40:43], s64 offen lds
    s_add_u32 m0, s74, 103552
    s_add_u32 s64, s75, 53248
    buffer_load_dwordx4 v14, s[40:43], s64 offen lds
    s_mov_b64 exec, 0xff
    buffer_load_dword v13, v12, s[32:35], s77 offen sc1
    s_mov_b64 exec, -1
    s_waitcnt vmcnt(7)
    v_add_u32 v6, 20608, v2
    v_xor_b32 v7, 64, v6
    ds_read_b64_tr_b16 v[136:137], v6 offset:0
    ds_read_b64_tr_b16 v[138:139], v6 offset:512
    ds_read_b64_tr_b16 v[140:141], v7 offset:0
    ds_read_b64_tr_b16 v[142:143], v7 offset:512
    v_add_u32 v6, 139904, v2
    v_xor_b32 v7, 64, v6
    ds_read_b64_tr_b16 v[144:145], v6 offset:0
    ds_read_b64_tr_b16 v[146:147], v6 offset:512
    ds_read_b64_tr_b16 v[148:149], v7 offset:0
    ds_read_b64_tr_b16 v[150:151], v7 offset:512
    v_add_u32 v6, 36992, v2
    v_xor_b32 v7, 64, v6
    ds_read_b64_tr_b16 v[152:153], v6 offset:0
    ds_read_b64_tr_b16 v[154:155], v6 offset:512
    ds_read_b64_tr_b16 v[156:157], v7 offset:0
    ds_read_b64_tr_b16 v[158:159], v7 offset:512
    v_add_u32 v6, 53376, v2
    v_xor_b32 v7, 64, v6
    ds_read_b64_tr_b16 v[160:161], v6 offset:0
    ds_read_b64_tr_b16 v[162:163], v6 offset:512
    ds_read_b64_tr_b16 v[164:165], v7 offset:0
    ds_read_b64_tr_b16 v[166:167], v7 offset:512
    s_waitcnt lgkmcnt(0)
    s_add_u32 m0, s74, 20608
    s_add_u32 s64, s75, 0
    buffer_load_dwordx4 v14, s[36:39], s64 offen lds
    s_add_u32 m0, s74, 21632
    s_add_u32 s64, s75, 4096
    buffer_load_dwordx4 v14, s[36:39], s64 offen lds
    s_add_u32 m0, s74, 139904
    s_add_u32 s64, s75, 16384
    buffer_load_dwordx4 v14, s[36:39], s64 offen lds
    s_add_u32 m0, s74, 140928
    s_add_u32 s64, s75, 20480
    buffer_load_dwordx4 v14, s[36:39], s64 offen lds
    s_add_u32 m0, s74, 36992
    s_add_u32 s64, s75, 32768
    buffer_load_dwordx4 v14, s[36:39], s64 offen lds
    s_add_u32 m0, s74, 38016
    s_add_u32 s64, s75, 36864
    buffer_load_dwordx4 v14, s[36:39], s64 offen lds
    s_add_u32 m0, s74, 53376
    s_add_u32 s64, s75, 49152
    buffer_load_dwordx4 v14, s[36:39], s64 offen lds
    s_add_u32 m0, s74, 54400
    s_add_u32 s64, s75, 53248
    buffer_load_dwordx4 v14, s[36:39], s64 offen lds
    s_waitcnt vmcnt(8)
    v_cmp_eq_u32 vcc, s55, v13
    s_and_b32 s64, vcc_lo, 0xf
    s_cmp_lg_u32 s64, 0xf
    s_cbranch_scc1 RffnA_psp_73
RffnA_pok_72:
    s_add_u32 s64, s72, 0
    buffer_load_dwordx4 v[184:187], v3, s[32:35], s64 offen sc1
    s_add_u32 s64, s72, 147456
    buffer_load_dwordx4 v[188:191], v3, s[32:35], s64 offen sc1
    s_add_u32 s64, s72, 1024
    buffer_load_dwordx4 v[192:195], v3, s[32:35], s64 offen sc1
    s_add_u32 s64, s72, 148480
    buffer_load_dwordx4 v[196:199], v3, s[32:35], s64 offen sc1
    s_add_u32 s64, s72, 2048
    buffer_load_dwordx4 v[200:203], v3, s[32:35], s64 offen sc1
    s_add_u32 s64, s72, 149504
    buffer_load_dwordx4 v[204:207], v3, s[32:35], s64 offen sc1
    s_add_u32 s64, s72, 3072
    buffer_load_dwordx4 v[208:211], v3, s[32:35], s64 offen sc1
    s_add_u32 s64, s72, 150528
    buffer_load_dwordx4 v[212:215], v3, s[32:35], s64 offen sc1
    s_add_u32 s64, s72, 4096
    buffer_load_dwordx4 v[216:219], v3, s[32:35], s64 offen sc1
    s_add_u32 s64, s72, 151552
    buffer_load_dwordx4 v[220:223], v3, s[32:35], s64 offen sc1
    s_mov_b64 exec, 0xff
    buffer_load_dword v13, v12, s[32:35], s77 offen sc1
    s_mov_b64 exec, -1
    s_add_u32 s64, s72, 5120
    buffer_load_dwordx4 v[224:227], v3, s[32:35], s64 offen sc1
    s_add_u32 s64, s72, 152576
    buffer_load_dwordx4 v[228:231], v3, s[32:35], s64 offen sc1
    s_add_u32 s64, s72, 6144
    buffer_load_dwordx4 v[232:235], v3, s[32:35], s64 offen sc1
    s_add_u32 s64, s72, 153600
    buffer_load_dwordx4 v[236:239], v3, s[32:35], s64 offen sc1
    s_add_u32 s64, s72, 7168
    buffer_load_dwordx4 v[240:243], v3, s[32:35], s64 offen sc1
    s_add_u32 s64, s72, 154624
    buffer_load_dwordx4 v[244:247], v3, s[32:35], s64 offen sc1
    s_add_u32 s64, s72, 8192
    buffer_load_dwordx4 v[248:251], v3, s[32:35], s64 offen sc1
    s_add_u32 s64, s72, 155648
    buffer_load_dwordx4 v[252:255], v3, s[32:35], s64 offen sc1
    s_waitcnt vmcnt(18)
    v_mfma_f32_32x32x16_bf16 v[16:31], v[80:83], v[184:187], 0
    v_mfma_f32_32x32x16_bf16 v[32:47], v[84:87], v[184:187], 0
    s_waitcnt vmcnt(17)
    v_mfma_f32_32x32x16_bf16 v[48:63], v[80:83], v[188:191], 0
    v_mfma_f32_32x32x16_bf16 v[64:79], v[84:87], v[188:191], 0
    s_add_u32 s64, s72, 9216
    buffer_load_dwordx4 v[184:187], v3, s[32:35], s64 offen sc1
    s_add_u32 s64, s72, 156672
    buffer_load_dwordx4 v[188:191], v3, s[32:35], s64 offen sc1
    s_waitcnt vmcnt(18)
    v_mfma_f32_32x32x16_bf16 v[16:31], v[88:91], v[192:195], v[16:31]
    v_mfma_f32_32x32x16_bf16 v[32:47], v[92:95], v[192:195], v[32:47]
    s_waitcnt vmcnt(17)
    v_mfma_f32_32x32x16_bf16 v[48:63], v[88:91], v[196:199], v[48:63]
    v_mfma_f32_32x32x16_bf16 v[64:79], v[92:95], v[196:199], v[64:79]
    s_waitcnt vmcnt(16)
    v_mfma_f32_32x32x16_bf16 v[16:31], v[96:99], v[200:203], v[16:31]
    v_mfma_f32_32x32x16_bf16 v[32:47], v[100:103], v[200:203], v[32:47]
    s_waitcnt vmcnt(15)
    v_mfma_f32_32x32x16_bf16 v[48:63], v[96:99], v[204:207], v[48:63]
    v_mfma_f32_32x32x16_bf16 v[64:79], v[100:103], v[204:207], v[64:79]
    s_waitcnt vmcnt(14)
    v_mfma_f32_32x32x16_bf16 v[16:31], v[104:107], v[208:211], v[16:31]
    v_mfma_f32_32x32x16_bf16 v[32:47], v[108:111], v[208:211], v[32:47]
    s_waitcnt vmcnt(13)
    v_mfma_f32_32x32x16_bf16 v[48:63], v[104:107], v[212:215], v[48:63]
    v_mfma_f32_32x32x16_bf16 v[64:79], v[108:111], v[212:215], v[64:79]
    s_waitcnt vmcnt(12)
    v_mfma_f32_32x32x16_bf16 v[16:31], v[112:115], v[216:219], v[16:31]
    v_mfma_f32_32x32x16_bf16 v[32:47], v[116:119], v[216:219], v[32:47]
    s_waitcnt vmcnt(11)
    v_mfma_f32_32x32x16_bf16 v[48:63], v[112:115], v[220:223], v[48:63]
    v_mfma_f32_32x32x16_bf16 v[64:79], v[116:119], v[220:223], v[64:79]
    s_waitcnt vmcnt(10)
    v_cmp_eq_u32 vcc, s55, v13
    s_and_b32 s64, vcc_lo, 0xf0
    s_cmp_lg_u32 s64, 0xf0
    s_cbranch_scc1 RffnA_psp_75
RffnA_pok_74:
    s_add_u32 s64, s76, 32768
    buffer_load_dwordx4 v[192:195], v3, s[32:35], s64 offen sc1
    s_add_u32 s64, s76, 180224
    buffer_load_dwordx4 v[196:199], v3, s[32:35], s64 offen sc1
    s_add_u32 s64, s76, 33792
    buffer_load_dwordx4 v[200:203], v3, s[32:35], s64 offen sc1
    s_add_u32 s64, s76, 181248
    buffer_load_dwordx4 v[204:207], v3, s[32:35], s64 offen sc1
    s_add_u32 s64, s76, 34816
    buffer_load_dwordx4 v[208:211], v3, s[32:35], s64 offen sc1
    s_add_u32 s64, s76, 182272
    buffer_load_dwordx4 v[212:215], v3, s[32:35], s64 offen sc1
    s_add_u32 s64, s76, 35840
    buffer_load_dwordx4 v[216:219], v3, s[32:35], s64 offen sc1
    s_add_u32 s64, s76, 183296
    buffer_load_dwordx4 v[220:223], v3, s[32:35], s64 offen sc1
    s_waitcnt vmcnt(17)
    v_mfma_f32_32x32x16_bf16 v[16:31], v[120:123], v[224:227], v[16:31]
    v_mfma_f32_32x32x16_bf16 v[32:47], v[124:127], v[224:227], v[32:47]
    s_waitcnt vmcnt(16)
    v_mfma_f32_32x32x16_bf16 v[48:63], v[120:123], v[228:231], v[48:63]
    v_mfma_f32_32x32x16_bf16 v[64:79], v[124:127], v[228:231], v[64:79]
    s_waitcnt vmcnt(15)
    v_mfma_f32_32x32x16_bf16 v[16:31], v[128:131], v[232:235], v[16:31]
    v_mfma_f32_32x32x16_bf16 v[32:47], v[132:135], v[232:235], v[32:47]
    s_waitcnt vmcnt(14)
    v_mfma_f32_32x32x16_bf16 v[48:63], v[128:131], v[236:239], v[48:63]
    v_mfma_f32_32x32x16_bf16 v[64:79], v[132:135], v[236:239], v[64:79]
    s_mov_b64 exec, 0x3
    buffer_load_dword v13, v0, s[32:35], s76 offen sc1
    s_mov_b64 exec, -1
    s_waitcnt vmcnt(14)
    v_mfma_f32_32x32x16_bf16 v[16:31], v[136:139], v[240:243], v[16:31]
    v_mfma_f32_32x32x16_bf16 v[32:47], v[140:143], v[240:243], v[32:47]
    s_waitcnt vmcnt(13)
    v_mfma_f32_32x32x16_bf16 v[48:63], v[136:139], v[244:247], v[48:63]
    v_mfma_f32_32x32x16_bf16 v[64:79], v[140:143], v[244:247], v[64:79]
    s_waitcnt vmcnt(12)
    v_mfma_f32_32x32x16_bf16 v[16:31], v[144:147], v[248:251], v[16:31]
    v_mfma_f32_32x32x16_bf16 v[32:47], v[148:151], v[248:251], v[32:47]
    s_waitcnt vmcnt(11)
    v_mfma_f32_32x32x16_bf16 v[48:63], v[144:147], v[252:255], v[48:63]
    v_mfma_f32_32x32x16_bf16 v[64:79], v[148:151], v[252:255], v[64:79]
    s_waitcnt vmcnt(0)
    v_cmp_ne_u32 vcc, -1, v13
    s_and_b32 s64, vcc_lo, 0x3
    s_cmp_lg_u32 s64, 0x3
    s_cbranch_scc1 RffnA_gsp_77
RffnA_gok_76:
    s_add_u32 s64, s76, 0
    buffer_load_dwordx4 v[224:227], v3, s[32:35], s64 offen sc1
    s_add_u32 s64, s76, 147456
    buffer_load_dwordx4 v[228:231], v3, s[32:35], s64 offen sc1
    s_add_u32 s64, s76, 1024
    buffer_load_dwordx4 v[232:235], v3, s[32:35], s64 offen sc1
    s_add_u32 s64, s76, 148480
    buffer_load_dwordx4 v[236:239], v3, s[32:35], s64 offen sc1
    s_add_u32 s64, s76, 2048
    buffer_load_dwordx4 v[240:243], v3, s[32:35], s64 offen sc1
    s_add_u32 s64, s76, 149504
    buffer_load_dwordx4 v[244:247], v3, s[32:35], s64 offen sc1
    s_add_u32 s64, s76, 3072
    buffer_load_dwordx4 v[248:251], v3, s[32:35], s64 offen sc1
    s_add_u32 s64, s76, 150528
    buffer_load_dwordx4 v[252:255], v3, s[32:35], s64 offen sc1
    v_mfma_f32_32x32x16_bf16 v[16:31], v[152:155], v[184:187], v[16:31]
    v_mfma_f32_32x32x16_bf16 v[32:47], v[156:159], v[184:187], v[32:47]
    v_mfma_f32_32x32x16_bf16 v[48:63], v[152:155], v[188:191], v[48:63]
    v_mfma_f32_32x32x16_bf16 v[64:79], v[156:159], v[188:191], v[64:79]
    v_add_u32 v6, 69760, v2
    v_xor_b32 v7, 64, v6
    ds_read_b64_tr_b16 v[176:177], v6 offset:0
    ds_read_b64_tr_b16 v[178:179], v6 offset:512
    ds_read_b64_tr_b16 v[180:181], v7 offset:0
    ds_read_b64_tr_b16 v[182:183], v7 offset:512
    v_mfma_f32_32x32x16_bf16 v[16:31], v[160:163], v[192:195], v[16:31]
    v_mfma_f32_32x32x16_bf16 v[32:47], v[164:167], v[192:195], v[32:47]
    v_mfma_f32_32x32x16_bf16 v[48:63], v[160:163], v[196:199], v[48:63]
    v_mfma_f32_32x32x16_bf16 v[64:79], v[164:167], v[196:199], v[64:79]
    s_waitcnt lgkmcnt(0)
    v_add_u32 v6, 86144, v2
    v_xor_b32 v7, 64, v6
    ds_read_b64_tr_b16 v[168:169], v6 offset:0
    ds_read_b64_tr_b16 v[170:171], v6 offset:512
    ds_read_b64_tr_b16 v[172:173], v7 offset:0
    ds_read_b64_tr_b16 v[174:175], v7 offset:512
    v_mfma_f32_32x32x16_bf16 v[16:31], v[176:179], v[200:203], v[16:31]
    v_mfma_f32_32x32x16_bf16 v[32:47], v[180:183], v[200:203], v[32:47]
    v_mfma_f32_32x32x16_bf16 v[48:63], v[176:179], v[204:207], v[48:63]
    v_mfma_f32_32x32x16_bf16 v[64:79], v[180:183], v[204:207], v[64:79]
    s_waitcnt lgkmcnt(0)
    v_add_u32 v6, 102528, v2
    v_xor_b32 v7, 64, v6
    ds_read_b64_tr_b16 v[176:177], v6 offset:0
    ds_read_b64_tr_b16 v[178:179], v6 offset:512
    ds_read_b64_tr_b16 v[180:181], v7 offset:0
    ds_read_b64_tr_b16 v[182:183], v7 offset:512
    v_mfma_f32_32x32x16_bf16 v[16:31], v[168:171], v[208:211], v[16:31]
    v_mfma_f32_32x32x16_bf16 v[32:47], v[172:175], v[208:211], v[32:47]
    v_mfma_f32_32x32x16_bf16 v[48:63], v[168:171], v[212:215], v[48:63]
    v_mfma_f32_32x32x16_bf16 v[64:79], v[172:175], v[212:215], v[64:79]
    s_waitcnt lgkmcnt(0)
    v_add_u32 v6, 20608, v2
    v_xor_b32 v7, 64, v6
    ds_read_b64_tr_b16 v[168:169], v6 offset:0
    ds_read_b64_tr_b16 v[170:171], v6 offset:512
    ds_read_b64_tr_b16 v[172:173], v7 offset:0
    ds_read_b64_tr_b16 v[174:175], v7 offset:512
    v_mfma_f32_32x32x16_bf16 v[16:31], v[176:179], v[216:219], v[16:31]
    v_mfma_f32_32x32x16_bf16 v[32:47], v[180:183], v[216:219], v[32:47]
    v_mfma_f32_32x32x16_bf16 v[48:63], v[176:179], v[220:223], v[48:63]
    v_mfma_f32_32x32x16_bf16 v[64:79], v[180:183], v[220:223], v[64:79]
    s_waitcnt vmcnt(6) lgkmcnt(0)
    v_max3_u32 v5, v224, v225, v226
    v_max3_u32 v15, v228, v229, v230
    v_max3_u32 v5, v5, v227, v231
    v_max_u32 v5, v5, v15
    v_cmp_eq_u32 vcc, -1, v5
    s_cbranch_vccnz RffnA_asp_79
RffnA_aok_78:
    v_add_u32 v6, 139904, v2
    v_xor_b32 v7, 64, v6
    ds_read_b64_tr_b16 v[176:177], v6 offset:0
    ds_read_b64_tr_b16 v[178:179], v6 offset:512
    ds_read_b64_tr_b16 v[180:181], v7 offset:0
    ds_read_b64_tr_b16 v[182:183], v7 offset:512
    v_mfma_f32_32x32x16_bf16 v[16:31], v[168:171], v[224:227], v[16:31]
    v_mfma_f32_32x32x16_bf16 v[32:47], v[172:175], v[224:227], v[32:47]
    v_mfma_f32_32x32x16_bf16 v[48:63], v[168:171], v[228:231], v[48:63]
    v_mfma_f32_32x32x16_bf16 v[64:79], v[172:175], v[228:231], v[64:79]
    s_waitcnt vmcnt(4) lgkmcnt(0)
    v_max3_u32 v5, v232, v233, v234
    v_max3_u32 v15, v236, v237, v238
    v_max3_u32 v5, v5, v235, v239
    v_max_u32 v5, v5, v15
    v_cmp_eq_u32 vcc, -1, v5
    s_cbranch_vccnz RffnA_asp_81
RffnA_aok_80:
    v_add_u32 v6, 36992, v2
    v_xor_b32 v7, 64, v6
    ds_read_b64_tr_b16 v[168:169], v6 offset:0
    ds_read_b64_tr_b16 v[170:171], v6 offset:512
    ds_read_b64_tr_b16 v[172:173], v7 offset:0
    ds_read_b64_tr_b16 v[174:175], v7 offset:512
    v_mfma_f32_32x32x16_bf16 v[16:31], v[176:179], v[232:235], v[16:31]
    v_mfma_f32_32x32x16_bf16 v[32:47], v[180:183], v[232:235], v[32:47]
    v_mfma_f32_32x32x16_bf16 v[48:63], v[176:179], v[236:239], v[48:63]
    v_mfma_f32_32x32x16_bf16 v[64:79], v[180:183], v[236:239], v[64:79]
    s_waitcnt vmcnt(2) lgkmcnt(0)
    v_max3_u32 v5, v240, v241, v242
    v_max3_u32 v15, v244, v245, v246
    v_max3_u32 v5, v5, v243, v247
    v_max_u32 v5, v5, v15
    v_cmp_eq_u32 vcc, -1, v5
    s_cbranch_vccnz RffnA_asp_83
RffnA_aok_82:
    v_add_u32 v6, 53376, v2
    v_xor_b32 v7, 64, v6
    ds_read_b64_tr_b16 v[176:177], v6 offset:0
    ds_read_b64_tr_b16 v[178:179], v6 offset:512
    ds_read_b64_tr_b16 v[180:181], v7 offset:0
    ds_read_b64_tr_b16 v[182:183], v7 offset:512
    v_mfma_f32_32x32x16_bf16 v[16:31], v[168:171], v[240:243], v[16:31]
    v_mfma_f32_32x32x16_bf16 v[32:47], v[172:175], v[240:243], v[32:47]
    v_mfma_f32_32x32x16_bf16 v[48:63], v[168:171], v[244:247], v[48:63]
    v_mfma_f32_32x32x16_bf16 v[64:79], v[172:175], v[244:247], v[64:79]
    s_waitcnt vmcnt(0) lgkmcnt(0)
    v_max3_u32 v5, v248, v249, v250
    v_max3_u32 v15, v252, v253, v254
    v_max3_u32 v5, v5, v251, v255
    v_max_u32 v5, v5, v15
    v_cmp_eq_u32 vcc, -1, v5
    s_cbranch_vccnz RffnA_asp_85
RffnA_aok_84:
    v_mfma_f32_32x32x16_bf16 v[16:31], v[176:179], v[248:251], v[16:31]
    v_mfma_f32_32x32x16_bf16 v[32:47], v[180:183], v[248:251], v[32:47]
    v_mfma_f32_32x32x16_bf16 v[48:63], v[176:179], v[252:255], v[48:63]
    v_mfma_f32_32x32x16_bf16 v[64:79], v[180:183], v[252:255], v[64:79]
    v_lshlrev_b32 v12, 4, v1
    s_lshl_b32 s64, s50, 11
    v_add_u32 v12, s64, v12
    v_add_u32 v13, 0x10000, v12
    v_add_u32 v14, 0x20000, v12
    s_waitcnt lgkmcnt(0)
    s_nop 2
    ds_write_b128 v12, v[16:19] offset:20608
    ds_write_b128 v12, v[20:23] offset:21632
    ds_write_b128 v14, v[24:27] offset:8832
    ds_write_b128 v14, v[28:31] offset:9856
    ds_write_b128 v12, v[32:35] offset:36992
    ds_write_b128 v12, v[36:39] offset:38016
    ds_write_b128 v12, v[40:43] offset:53376
    ds_write_b128 v12, v[44:47] offset:54400
    ds_write_b128 v13, v[48:51] offset:4224
    ds_write_b128 v13, v[52:55] offset:5248
    ds_write_b128 v13, v[56:59] offset:20608
    ds_write_b128 v13, v[60:63] offset:21632
    ds_write_b128 v13, v[64:67] offset:36992
    ds_write_b128 v13, v[68:71] offset:38016
    ds_write_b128 v12, v[72:75] offset:0
    ds_write_b128 v12, v[76:79] offset:1024
    s_mov_b32 s64, 20608
    s_cmp_eq_u32 s53, 1
    s_cselect_b32 s64, 69760, s64
    s_cmp_eq_u32 s53, 2
    s_cselect_b32 s64, 139904, s64
    s_cmp_eq_u32 s53, 3
    s_cselect_b32 s64, 86144, s64
    v_and_b32 v12, 31, v1
    v_lshlrev_b32 v12, 4, v12
    v_lshrrev_b32 v13, 5, v1
    v_lshlrev_b32 v13, 10, v13
    v_add_u32 v12, v12, v13
    v_add_u32 v12, s64, v12
    s_waitcnt lgkmcnt(0)
    s_barrier
    ds_read_b128 v[80:83], v12 offset:0
    ds_read_b128 v[84:87], v12 offset:512
    ds_read_b128 v[88:91], v12 offset:2048
    ds_read_b128 v[92:95], v12 offset:2560
    ds_read_b128 v[96:99], v12 offset:4096
    ds_read_b128 v[100:103], v12 offset:4608
    ds_read_b128 v[104:107], v12 offset:6144
    ds_read_b128 v[108:111], v12 offset:6656
    ds_read_b128 v[112:115], v12 offset:8192
    ds_read_b128 v[116:119], v12 offset:8704
    ds_read_b128 v[120:123], v12 offset:10240
    ds_read_b128 v[124:127], v12 offset:10752
    ds_read_b128 v[128:131], v12 offset:12288
    ds_read_b128 v[132:135], v12 offset:12800
    ds_read_b128 v[136:139], v12 offset:14336
    ds_read_b128 v[140:143], v12 offset:14848
    v_lshlrev_b32 v16, 16, v8
    v_and_b32 v17, 0xffff0000, v8
    v_lshlrev_b32 v18, 16, v9
    v_and_b32 v19, 0xffff0000, v9
    v_lshlrev_b32 v20, 16, v10
    v_and_b32 v21, 0xffff0000, v10
    v_lshlrev_b32 v22, 16, v11
    v_and_b32 v23, 0xffff0000, v11
    s_waitcnt lgkmcnt(14)
    v_pk_add_f32 v[16:17], v[16:17], v[80:81]
    v_pk_add_f32 v[18:19], v[18:19], v[82:83]
    v_pk_add_f32 v[20:21], v[20:21], v[84:85]
    v_pk_add_f32 v[22:23], v[22:23], v[86:87]
    s_waitcnt lgkmcnt(12)
    v_pk_add_f32 v[16:17], v[16:17], v[88:89]
    v_pk_add_f32 v[18:19], v[18:19], v[90:91]
    v_pk_add_f32 v[20:21], v[20:21], v[92:93]
    v_pk_add_f32 v[22:23], v[22:23], v[94:95]
    s_waitcnt lgkmcnt(10)
    v_pk_add_f32 v[16:17], v[16:17], v[96:97]
    v_pk_add_f32 v[18:19], v[18:19], v[98:99]
    v_pk_add_f32 v[20:21], v[20:21], v[100:101]
    v_pk_add_f32 v[22:23], v[22:23], v[102:103]
    s_waitcnt lgkmcnt(8)
    v_pk_add_f32 v[16:17], v[16:17], v[104:105]
    v_pk_add_f32 v[18:19], v[18:19], v[106:107]
    v_pk_add_f32 v[20:21], v[20:21], v[108:109]
    v_pk_add_f32 v[22:23], v[22:23], v[110:111]
    s_waitcnt lgkmcnt(6)
    v_pk_add_f32 v[16:17], v[16:17], v[112:113]
    v_pk_add_f32 v[18:19], v[18:19], v[114:115]
    v_pk_add_f32 v[20:21], v[20:21], v[116:117]
    v_pk_add_f32 v[22:23], v[22:23], v[118:119]
    s_waitcnt lgkmcnt(4)
    v_pk_add_f32 v[16:17], v[16:17], v[120:121]
    v_pk_add_f32 v[18:19], v[18:19], v[122:123]
    v_pk_add_f32 v[20:21], v[20:21], v[124:125]
    v_pk_add_f32 v[22:23], v[22:23], v[126:127]
    s_waitcnt lgkmcnt(2)
    v_pk_add_f32 v[16:17], v[16:17], v[128:129]
    v_pk_add_f32 v[18:19], v[18:19], v[130:131]
    v_pk_add_f32 v[20:21], v[20:21], v[132:133]
    v_pk_add_f32 v[22:23], v[22:23], v[134:135]
    s_waitcnt lgkmcnt(0)
    v_pk_add_f32 v[16:17], v[16:17], v[136:137]
    v_pk_add_f32 v[18:19], v[18:19], v[138:139]
    v_pk_add_f32 v[20:21], v[20:21], v[140:141]
    v_pk_add_f32 v[22:23], v[22:23], v[142:143]
    v_cvt_pk_bf16_f32 v24, v16, v17
    v_cvt_pk_bf16_f32 v25, v18, v19
    v_cvt_pk_bf16_f32 v26, v20, v21
    v_cvt_pk_bf16_f32 v27, v22, v23
    buffer_store_dwordx4 v[24:27], v4, s[44:47], s73 offen
    s_endpgm
RffnA_retry:
    s_mov_b32 s67, 0
RffnA_rl_86:
    buffer_load_dwordx4 v[24:27], v15, s[32:35], s12 offen offset:0 sc1
    buffer_load_dwordx4 v[28:31], v15, s[32:35], s12 offen offset:512 sc1
    buffer_load_dwordx4 v[32:35], v15, s[32:35], s12 offen offset:1024 sc1
    buffer_load_dwordx4 v[36:39], v15, s[32:35], s12 offen offset:1536 sc1
    buffer_load_dwordx4 v[56:59], v60, s[32:35], s14 offen sc1
    s_waitcnt vmcnt(0)
    s_add_u32 s67, s67, 1
    s_cmp_gt_u32 s67, 400000
    s_cbranch_scc1 RffnA_recok
    v_cmp_ne_u32 s[10:11], s56, v27
    v_cmp_ne_u32 vcc, s56, v31
    s_or_b64 s[10:11], s[10:11], vcc
    v_cmp_ne_u32 vcc, s56, v35
    s_or_b64 s[10:11], s[10:11], vcc
    v_cmp_ne_u32 vcc, s56, v39
    s_or_b64 s[10:11], s[10:11], vcc
    v_cmp_ne_u32 vcc, s55, v59
    s_or_b64 s[10:11], s[10:11], vcc
    s_cmp_lg_u64 s[10:11], 0
    s_cbranch_scc1 RffnA_rl_86
RffnA_rok_87:
    s_branch RffnA_recok
RffnA_psp_73:
RffnA_pl_88:
    s_sleep 4
    s_mov_b64 exec, 0xff
    buffer_load_dword v13, v12, s[32:35], s77 offen sc1
    s_mov_b64 exec, -1
    s_waitcnt vmcnt(0)
    v_cmp_eq_u32 vcc, s55, v13
    s_add_u32 s3, s3, 1
    s_cmp_gt_u32 s3, 400000
    s_cbranch_scc1 RffnA_pok_72
    s_and_b32 s64, vcc_lo, 0xf
    s_cmp_lg_u32 s64, 0xf
    s_cbranch_scc1 RffnA_pl_88
    s_branch RffnA_pok_72
RffnA_psp_75:
RffnA_pl_89:
    s_sleep 4
    s_mov_b64 exec, 0xff
    buffer_load_dword v13, v12, s[32:35], s77 offen sc1
    s_mov_b64 exec, -1
    s_waitcnt vmcnt(0)
    v_cmp_eq_u32 vcc, s55, v13
    s_add_u32 s3, s3, 1
    s_cmp_gt_u32 s3, 400000
    s_cbranch_scc1 RffnA_pok_74
    s_and_b32 s64, vcc_lo, 0xf0
    s_cmp_lg_u32 s64, 0xf0
    s_cbranch_scc1 RffnA_pl_89
    s_branch RffnA_pok_74
RffnA_gsp_77:
RffnA_gl_90:
    s_sleep 4
    s_mov_b64 exec, 0x3
    buffer_load_dword v13, v0, s[32:35], s76 offen sc1
    s_mov_b64 exec, -1
    s_waitcnt vmcnt(0)
    v_cmp_ne_u32 vcc, -1, v13
    s_add_u32 s3, s3, 1
    s_cmp_gt_u32 s3, 400000
    s_cbranch_scc1 RffnA_gok_76
    s_and_b32 s64, vcc_lo, 0x3
    s_cmp_lg_u32 s64, 0x3
    s_cbranch_scc1 RffnA_gl_90
    s_branch RffnA_gok_76
RffnA_asp_79:
RffnA_al_91:
    s_add_u32 s64, s76, 0
    buffer_load_dwordx4 v[224:227], v3, s[32:35], s64 offen sc1
    s_add_u32 s64, s76, 147456
    buffer_load_dwordx4 v[228:231], v3, s[32:35], s64 offen sc1
    s_add_u32 s64, s76, 1024
    buffer_load_dwordx4 v[232:235], v3, s[32:35], s64 offen sc1
    s_add_u32 s64, s76, 148480
    buffer_load_dwordx4 v[236:239], v3, s[32:35], s64 offen sc1
    s_add_u32 s64, s76, 2048
    buffer_load_dwordx4 v[240:243], v3, s[32:35], s64 offen sc1
    s_add_u32 s64, s76, 149504
    buffer_load_dwordx4 v[244:247], v3, s[32:35], s64 offen sc1
    s_add_u32 s64, s76, 3072
    buffer_load_dwordx4 v[248:251], v3, s[32:35], s64 offen sc1
    s_add_u32 s64, s76, 150528
    buffer_load_dwordx4 v[252:255], v3, s[32:35], s64 offen sc1
    s_waitcnt vmcnt(0)
    v_max3_u32 v5, v224, v225, v226
    v_max3_u32 v15, v228, v229, v230
    v_max3_u32 v5, v5, v227, v231
    v_max_u32 v5, v5, v15
    v_cmp_eq_u32 vcc, -1, v5
    s_add_u32 s3, s3, 1
    s_cmp_gt_u32 s3, 400000
    s_cbranch_scc1 RffnA_aok_78
    s_cbranch_vccnz RffnA_al_91
    s_branch RffnA_aok_78
RffnA_asp_81:
RffnA_al_92:
    s_add_u32 s64, s76, 1024
    buffer_load_dwordx4 v[232:235], v3, s[32:35], s64 offen sc1
    s_add_u32 s64, s76, 148480
    buffer_load_dwordx4 v[236:239], v3, s[32:35], s64 offen sc1
    s_add_u32 s64, s76, 2048
    buffer_load_dwordx4 v[240:243], v3, s[32:35], s64 offen sc1
    s_add_u32 s64, s76, 149504
    buffer_load_dwordx4 v[244:247], v3, s[32:35], s64 offen sc1
    s_add_u32 s64, s76, 3072
    buffer_load_dwordx4 v[248:251], v3, s[32:35], s64 offen sc1
    s_add_u32 s64, s76, 150528
    buffer_load_dwordx4 v[252:255], v3, s[32:35], s64 offen sc1
    s_waitcnt vmcnt(0)
    v_max3_u32 v5, v232, v233, v234
    v_max3_u32 v15, v236, v237, v238
    v_max3_u32 v5, v5, v235, v239
    v_max_u32 v5, v5, v15
    v_cmp_eq_u32 vcc, -1, v5
    s_add_u32 s3, s3, 1
    s_cmp_gt_u32 s3, 400000
    s_cbranch_scc1 RffnA_aok_80
    s_cbranch_vccnz RffnA_al_92
    s_branch RffnA_aok_80
RffnA_asp_83:
RffnA_al_93:
    s_add_u32 s64, s76, 2048
    buffer_load_dwordx4 v[240:243], v3, s[32:35], s64 offen sc1
    s_add_u32 s64, s76, 149504
    buffer_load_dwordx4 v[244:247], v3, s[32:35], s64 offen sc1
    s_add_u32 s64, s76, 3072
    buffer_load_dwordx4 v[248:251], v3, s[32:35], s64 offen sc1
    s_add_u32 s64, s76, 150528
    buffer_load_dwordx4 v[252:255], v3, s[32:35], s64 offen sc1
    s_waitcnt vmcnt(0)
    v_max3_u32 v5, v240, v241, v242
    v_max3_u32 v15, v244, v245, v246
    v_max3_u32 v5, v5, v243, v247
    v_max_u32 v5, v5, v15
    v_cmp_eq_u32 vcc, -1, v5
    s_add_u32 s3, s3, 1
    s_cmp_gt_u32 s3, 400000
    s_cbranch_scc1 RffnA_aok_82
    s_cbranch_vccnz RffnA_al_93
    s_branch RffnA_aok_82
RffnA_asp_85:
RffnA_al_94:
    s_add_u32 s64, s76, 3072
    buffer_load_dwordx4 v[248:251], v3, s[32:35], s64 offen sc1
    s_add_u32 s64, s76, 150528
    buffer_load_dwordx4 v[252:255], v3, s[32:35], s64 offen sc1
    s_waitcnt vmcnt(0)
    v_max3_u32 v5, v248, v249, v250
    v_max3_u32 v15, v252, v253, v254
    v_max3_u32 v5, v5, v251, v255
    v_max_u32 v5, v5, v15
    v_cmp_eq_u32 vcc, -1, v5
    s_add_u32 s3, s3, 1
    s_cmp_gt_u32 s3, 400000
    s_cbranch_scc1 RffnA_aok_84
    s_cbranch_vccnz RffnA_al_94
    s_branch RffnA_aok_84
RffnB:
    s_mov_b32 s3, 0
    v_lshrrev_b32 v40, 3, v1
    v_and_b32 v41, 7, v1
    v_lshrrev_b32 v42, 4, v1
    v_add_u32 v43, 0, v1
    v_mul_u32_u24 v44, 3277, v43
    v_lshrrev_b32 v44, 16, v44
    v_mul_u32_u24 v45, 20, v44
    v_sub_u32 v45, v43, v45
    v_mul_u32_u24 v44, 3584, v44
    v_lshlrev_b32 v45, 4, v45
    v_add_u32 v16, v44, v45
    v_add_u32 v43, 64, v1
    v_mul_u32_u24 v44, 3277, v43
    v_lshrrev_b32 v44, 16, v44
    v_mul_u32_u24 v45, 20, v44
    v_sub_u32 v45, v43, v45
    v_mul_u32_u24 v44, 3584, v44
    v_lshlrev_b32 v45, 4, v45
    v_add_u32 v17, v44, v45
    v_add_u32 v43, 128, v1
    v_mul_u32_u24 v44, 3277, v43
    v_lshrrev_b32 v44, 16, v44
    v_mul_u32_u24 v45, 20, v44
    v_sub_u32 v45, v43, v45
    v_mul_u32_u24 v44, 3584, v44
    v_lshlrev_b32 v45, 4, v45
    v_add_u32 v18, v44, v45
    v_add_u32 v43, 192, v1
    v_mul_u32_u24 v44, 3277, v43
    v_lshrrev_b32 v44, 16, v44
    v_mul_u32_u24 v45, 20, v44
    v_sub_u32 v45, v43, v45
    v_mul_u32_u24 v44, 3584, v44
    v_lshlrev_b32 v45, 4, v45
    v_add_u32 v19, v44, v45
    v_add_u32 v43, 256, v1
    v_mul_u32_u24 v44, 3277, v43
    v_lshrrev_b32 v44, 16, v44
    v_mul_u32_u24 v45, 20, v44
    v_sub_u32 v45, v43, v45
    v_mul_u32_u24 v44, 3584, v44
    v_lshlrev_b32 v45, 4, v45
    v_add_u32 v20, v44, v45
    s_and_b32 s65, s53, 1
    s_mul_i32 s59, s65, 57344
    s_mul_i32 s64, s49, 320
    s_add_u32 s59, s59, s64
    s_add_u32 s59, s59, 1024
    s_mul_i32 s57, s65, 5120
    s_lshr_b32 s64, s53, 1
    s_mul_i32 s64, s64, 10272
    s_add_u32 s57, s57, s64
    s_lshr_b32 s64, s48, 3
    s_xor_b32 s65, s64, 1
    s_mul_i32 s75, s64, 917504
    s_add_u32 s75, s75, s59
    s_mul_i32 s76, s65, 917504
    s_add_u32 s76, s76, s59
    s_waitcnt lgkmcnt(0)
    s_mov_b32 s16, s4
    s_mov_b32 s17, s5
    s_mov_b32 s18, 0x200000
    s_mov_b32 s19, 0x00020000
    s_mov_b32 s32, s12
    s_mov_b32 s33, s13
    s_mov_b32 s34, 0x1000000
    s_mov_b32 s35, 0x00020000
    s_cmp_lt_u32 s53, 2
    s_cselect_b32 s20, s8, s10
    s_cselect_b32 s21, s9, s11
    s_mov_b32 s22, 0x1c0000
    s_mov_b32 s23, 0x00020000
    s_add_u32 m0, s57, 0
    s_nop 0
    buffer_load_dwordx4 v16, s[20:23], s75 offen lds
    s_add_u32 m0, s57, 1024
    s_nop 0
    buffer_load_dwordx4 v17, s[20:23], s75 offen lds
    s_add_u32 m0, s57, 2048
    s_nop 0
    buffer_load_dwordx4 v18, s[20:23], s75 offen lds
    s_add_u32 m0, s57, 3072
    s_nop 0
    buffer_load_dwordx4 v19, s[20:23], s75 offen lds
    s_add_u32 m0, s57, 4096
    s_nop 0
    buffer_load_dwordx4 v20, s[20:23], s75 offen lds
    s_lshl_b32 s64, s48, 7
    s_add_u32 s64, s64, 0x998000
    s_lshl_b32 s65, s54, 7
    s_add_u32 s65, s65, 0x999000
    buffer_load_dword v62, off, s[32:35], s64 sc1
    buffer_load_dword v63, off, s[32:35], s65 sc1
    s_add_u32 m0, s57, 20608
    s_add_u32 s65, s75, 114688
    buffer_load_dwordx4 v16, s[20:23], s65 offen lds
    s_add_u32 m0, s57, 21632
    s_nop 0
    buffer_load_dwordx4 v17, s[20:23], s65 offen lds
    s_add_u32 m0, s57, 22656
    s_nop 0
    buffer_load_dwordx4 v18, s[20:23], s65 offen lds
    s_add_u32 m0, s57, 23680
    s_nop 0
    buffer_load_dwordx4 v19, s[20:23], s65 offen lds
    s_add_u32 m0, s57, 24704
    s_nop 0
    buffer_load_dwordx4 v20, s[20:23], s65 offen lds
    s_add_u32 m0, s57, 41216
    s_add_u32 s65, s75, 229376
    buffer_load_dwordx4 v16, s[20:23], s65 offen lds
    s_add_u32 m0, s57, 42240
    s_nop 0
    buffer_load_dwordx4 v17, s[20:23], s65 offen lds
    s_add_u32 m0, s57, 43264
    s_nop 0
    buffer_load_dwordx4 v18, s[20:23], s65 offen lds
    s_add_u32 m0, s57, 44288
    s_nop 0
    buffer_load_dwordx4 v19, s[20:23], s65 offen lds
    s_add_u32 m0, s57, 45312
    s_nop 0
    buffer_load_dwordx4 v20, s[20:23], s65 offen lds
    s_add_u32 m0, s57, 61824
    s_add_u32 s65, s75, 344064
    buffer_load_dwordx4 v16, s[20:23], s65 offen lds
    s_add_u32 m0, s57, 62848
    s_nop 0
    buffer_load_dwordx4 v17, s[20:23], s65 offen lds
    s_add_u32 m0, s57, 63872
    s_nop 0
    buffer_load_dwordx4 v18, s[20:23], s65 offen lds
    s_add_u32 m0, s57, 64896
    s_nop 0
    buffer_load_dwordx4 v19, s[20:23], s65 offen lds
    s_add_u32 m0, s57, 65920
    s_nop 0
    buffer_load_dwordx4 v20, s[20:23], s65 offen lds
    s_add_u32 m0, s57, 82432
    s_add_u32 s65, s75, 458752
    buffer_load_dwordx4 v16, s[20:23], s65 offen lds
    s_add_u32 m0, s57, 83456
    s_nop 0
    buffer_load_dwordx4 v17, s[20:23], s65 offen lds
    s_add_u32 m0, s57, 84480
    s_nop 0
    buffer_load_dwordx4 v18, s[20:23], s65 offen lds
    s_add_u32 m0, s57, 85504
    s_nop 0
    buffer_load_dwordx4 v19, s[20:23], s65 offen lds
    s_add_u32 m0, s57, 86528
    s_nop 0
    buffer_load_dwordx4 v20, s[20:23], s65 offen lds
    s_mov_b32 s36, s14
    s_mov_b32 s37, s15
    s_mov_b32 s38, 0x80000
    s_mov_b32 s39, 0x00020000
    s_mov_b32 s40, s44
    s_mov_b32 s41, s45
    s_mov_b32 s42, 0x1c0000
    s_mov_b32 s43, 0x00020000
    s_mov_b32 s44, s46
    s_mov_b32 s45, s47
    s_mov_b32 s46, 0x200000
    s_mov_b32 s47, 0x00020000
    v_lshrrev_b32 v46, 4, v1
    v_bfe_u32 v47, v1, 2, 2
    v_and_b32 v48, 3, v1
    v_lshrrev_b32 v49, 1, v46
    v_and_b32 v50, 1, v46
    v_lshlrev_b32 v51, 3, v49
    v_add_u32 v51, v51, v47
    v_lshrrev_b32 v52, 1, v47
    v_mul_u32_u24 v53, 10272, v50
    v_mul_u32_u24 v54, 320, v51
    v_add_u32 v53, v53, v54
    v_lshlrev_b32 v55, 3, v48
    v_add_u32 v53, v53, v55
    s_lshl_b32 s64, s52, 6
    s_add_u32 s64, s64, 192
    v_add_u32 v2, s64, v53
    v_add_u32 v3, 61824, v2
    v_and_b32 v53, 31, v1
    v_lshrrev_b32 v54, 5, v1
    v_bfe_u32 v55, v1, 1, 3
    v_xor_b32 v55, v55, v54
    v_lshlrev_b32 v55, 4, v55
    v_lshlrev_b32 v53, 7, v53
    v_add_u32 v53, v53, v55
    s_lshl_b32 s64, s51, 13
    s_add_u32 s64, s64, 103040
    v_add_u32 v8, s64, v53
    v_xor_b32 v9, 32, v8
    v_xor_b32 v10, 64, v8
    v_xor_b32 v11, 96, v8
    v_lshrrev_b32 v53, 3, v1
    v_and_b32 v54, 3, v53
    v_lshrrev_b32 v55, 2, v53
    v_lshlrev_b32 v55, 3, v55
    v_add_u32 v54, v54, v55
    v_lshlrev_b32 v54, 10, v54
    v_bfe_u32 v55, v53, 1, 1
    v_lshlrev_b32 v55, 2, v55
    v_and_b32 v56, 7, v1
    v_xor_b32 v55, v55, v56
    v_lshlrev_b32 v55, 4, v55
    v_add_u32 v14, v54, v55
    s_and_b32 s64, s2, 7
    s_lshr_b32 s64, s64, 1
    s_and_b32 s65, s64, 1
    s_lshl_b32 s69, s48, 1
    s_add_u32 s69, s69, s65
    s_lshr_b32 s64, s64, 1
    s_lshl_b32 s64, s64, 2
    s_add_u32 s70, s64, s79
    s_mov_b32 s15, s50
    s_mul_i32 s71, s15, 163840
    s_add_u32 s71, s71, 524288
    s_lshl_b32 s64, s70, 7
    s_add_u32 s71, s71, s64
    s_lshl_b32 s74, s50, 11
    s_mul_i32 s72, s69, 294912
    s_and_b32 s68, s48, 7
    s_cmp_eq_u32 s51, 1
    s_cselect_b32 s68, s68, 99
    s_waitcnt vmcnt(20)
    v_readfirstlane_b32 s55, v62
    v_readfirstlane_b32 s56, v63
    s_mul_i32 s55, s55, 0x9e3779b1
    s_add_u32 s55, s55, 0x7f4a7c15
    s_mul_i32 s56, s56, 0x9e3779b1
    s_add_u32 s56, s56, 0x7f4a7c15
    s_waitcnt lgkmcnt(0)
    s_barrier
    ds_read_b128 v[160:163], v8 offset:0
    ds_read_b128 v[164:167], v8 offset:4096
    ds_read_b64_tr_b16 v[176:177], v2 offset:0
    ds_read_b64_tr_b16 v[178:179], v2 offset:1280
    ds_read_b64_tr_b16 v[180:181], v2 offset:32
    ds_read_b64_tr_b16 v[182:183], v2 offset:1312
    ds_read_b128 v[168:171], v9 offset:0
    ds_read_b128 v[172:175], v9 offset:4096
    ds_read_b64_tr_b16 v[184:185], v2 offset:5120
    ds_read_b64_tr_b16 v[186:187], v2 offset:6400
    ds_read_b64_tr_b16 v[188:189], v2 offset:5152
    ds_read_b64_tr_b16 v[190:191], v2 offset:6432
    s_waitcnt vmcnt(15) lgkmcnt(0)
    s_barrier
    s_cmp_lg_u32 s68, 0
    s_cbranch_scc1 RffnB_nocs_95
    v_bfe_u32 v40, v1, 4, 1
    v_and_b32 v41, 1, v1
    v_cmp_eq_u32 vcc, v40, v41
    v_mov_b32 v42, 0x3f803f80
    s_nop 0
    v_cndmask_b32 v40, 0, v42, vcc
    v_mov_b32 v41, v40
    v_mov_b32 v42, v40
    v_mov_b32 v43, v40
    s_nop 1
    v_mfma_f32_16x16x32_bf16 v[44:47], v[40:43], v[176:179], 0
    v_mfma_f32_16x16x32_bf16 v[48:51], v[40:43], v[180:183], 0
    v_mfma_f32_16x16x32_bf16 v[44:47], v[40:43], v[184:187], v[44:47]
    v_mfma_f32_16x16x32_bf16 v[48:51], v[40:43], v[188:191], v[48:51]
    v_bfe_u32 v28, v1, 4, 1
    v_cmp_eq_u32 vcc, 1, v28
    s_nop 4
    v_cndmask_b32 v24, v44, v45, vcc
    v_cndmask_b32 v25, v48, v49, vcc
    v_mov_b32 v26, s56
    v_mov_b32 v27, s56
    s_lshl_b32 s64, s54, 2
    s_add_u32 s64, s64, s52
    s_add_u32 s64, s64, 2
    s_lshl_b32 s64, s64, 4
    s_add_u32 s64, s64, s48
    s_lshl_b32 s64, s64, 9
    s_add_u32 s64, s64, 0x910000
    v_lshlrev_b32 v28, 4, v1
    s_mov_b32 exec_hi, 0
    buffer_store_dwordx4 v[24:27], v28, s[32:35], s64 offen sc1
    s_mov_b32 exec_hi, -1
RffnB_nocs_95:
    s_add_u32 m0, s57, 0
    s_add_u32 s65, s75, 573440
    buffer_load_dwordx4 v16, s[20:23], s65 offen lds
    ds_read_b128 v[204:207], v10 offset:0
    ds_read_b128 v[208:211], v10 offset:4096
    s_add_u32 m0, s57, 1024
    s_nop 0
    buffer_load_dwordx4 v17, s[20:23], s65 offen lds
    ds_read_b64_tr_b16 v[220:221], v2 offset:20608
    ds_read_b64_tr_b16 v[222:223], v2 offset:21888
    s_add_u32 m0, s57, 2048
    s_nop 0
    buffer_load_dwordx4 v18, s[20:23], s65 offen lds
    ds_read_b64_tr_b16 v[224:225], v2 offset:20640
    ds_read_b64_tr_b16 v[226:227], v2 offset:21920
    s_add_u32 m0, s57, 3072
    s_nop 0
    buffer_load_dwordx4 v19, s[20:23], s65 offen lds
    ds_read_b128 v[212:215], v11 offset:0
    ds_read_b128 v[216:219], v11 offset:4096
    s_add_u32 m0, s57, 4096
    s_nop 0
    buffer_load_dwordx4 v20, s[20:23], s65 offen lds
    ds_read_b64_tr_b16 v[228:229], v2 offset:25728
    ds_read_b64_tr_b16 v[230:231], v2 offset:27008
    ds_read_b64_tr_b16 v[232:233], v2 offset:25760
    ds_read_b64_tr_b16 v[234:235], v2 offset:27040
    v_mfma_f32_32x32x16_bf16 v[64:79], v[176:179], v[160:163], 0
    v_mfma_f32_32x32x16_bf16 v[80:95], v[176:179], v[164:167], 0
    v_mfma_f32_32x32x16_bf16 v[96:111], v[180:183], v[160:163], 0
    v_mfma_f32_32x32x16_bf16 v[112:127], v[180:183], v[164:167], 0
    v_mfma_f32_32x32x16_bf16 v[64:79], v[184:187], v[168:171], v[64:79]
    v_mfma_f32_32x32x16_bf16 v[80:95], v[184:187], v[172:175], v[80:95]
    v_mfma_f32_32x32x16_bf16 v[96:111], v[188:191], v[168:171], v[96:111]
    v_mfma_f32_32x32x16_bf16 v[112:127], v[188:191], v[172:175], v[112:127]
    s_waitcnt vmcnt(15) lgkmcnt(0)
    s_barrier
    s_cmp_lg_u32 s68, 1
    s_cbranch_scc1 RffnB_nocs_96
    v_bfe_u32 v40, v1, 4, 1
    v_and_b32 v41, 1, v1
    v_cmp_eq_u32 vcc, v40, v41
    v_mov_b32 v42, 0x3f803f80
    s_nop 0
    v_cndmask_b32 v40, 0, v42, vcc
    v_mov_b32 v41, v40
    v_mov_b32 v42, v40
    v_mov_b32 v43, v40
    s_nop 1
    v_mfma_f32_16x16x32_bf16 v[44:47], v[40:43], v[220:223], 0
    v_mfma_f32_16x16x32_bf16 v[48:51], v[40:43], v[224:227], 0
    v_mfma_f32_16x16x32_bf16 v[44:47], v[40:43], v[228:231], v[44:47]
    v_mfma_f32_16x16x32_bf16 v[48:51], v[40:43], v[232:235], v[48:51]
    v_bfe_u32 v28, v1, 4, 1
    v_cmp_eq_u32 vcc, 1, v28
    s_nop 4
    v_cndmask_b32 v24, v44, v45, vcc
    v_cndmask_b32 v25, v48, v49, vcc
    v_mov_b32 v26, s56
    v_mov_b32 v27, s56
    s_lshl_b32 s64, s54, 2
    s_add_u32 s64, s64, s52
    s_add_u32 s64, s64, 2
    s_lshl_b32 s64, s64, 4
    s_add_u32 s64, s64, s48
    s_lshl_b32 s64, s64, 9
    s_add_u32 s64, s64, 0x910000
    v_lshlrev_b32 v28, 4, v1
    s_mov_b32 exec_hi, 0
    buffer_store_dwordx4 v[24:27], v28, s[32:35], s64 offen sc1
    s_mov_b32 exec_hi, -1
RffnB_nocs_96:
    s_add_u32 m0, s57, 20608
    s_add_u32 s65, s75, 688128
    buffer_load_dwordx4 v16, s[20:23], s65 offen lds
    ds_read_b128 v[160:163], v8 offset:18432
    ds_read_b128 v[164:167], v8 offset:22528
    s_add_u32 m0, s57, 21632
    s_nop 0
    buffer_load_dwordx4 v17, s[20:23], s65 offen lds
    ds_read_b64_tr_b16 v[176:177], v2 offset:41216
    ds_read_b64_tr_b16 v[178:179], v2 offset:42496
    s_add_u32 m0, s57, 22656
    s_nop 0
    buffer_load_dwordx4 v18, s[20:23], s65 offen lds
    ds_read_b64_tr_b16 v[180:181], v2 offset:41248
    ds_read_b64_tr_b16 v[182:183], v2 offset:42528
    s_add_u32 m0, s57, 23680
    s_nop 0
    buffer_load_dwordx4 v19, s[20:23], s65 offen lds
    ds_read_b128 v[168:171], v9 offset:18432
    ds_read_b128 v[172:175], v9 offset:22528
    s_add_u32 m0, s57, 24704
    s_nop 0
    buffer_load_dwordx4 v20, s[20:23], s65 offen lds
    ds_read_b64_tr_b16 v[184:185], v2 offset:46336
    ds_read_b64_tr_b16 v[186:187], v2 offset:47616
    ds_read_b64_tr_b16 v[188:189], v2 offset:46368
    ds_read_b64_tr_b16 v[190:191], v2 offset:47648
    v_mfma_f32_32x32x16_bf16 v[64:79], v[220:223], v[204:207], v[64:79]
    v_mfma_f32_32x32x16_bf16 v[80:95], v[220:223], v[208:211], v[80:95]
    v_mfma_f32_32x32x16_bf16 v[96:111], v[224:227], v[204:207], v[96:111]
    v_mfma_f32_32x32x16_bf16 v[112:127], v[224:227], v[208:211], v[112:127]
    v_mfma_f32_32x32x16_bf16 v[64:79], v[228:231], v[212:215], v[64:79]
    v_mfma_f32_32x32x16_bf16 v[80:95], v[228:231], v[216:219], v[80:95]
    v_mfma_f32_32x32x16_bf16 v[96:111], v[232:235], v[212:215], v[96:111]
    v_mfma_f32_32x32x16_bf16 v[112:127], v[232:235], v[216:219], v[112:127]
    s_waitcnt vmcnt(15) lgkmcnt(0)
    s_barrier
    s_cmp_lg_u32 s68, 2
    s_cbranch_scc1 RffnB_nocs_97
    v_bfe_u32 v40, v1, 4, 1
    v_and_b32 v41, 1, v1
    v_cmp_eq_u32 vcc, v40, v41
    v_mov_b32 v42, 0x3f803f80
    s_nop 0
    v_cndmask_b32 v40, 0, v42, vcc
    v_mov_b32 v41, v40
    v_mov_b32 v42, v40
    v_mov_b32 v43, v40
    s_nop 1
    v_mfma_f32_16x16x32_bf16 v[44:47], v[40:43], v[176:179], 0
    v_mfma_f32_16x16x32_bf16 v[48:51], v[40:43], v[180:183], 0
    v_mfma_f32_16x16x32_bf16 v[44:47], v[40:43], v[184:187], v[44:47]
    v_mfma_f32_16x16x32_bf16 v[48:51], v[40:43], v[188:191], v[48:51]
    v_bfe_u32 v28, v1, 4, 1
    v_cmp_eq_u32 vcc, 1, v28
    s_nop 4
    v_cndmask_b32 v24, v44, v45, vcc
    v_cndmask_b32 v25, v48, v49, vcc
    v_mov_b32 v26, s56
    v_mov_b32 v27, s56
    s_lshl_b32 s64, s54, 2
    s_add_u32 s64, s64, s52
    s_add_u32 s64, s64, 2
    s_lshl_b32 s64, s64, 4
    s_add_u32 s64, s64, s48
    s_lshl_b32 s64, s64, 9
    s_add_u32 s64, s64, 0x910000
    v_lshlrev_b32 v28, 4, v1
    s_mov_b32 exec_hi, 0
    buffer_store_dwordx4 v[24:27], v28, s[32:35], s64 offen sc1
    s_mov_b32 exec_hi, -1
RffnB_nocs_97:
    s_add_u32 m0, s57, 41216
    s_add_u32 s65, s75, 802816
    buffer_load_dwordx4 v16, s[20:23], s65 offen lds
    ds_read_b128 v[204:207], v10 offset:18432
    ds_read_b128 v[208:211], v10 offset:22528
    s_add_u32 m0, s57, 42240
    s_nop 0
    buffer_load_dwordx4 v17, s[20:23], s65 offen lds
    ds_read_b64_tr_b16 v[220:221], v3 offset:0
    ds_read_b64_tr_b16 v[222:223], v3 offset:1280
    s_add_u32 m0, s57, 43264
    s_nop 0
    buffer_load_dwordx4 v18, s[20:23], s65 offen lds
    ds_read_b64_tr_b16 v[224:225], v3 offset:32
    ds_read_b64_tr_b16 v[226:227], v3 offset:1312
    s_add_u32 m0, s57, 44288
    s_nop 0
    buffer_load_dwordx4 v19, s[20:23], s65 offen lds
    ds_read_b128 v[212:215], v11 offset:18432
    ds_read_b128 v[216:219], v11 offset:22528
    s_add_u32 m0, s57, 45312
    s_nop 0
    buffer_load_dwordx4 v20, s[20:23], s65 offen lds
    ds_read_b64_tr_b16 v[228:229], v3 offset:5120
    ds_read_b64_tr_b16 v[230:231], v3 offset:6400
    ds_read_b64_tr_b16 v[232:233], v3 offset:5152
    ds_read_b64_tr_b16 v[234:235], v3 offset:6432
    v_mfma_f32_32x32x16_bf16 v[64:79], v[176:179], v[160:163], v[64:79]
    v_mfma_f32_32x32x16_bf16 v[80:95], v[176:179], v[164:167], v[80:95]
    v_mfma_f32_32x32x16_bf16 v[96:111], v[180:183], v[160:163], v[96:111]
    v_mfma_f32_32x32x16_bf16 v[112:127], v[180:183], v[164:167], v[112:127]
    v_mfma_f32_32x32x16_bf16 v[64:79], v[184:187], v[168:171], v[64:79]
    v_mfma_f32_32x32x16_bf16 v[80:95], v[184:187], v[172:175], v[80:95]
    v_mfma_f32_32x32x16_bf16 v[96:111], v[188:191], v[168:171], v[96:111]
    v_mfma_f32_32x32x16_bf16 v[112:127], v[188:191], v[172:175], v[112:127]
    s_waitcnt vmcnt(15) lgkmcnt(0)
    s_barrier
    s_cmp_lg_u32 s68, 3
    s_cbranch_scc1 RffnB_nocs_98
    v_bfe_u32 v40, v1, 4, 1
    v_and_b32 v41, 1, v1
    v_cmp_eq_u32 vcc, v40, v41
    v_mov_b32 v42, 0x3f803f80
    s_nop 0
    v_cndmask_b32 v40, 0, v42, vcc
    v_mov_b32 v41, v40
    v_mov_b32 v42, v40
    v_mov_b32 v43, v40
    s_nop 1
    v_mfma_f32_16x16x32_bf16 v[44:47], v[40:43], v[220:223], 0
    v_mfma_f32_16x16x32_bf16 v[48:51], v[40:43], v[224:227], 0
    v_mfma_f32_16x16x32_bf16 v[44:47], v[40:43], v[228:231], v[44:47]
    v_mfma_f32_16x16x32_bf16 v[48:51], v[40:43], v[232:235], v[48:51]
    v_bfe_u32 v28, v1, 4, 1
    v_cmp_eq_u32 vcc, 1, v28
    s_nop 4
    v_cndmask_b32 v24, v44, v45, vcc
    v_cndmask_b32 v25, v48, v49, vcc
    v_mov_b32 v26, s56
    v_mov_b32 v27, s56
    s_lshl_b32 s64, s54, 2
    s_add_u32 s64, s64, s52
    s_add_u32 s64, s64, 2
    s_lshl_b32 s64, s64, 4
    s_add_u32 s64, s64, s48
    s_lshl_b32 s64, s64, 9
    s_add_u32 s64, s64, 0x910000
    v_lshlrev_b32 v28, 4, v1
    s_mov_b32 exec_hi, 0
    buffer_store_dwordx4 v[24:27], v28, s[32:35], s64 offen sc1
    s_mov_b32 exec_hi, -1
RffnB_nocs_98:
    s_add_u32 m0, s57, 61824
    s_nop 0
    buffer_load_dwordx4 v16, s[20:23], s76 offen lds
    ds_read_b128 v[160:163], v8 offset:36864
    ds_read_b128 v[164:167], v8 offset:40960
    s_add_u32 m0, s57, 62848
    s_nop 0
    buffer_load_dwordx4 v17, s[20:23], s76 offen lds
    ds_read_b64_tr_b16 v[176:177], v3 offset:20608
    ds_read_b64_tr_b16 v[178:179], v3 offset:21888
    s_add_u32 m0, s57, 63872
    s_nop 0
    buffer_load_dwordx4 v18, s[20:23], s76 offen lds
    ds_read_b64_tr_b16 v[180:181], v3 offset:20640
    ds_read_b64_tr_b16 v[182:183], v3 offset:21920
    s_add_u32 m0, s57, 64896
    s_nop 0
    buffer_load_dwordx4 v19, s[20:23], s76 offen lds
    ds_read_b128 v[168:171], v9 offset:36864
    ds_read_b128 v[172:175], v9 offset:40960
    s_add_u32 m0, s57, 65920
    s_nop 0
    buffer_load_dwordx4 v20, s[20:23], s76 offen lds
    ds_read_b64_tr_b16 v[184:185], v3 offset:25728
    ds_read_b64_tr_b16 v[186:187], v3 offset:27008
    ds_read_b64_tr_b16 v[188:189], v3 offset:25760
    ds_read_b64_tr_b16 v[190:191], v3 offset:27040
    v_mfma_f32_32x32x16_bf16 v[64:79], v[220:223], v[204:207], v[64:79]
    v_mfma_f32_32x32x16_bf16 v[80:95], v[220:223], v[208:211], v[80:95]
    v_mfma_f32_32x32x16_bf16 v[96:111], v[224:227], v[204:207], v[96:111]
    v_mfma_f32_32x32x16_bf16 v[112:127], v[224:227], v[208:211], v[112:127]
    v_mfma_f32_32x32x16_bf16 v[64:79], v[228:231], v[212:215], v[64:79]
    v_mfma_f32_32x32x16_bf16 v[80:95], v[228:231], v[216:219], v[80:95]
    v_mfma_f32_32x32x16_bf16 v[96:111], v[232:235], v[212:215], v[96:111]
    v_mfma_f32_32x32x16_bf16 v[112:127], v[232:235], v[216:219], v[112:127]
    s_waitcnt vmcnt(15) lgkmcnt(0)
    s_barrier
    s_cmp_lg_u32 s68, 4
    s_cbranch_scc1 RffnB_nocs_99
    v_bfe_u32 v40, v1, 4, 1
    v_and_b32 v41, 1, v1
    v_cmp_eq_u32 vcc, v40, v41
    v_mov_b32 v42, 0x3f803f80
    s_nop 0
    v_cndmask_b32 v40, 0, v42, vcc
    v_mov_b32 v41, v40
    v_mov_b32 v42, v40
    v_mov_b32 v43, v40
    s_nop 1
    v_mfma_f32_16x16x32_bf16 v[44:47], v[40:43], v[176:179], 0
    v_mfma_f32_16x16x32_bf16 v[48:51], v[40:43], v[180:183], 0
    v_mfma_f32_16x16x32_bf16 v[44:47], v[40:43], v[184:187], v[44:47]
    v_mfma_f32_16x16x32_bf16 v[48:51], v[40:43], v[188:191], v[48:51]
    v_bfe_u32 v28, v1, 4, 1
    v_cmp_eq_u32 vcc, 1, v28
    s_nop 4
    v_cndmask_b32 v24, v44, v45, vcc
    v_cndmask_b32 v25, v48, v49, vcc
    v_mov_b32 v26, s56
    v_mov_b32 v27, s56
    s_lshl_b32 s64, s54, 2
    s_add_u32 s64, s64, s52
    s_add_u32 s64, s64, 2
    s_lshl_b32 s64, s64, 4
    s_add_u32 s64, s64, s48
    s_lshl_b32 s64, s64, 9
    s_add_u32 s64, s64, 0x910000
    v_lshlrev_b32 v28, 4, v1
    s_mov_b32 exec_hi, 0
    buffer_store_dwordx4 v[24:27], v28, s[32:35], s64 offen sc1
    s_mov_b32 exec_hi, -1
RffnB_nocs_99:
    s_add_u32 m0, s57, 82432
    s_add_u32 s65, s76, 114688
    buffer_load_dwordx4 v16, s[20:23], s65 offen lds
    ds_read_b128 v[204:207], v10 offset:36864
    ds_read_b128 v[208:211], v10 offset:40960
    s_add_u32 m0, s57, 83456
    s_nop 0
    buffer_load_dwordx4 v17, s[20:23], s65 offen lds
    ds_read_b64_tr_b16 v[220:221], v2 offset:0
    ds_read_b64_tr_b16 v[222:223], v2 offset:1280
    s_add_u32 m0, s57, 84480
    s_nop 0
    buffer_load_dwordx4 v18, s[20:23], s65 offen lds
    ds_read_b64_tr_b16 v[224:225], v2 offset:32
    ds_read_b64_tr_b16 v[226:227], v2 offset:1312
    s_add_u32 m0, s57, 85504
    s_nop 0
    buffer_load_dwordx4 v19, s[20:23], s65 offen lds
    ds_read_b128 v[212:215], v11 offset:36864
    ds_read_b128 v[216:219], v11 offset:40960
    s_add_u32 m0, s57, 86528
    s_nop 0
    buffer_load_dwordx4 v20, s[20:23], s65 offen lds
    ds_read_b64_tr_b16 v[228:229], v2 offset:5120
    ds_read_b64_tr_b16 v[230:231], v2 offset:6400
    ds_read_b64_tr_b16 v[232:233], v2 offset:5152
    ds_read_b64_tr_b16 v[234:235], v2 offset:6432
    v_mfma_f32_32x32x16_bf16 v[64:79], v[176:179], v[160:163], v[64:79]
    v_mfma_f32_32x32x16_bf16 v[80:95], v[176:179], v[164:167], v[80:95]
    v_mfma_f32_32x32x16_bf16 v[96:111], v[180:183], v[160:163], v[96:111]
    v_mfma_f32_32x32x16_bf16 v[112:127], v[180:183], v[164:167], v[112:127]
    v_mfma_f32_32x32x16_bf16 v[64:79], v[184:187], v[168:171], v[64:79]
    v_mfma_f32_32x32x16_bf16 v[80:95], v[184:187], v[172:175], v[80:95]
    v_mfma_f32_32x32x16_bf16 v[96:111], v[188:191], v[168:171], v[96:111]
    v_mfma_f32_32x32x16_bf16 v[112:127], v[188:191], v[172:175], v[112:127]
    s_waitcnt vmcnt(15) lgkmcnt(0)
    s_barrier
    s_cmp_lg_u32 s68, 5
    s_cbranch_scc1 RffnB_nocs_100
    v_bfe_u32 v40, v1, 4, 1
    v_and_b32 v41, 1, v1
    v_cmp_eq_u32 vcc, v40, v41
    v_mov_b32 v42, 0x3f803f80
    s_nop 0
    v_cndmask_b32 v40, 0, v42, vcc
    v_mov_b32 v41, v40
    v_mov_b32 v42, v40
    v_mov_b32 v43, v40
    s_nop 1
    v_mfma_f32_16x16x32_bf16 v[44:47], v[40:43], v[220:223], 0
    v_mfma_f32_16x16x32_bf16 v[48:51], v[40:43], v[224:227], 0
    v_mfma_f32_16x16x32_bf16 v[44:47], v[40:43], v[228:231], v[44:47]
    v_mfma_f32_16x16x32_bf16 v[48:51], v[40:43], v[232:235], v[48:51]
    v_bfe_u32 v28, v1, 4, 1
    v_cmp_eq_u32 vcc, 1, v28
    s_nop 4
    v_cndmask_b32 v24, v44, v45, vcc
    v_cndmask_b32 v25, v48, v49, vcc
    v_mov_b32 v26, s56
    v_mov_b32 v27, s56
    s_lshl_b32 s64, s54, 2
    s_add_u32 s64, s64, s52
    s_add_u32 s64, s64, 2
    s_lshl_b32 s64, s64, 4
    s_add_u32 s64, s64, s48
    s_lshl_b32 s64, s64, 9
    s_add_u32 s64, s64, 0x910000
    v_lshlrev_b32 v28, 4, v1
    s_mov_b32 exec_hi, 0
    buffer_store_dwordx4 v[24:27], v28, s[32:35], s64 offen sc1
    s_mov_b32 exec_hi, -1
RffnB_nocs_100:
    s_add_u32 m0, s57, 0
    s_add_u32 s65, s76, 229376
    buffer_load_dwordx4 v16, s[20:23], s65 offen lds
    ds_read_b128 v[160:163], v8 offset:0
    ds_read_b128 v[164:167], v8 offset:4096
    s_add_u32 m0, s57, 1024
    s_nop 0
    buffer_load_dwordx4 v17, s[20:23], s65 offen lds
    ds_read_b64_tr_b16 v[176:177], v2 offset:20608
    ds_read_b64_tr_b16 v[178:179], v2 offset:21888
    s_add_u32 m0, s57, 2048
    s_nop 0
    buffer_load_dwordx4 v18, s[20:23], s65 offen lds
    ds_read_b64_tr_b16 v[180:181], v2 offset:20640
    ds_read_b64_tr_b16 v[182:183], v2 offset:21920
    s_add_u32 m0, s57, 3072
    s_nop 0
    buffer_load_dwordx4 v19, s[20:23], s65 offen lds
    ds_read_b128 v[168:171], v9 offset:0
    ds_read_b128 v[172:175], v9 offset:4096
    s_add_u32 m0, s57, 4096
    s_nop 0
    buffer_load_dwordx4 v20, s[20:23], s65 offen lds
    ds_read_b64_tr_b16 v[184:185], v2 offset:25728
    ds_read_b64_tr_b16 v[186:187], v2 offset:27008
    ds_read_b64_tr_b16 v[188:189], v2 offset:25760
    ds_read_b64_tr_b16 v[190:191], v2 offset:27040
    v_mfma_f32_32x32x16_bf16 v[64:79], v[220:223], v[204:207], v[64:79]
    v_mfma_f32_32x32x16_bf16 v[80:95], v[220:223], v[208:211], v[80:95]
    v_mfma_f32_32x32x16_bf16 v[96:111], v[224:227], v[204:207], v[96:111]
    v_mfma_f32_32x32x16_bf16 v[112:127], v[224:227], v[208:211], v[112:127]
    v_mfma_f32_32x32x16_bf16 v[64:79], v[228:231], v[212:215], v[64:79]
    v_mfma_f32_32x32x16_bf16 v[80:95], v[228:231], v[216:219], v[80:95]
    v_mfma_f32_32x32x16_bf16 v[96:111], v[232:235], v[212:215], v[96:111]
    v_mfma_f32_32x32x16_bf16 v[112:127], v[232:235], v[216:219], v[112:127]
    s_waitcnt vmcnt(15) lgkmcnt(0)
    s_barrier
    s_cmp_lg_u32 s68, 6
    s_cbranch_scc1 RffnB_nocs_101
    v_bfe_u32 v40, v1, 4, 1
    v_and_b32 v41, 1, v1
    v_cmp_eq_u32 vcc, v40, v41
    v_mov_b32 v42, 0x3f803f80
    s_nop 0
    v_cndmask_b32 v40, 0, v42, vcc
    v_mov_b32 v41, v40
    v_mov_b32 v42, v40
    v_mov_b32 v43, v40
    s_nop 1
    v_mfma_f32_16x16x32_bf16 v[44:47], v[40:43], v[176:179], 0
    v_mfma_f32_16x16x32_bf16 v[48:51], v[40:43], v[180:183], 0
    v_mfma_f32_16x16x32_bf16 v[44:47], v[40:43], v[184:187], v[44:47]
    v_mfma_f32_16x16x32_bf16 v[48:51], v[40:43], v[188:191], v[48:51]
    v_bfe_u32 v28, v1, 4, 1
    v_cmp_eq_u32 vcc, 1, v28
    s_nop 4
    v_cndmask_b32 v24, v44, v45, vcc
    v_cndmask_b32 v25, v48, v49, vcc
    v_mov_b32 v26, s56
    v_mov_b32 v27, s56
    s_lshl_b32 s64, s54, 2
    s_add_u32 s64, s64, s52
    s_add_u32 s64, s64, 2
    s_lshl_b32 s64, s64, 4
    s_add_u32 s64, s64, s48
    s_lshl_b32 s64, s64, 9
    s_add_u32 s64, s64, 0x910000
    v_lshlrev_b32 v28, 4, v1
    s_mov_b32 exec_hi, 0
    buffer_store_dwordx4 v[24:27], v28, s[32:35], s64 offen sc1
    s_mov_b32 exec_hi, -1
RffnB_nocs_101:
    s_add_u32 m0, s57, 20608
    s_add_u32 s65, s76, 344064
    buffer_load_dwordx4 v16, s[20:23], s65 offen lds
    ds_read_b128 v[204:207], v10 offset:0
    ds_read_b128 v[208:211], v10 offset:4096
    s_add_u32 m0, s57, 21632
    s_nop 0
    buffer_load_dwordx4 v17, s[20:23], s65 offen lds
    ds_read_b64_tr_b16 v[220:221], v2 offset:41216
    ds_read_b64_tr_b16 v[222:223], v2 offset:42496
    s_add_u32 m0, s57, 22656
    s_nop 0
    buffer_load_dwordx4 v18, s[20:23], s65 offen lds
    ds_read_b64_tr_b16 v[224:225], v2 offset:41248
    ds_read_b64_tr_b16 v[226:227], v2 offset:42528
    s_add_u32 m0, s57, 23680
    s_nop 0
    buffer_load_dwordx4 v19, s[20:23], s65 offen lds
    ds_read_b128 v[212:215], v11 offset:0
    ds_read_b128 v[216:219], v11 offset:4096
    s_add_u32 m0, s57, 24704
    s_nop 0
    buffer_load_dwordx4 v20, s[20:23], s65 offen lds
    ds_read_b64_tr_b16 v[228:229], v2 offset:46336
    ds_read_b64_tr_b16 v[230:231], v2 offset:47616
    ds_read_b64_tr_b16 v[232:233], v2 offset:46368
    ds_read_b64_tr_b16 v[234:235], v2 offset:47648
    v_mfma_f32_32x32x16_bf16 v[64:79], v[176:179], v[160:163], v[64:79]
    v_mfma_f32_32x32x16_bf16 v[80:95], v[176:179], v[164:167], v[80:95]
    v_mfma_f32_32x32x16_bf16 v[96:111], v[180:183], v[160:163], v[96:111]
    v_mfma_f32_32x32x16_bf16 v[112:127], v[180:183], v[164:167], v[112:127]
    v_mfma_f32_32x32x16_bf16 v[64:79], v[184:187], v[168:171], v[64:79]
    v_mfma_f32_32x32x16_bf16 v[80:95], v[184:187], v[172:175], v[80:95]
    v_mfma_f32_32x32x16_bf16 v[96:111], v[188:191], v[168:171], v[96:111]
    v_mfma_f32_32x32x16_bf16 v[112:127], v[188:191], v[172:175], v[112:127]
    s_waitcnt vmcnt(15) lgkmcnt(0)
    s_barrier
    s_cmp_lg_u32 s68, 7
    s_cbranch_scc1 RffnB_nocs_102
    v_bfe_u32 v40, v1, 4, 1
    v_and_b32 v41, 1, v1
    v_cmp_eq_u32 vcc, v40, v41
    v_mov_b32 v42, 0x3f803f80
    s_nop 0
    v_cndmask_b32 v40, 0, v42, vcc
    v_mov_b32 v41, v40
    v_mov_b32 v42, v40
    v_mov_b32 v43, v40
    s_nop 1
    v_mfma_f32_16x16x32_bf16 v[44:47], v[40:43], v[220:223], 0
    v_mfma_f32_16x16x32_bf16 v[48:51], v[40:43], v[224:227], 0
    v_mfma_f32_16x16x32_bf16 v[44:47], v[40:43], v[228:231], v[44:47]
    v_mfma_f32_16x16x32_bf16 v[48:51], v[40:43], v[232:235], v[48:51]
    v_bfe_u32 v28, v1, 4, 1
    v_cmp_eq_u32 vcc, 1, v28
    s_nop 4
    v_cndmask_b32 v24, v44, v45, vcc
    v_cndmask_b32 v25, v48, v49, vcc
    v_mov_b32 v26, s56
    v_mov_b32 v27, s56
    s_lshl_b32 s64, s54, 2
    s_add_u32 s64, s64, s52
    s_add_u32 s64, s64, 2
    s_lshl_b32 s64, s64, 4
    s_add_u32 s64, s64, s48
    s_lshl_b32 s64, s64, 9
    s_add_u32 s64, s64, 0x910000
    v_lshlrev_b32 v28, 4, v1
    s_mov_b32 exec_hi, 0
    buffer_store_dwordx4 v[24:27], v28, s[32:35], s64 offen sc1
    s_mov_b32 exec_hi, -1
RffnB_nocs_102:
    s_add_u32 m0, s57, 41216
    s_add_u32 s65, s76, 458752
    buffer_load_dwordx4 v16, s[20:23], s65 offen lds
    ds_read_b128 v[160:163], v8 offset:18432
    ds_read_b128 v[164:167], v8 offset:22528
    s_add_u32 m0, s57, 42240
    s_nop 0
    buffer_load_dwordx4 v17, s[20:23], s65 offen lds
    ds_read_b64_tr_b16 v[176:177], v3 offset:0
    ds_read_b64_tr_b16 v[178:179], v3 offset:1280
    s_add_u32 m0, s57, 43264
    s_nop 0
    buffer_load_dwordx4 v18, s[20:23], s65 offen lds
    ds_read_b64_tr_b16 v[180:181], v3 offset:32
    ds_read_b64_tr_b16 v[182:183], v3 offset:1312
    s_add_u32 m0, s57, 44288
    s_nop 0
    buffer_load_dwordx4 v19, s[20:23], s65 offen lds
    ds_read_b128 v[168:171], v9 offset:18432
    ds_read_b128 v[172:175], v9 offset:22528
    s_add_u32 m0, s57, 45312
    s_nop 0
    buffer_load_dwordx4 v20, s[20:23], s65 offen lds
    ds_read_b64_tr_b16 v[184:185], v3 offset:5120
    ds_read_b64_tr_b16 v[186:187], v3 offset:6400
    ds_read_b64_tr_b16 v[188:189], v3 offset:5152
    ds_read_b64_tr_b16 v[190:191], v3 offset:6432
    v_mfma_f32_32x32x16_bf16 v[64:79], v[220:223], v[204:207], v[64:79]
    v_mfma_f32_32x32x16_bf16 v[80:95], v[220:223], v[208:211], v[80:95]
    v_mfma_f32_32x32x16_bf16 v[96:111], v[224:227], v[204:207], v[96:111]
    v_mfma_f32_32x32x16_bf16 v[112:127], v[224:227], v[208:211], v[112:127]
    v_mfma_f32_32x32x16_bf16 v[64:79], v[228:231], v[212:215], v[64:79]
    v_mfma_f32_32x32x16_bf16 v[80:95], v[228:231], v[216:219], v[80:95]
    v_mfma_f32_32x32x16_bf16 v[96:111], v[232:235], v[212:215], v[96:111]
    v_mfma_f32_32x32x16_bf16 v[112:127], v[232:235], v[216:219], v[112:127]
    s_waitcnt vmcnt(15) lgkmcnt(0)
    s_barrier
    s_add_u32 m0, s57, 61824
    s_add_u32 s65, s76, 573440
    buffer_load_dwordx4 v16, s[20:23], s65 offen lds
    ds_read_b128 v[204:207], v10 offset:18432
    ds_read_b128 v[208:211], v10 offset:22528
    s_add_u32 m0, s57, 62848
    s_nop 0
    buffer_load_dwordx4 v17, s[20:23], s65 offen lds
    ds_read_b64_tr_b16 v[220:221], v3 offset:20608
    ds_read_b64_tr_b16 v[222:223], v3 offset:21888
    s_add_u32 m0, s57, 63872
    s_nop 0
    buffer_load_dwordx4 v18, s[20:23], s65 offen lds
    ds_read_b64_tr_b16 v[224:225], v3 offset:20640
    ds_read_b64_tr_b16 v[226:227], v3 offset:21920
    s_add_u32 m0, s57, 64896
    s_nop 0
    buffer_load_dwordx4 v19, s[20:23], s65 offen lds
    ds_read_b128 v[212:215], v11 offset:18432
    ds_read_b128 v[216:219], v11 offset:22528
    s_add_u32 m0, s57, 65920
    s_nop 0
    buffer_load_dwordx4 v20, s[20:23], s65 offen lds
    ds_read_b64_tr_b16 v[228:229], v3 offset:25728
    ds_read_b64_tr_b16 v[230:231], v3 offset:27008
    ds_read_b64_tr_b16 v[232:233], v3 offset:25760
    ds_read_b64_tr_b16 v[234:235], v3 offset:27040
    v_mfma_f32_32x32x16_bf16 v[64:79], v[176:179], v[160:163], v[64:79]
    v_mfma_f32_32x32x16_bf16 v[80:95], v[176:179], v[164:167], v[80:95]
    v_mfma_f32_32x32x16_bf16 v[96:111], v[180:183], v[160:163], v[96:111]
    v_mfma_f32_32x32x16_bf16 v[112:127], v[180:183], v[164:167], v[112:127]
    v_mfma_f32_32x32x16_bf16 v[64:79], v[184:187], v[168:171], v[64:79]
    v_mfma_f32_32x32x16_bf16 v[80:95], v[184:187], v[172:175], v[80:95]
    v_mfma_f32_32x32x16_bf16 v[96:111], v[188:191], v[168:171], v[96:111]
    v_mfma_f32_32x32x16_bf16 v[112:127], v[188:191], v[172:175], v[112:127]
    s_waitcnt vmcnt(15) lgkmcnt(0)
    s_barrier
    s_add_u32 m0, s57, 82432
    s_add_u32 s65, s76, 688128
    buffer_load_dwordx4 v16, s[20:23], s65 offen lds
    ds_read_b128 v[160:163], v8 offset:36864
    ds_read_b128 v[164:167], v8 offset:40960
    s_add_u32 m0, s57, 83456
    s_nop 0
    buffer_load_dwordx4 v17, s[20:23], s65 offen lds
    ds_read_b64_tr_b16 v[176:177], v2 offset:0
    ds_read_b64_tr_b16 v[178:179], v2 offset:1280
    s_add_u32 m0, s57, 84480
    s_nop 0
    buffer_load_dwordx4 v18, s[20:23], s65 offen lds
    ds_read_b64_tr_b16 v[180:181], v2 offset:32
    ds_read_b64_tr_b16 v[182:183], v2 offset:1312
    s_add_u32 m0, s57, 85504
    s_nop 0
    buffer_load_dwordx4 v19, s[20:23], s65 offen lds
    ds_read_b128 v[168:171], v9 offset:36864
    ds_read_b128 v[172:175], v9 offset:40960
    s_add_u32 m0, s57, 86528
    s_nop 0
    buffer_load_dwordx4 v20, s[20:23], s65 offen lds
    ds_read_b64_tr_b16 v[184:185], v2 offset:5120
    ds_read_b64_tr_b16 v[186:187], v2 offset:6400
    ds_read_b64_tr_b16 v[188:189], v2 offset:5152
    ds_read_b64_tr_b16 v[190:191], v2 offset:6432
    v_mfma_f32_32x32x16_bf16 v[64:79], v[220:223], v[204:207], v[64:79]
    v_and_b32 v15, 31, v1
    v_lshlrev_b32 v15, 4, v15
    v_lshrrev_b32 v60, 5, v1
    v_lshlrev_b32 v61, 11, v60
    v_add_u32 v15, v15, v61
    v_mfma_f32_32x32x16_bf16 v[80:95], v[220:223], v[208:211], v[80:95]
    s_lshl_b32 s12, s54, 2
    s_add_u32 s12, s12, s52
    s_add_u32 s12, s12, 2
    s_lshl_b32 s12, s12, 1
    s_add_u32 s12, s12, s51
    s_lshl_b32 s12, s12, 12
    s_add_u32 s12, s12, 0x910000
    v_mfma_f32_32x32x16_bf16 v[96:111], v[224:227], v[204:207], v[96:111]
    v_mfma_f32_32x32x16_bf16 v[112:127], v[224:227], v[208:211], v[112:127]
    v_and_b32 v61, 31, v1
    v_lshlrev_b32 v61, 5, v61
    v_lshlrev_b32 v60, 4, v60
    v_add_u32 v60, v60, v61
    v_mfma_f32_32x32x16_bf16 v[64:79], v[228:231], v[212:215], v[64:79]
    v_mfma_f32_32x32x16_bf16 v[80:95], v[228:231], v[216:219], v[80:95]
    s_lshl_b32 s14, s48, 11
    s_lshl_b32 s13, s51, 10
    s_add_u32 s14, s14, s13
    s_add_u32 s14, s14, 0x900000
    v_mfma_f32_32x32x16_bf16 v[96:111], v[232:235], v[212:215], v[96:111]
    v_mfma_f32_32x32x16_bf16 v[112:127], v[232:235], v[216:219], v[112:127]
    s_waitcnt vmcnt(15) lgkmcnt(0)
    s_barrier
    s_add_u32 m0, s57, 0
    s_add_u32 s65, s76, 802816
    buffer_load_dwordx4 v16, s[20:23], s65 offen lds
    ds_read_b128 v[204:207], v10 offset:36864
    ds_read_b128 v[208:211], v10 offset:40960
    s_add_u32 m0, s57, 1024
    s_nop 0
    buffer_load_dwordx4 v17, s[20:23], s65 offen lds
    ds_read_b64_tr_b16 v[220:221], v2 offset:20608
    ds_read_b64_tr_b16 v[222:223], v2 offset:21888
    s_add_u32 m0, s57, 2048
    s_nop 0
    buffer_load_dwordx4 v18, s[20:23], s65 offen lds
    ds_read_b64_tr_b16 v[224:225], v2 offset:20640
    ds_read_b64_tr_b16 v[226:227], v2 offset:21920
    s_add_u32 m0, s57, 3072
    s_nop 0
    buffer_load_dwordx4 v19, s[20:23], s65 offen lds
    ds_read_b128 v[212:215], v11 offset:36864
    ds_read_b128 v[216:219], v11 offset:40960
    s_add_u32 m0, s57, 4096
    s_nop 0
    buffer_load_dwordx4 v20, s[20:23], s65 offen lds
    ds_read_b64_tr_b16 v[228:229], v2 offset:25728
    ds_read_b64_tr_b16 v[230:231], v2 offset:27008
    ds_read_b64_tr_b16 v[232:233], v2 offset:25760
    ds_read_b64_tr_b16 v[234:235], v2 offset:27040
    v_mfma_f32_32x32x16_bf16 v[64:79], v[176:179], v[160:163], v[64:79]
    v_mfma_f32_32x32x16_bf16 v[80:95], v[176:179], v[164:167], v[80:95]
    v_mfma_f32_32x32x16_bf16 v[96:111], v[180:183], v[160:163], v[96:111]
    v_mfma_f32_32x32x16_bf16 v[112:127], v[180:183], v[164:167], v[112:127]
    v_mfma_f32_32x32x16_bf16 v[64:79], v[184:187], v[168:171], v[64:79]
    v_mfma_f32_32x32x16_bf16 v[80:95], v[184:187], v[172:175], v[80:95]
    v_mfma_f32_32x32x16_bf16 v[96:111], v[188:191], v[168:171], v[96:111]
    v_mfma_f32_32x32x16_bf16 v[112:127], v[188:191], v[172:175], v[112:127]
    s_waitcnt vmcnt(15) lgkmcnt(0)
    s_barrier
    buffer_load_dwordx4 v[24:27], v15, s[32:35], s12 offen offset:0 sc1
    ds_read_b128 v[160:163], v8 offset:0
    ds_read_b128 v[164:167], v8 offset:4096
    buffer_load_dwordx4 v[28:31], v15, s[32:35], s12 offen offset:512 sc1
    ds_read_b64_tr_b16 v[176:177], v2 offset:41216
    ds_read_b64_tr_b16 v[178:179], v2 offset:42496
    buffer_load_dwordx4 v[32:35], v15, s[32:35], s12 offen offset:1024 sc1
    ds_read_b64_tr_b16 v[180:181], v2 offset:41248
    ds_read_b64_tr_b16 v[182:183], v2 offset:42528
    buffer_load_dwordx4 v[36:39], v15, s[32:35], s12 offen offset:1536 sc1
    ds_read_b128 v[168:171], v9 offset:0
    ds_read_b128 v[172:175], v9 offset:4096
    buffer_load_dwordx4 v[56:59], v60, s[32:35], s14 offen sc1
    ds_read_b64_tr_b16 v[184:185], v2 offset:46336
    ds_read_b64_tr_b16 v[186:187], v2 offset:47616
    ds_read_b64_tr_b16 v[188:189], v2 offset:46368
    ds_read_b64_tr_b16 v[190:191], v2 offset:47648
    v_mfma_f32_32x32x16_bf16 v[64:79], v[220:223], v[204:207], v[64:79]
    v_mfma_f32_32x32x16_bf16 v[80:95], v[220:223], v[208:211], v[80:95]
    v_mfma_f32_32x32x16_bf16 v[96:111], v[224:227], v[204:207], v[96:111]
    v_mfma_f32_32x32x16_bf16 v[112:127], v[224:227], v[208:211], v[112:127]
    v_mfma_f32_32x32x16_bf16 v[64:79], v[228:231], v[212:215], v[64:79]
    v_mfma_f32_32x32x16_bf16 v[80:95], v[228:231], v[216:219], v[80:95]
    v_mfma_f32_32x32x16_bf16 v[96:111], v[232:235], v[212:215], v[96:111]
    v_mfma_f32_32x32x16_bf16 v[112:127], v[232:235], v[216:219], v[112:127]
    s_waitcnt vmcnt(15) lgkmcnt(0)
    s_barrier
    s_add_u32 m0, s74, 20608
    s_add_u32 s64, s71, 0
    buffer_load_dwordx4 v14, s[40:43], s64 offen lds
    ds_read_b128 v[204:207], v10 offset:0
    ds_read_b128 v[208:211], v10 offset:4096
    s_add_u32 m0, s74, 21632
    s_add_u32 s64, s71, 4096
    buffer_load_dwordx4 v14, s[40:43], s64 offen lds
    ds_read_b64_tr_b16 v[220:221], v3 offset:0
    ds_read_b64_tr_b16 v[222:223], v3 offset:1280
    s_add_u32 m0, s74, 139904
    s_add_u32 s64, s71, 16384
    buffer_load_dwordx4 v14, s[40:43], s64 offen lds
    ds_read_b64_tr_b16 v[224:225], v3 offset:32
    ds_read_b64_tr_b16 v[226:227], v3 offset:1312
    s_add_u32 m0, s74, 140928
    s_add_u32 s64, s71, 20480
    buffer_load_dwordx4 v14, s[40:43], s64 offen lds
    ds_read_b128 v[212:215], v11 offset:0
    ds_read_b128 v[216:219], v11 offset:4096
    s_add_u32 m0, s74, 36992
    s_add_u32 s64, s71, 32768
    buffer_load_dwordx4 v14, s[40:43], s64 offen lds
    ds_read_b64_tr_b16 v[228:229], v3 offset:5120
    ds_read_b64_tr_b16 v[230:231], v3 offset:6400
    s_add_u32 m0, s74, 38016
    s_add_u32 s64, s71, 36864
    buffer_load_dwordx4 v14, s[40:43], s64 offen lds
    ds_read_b64_tr_b16 v[232:233], v3 offset:5152
    ds_read_b64_tr_b16 v[234:235], v3 offset:6432
    v_mfma_f32_32x32x16_bf16 v[64:79], v[176:179], v[160:163], v[64:79]
    v_mfma_f32_32x32x16_bf16 v[80:95], v[176:179], v[164:167], v[80:95]
    v_mfma_f32_32x32x16_bf16 v[96:111], v[180:183], v[160:163], v[96:111]
    v_mfma_f32_32x32x16_bf16 v[112:127], v[180:183], v[164:167], v[112:127]
    v_mfma_f32_32x32x16_bf16 v[64:79], v[184:187], v[168:171], v[64:79]
    v_mfma_f32_32x32x16_bf16 v[80:95], v[184:187], v[172:175], v[80:95]
    v_mfma_f32_32x32x16_bf16 v[96:111], v[188:191], v[168:171], v[96:111]
    v_mfma_f32_32x32x16_bf16 v[112:127], v[188:191], v[172:175], v[112:127]
    s_waitcnt vmcnt(16) lgkmcnt(0)
    s_barrier
    s_add_u32 m0, s74, 53376
    s_add_u32 s64, s71, 49152
    buffer_load_dwordx4 v14, s[40:43], s64 offen lds
    ds_read_b128 v[160:163], v8 offset:18432
    ds_read_b128 v[164:167], v8 offset:22528
    s_add_u32 m0, s74, 54400
    s_add_u32 s64, s71, 53248
    buffer_load_dwordx4 v14, s[40:43], s64 offen lds
    ds_read_b64_tr_b16 v[176:177], v3 offset:20608
    ds_read_b64_tr_b16 v[178:179], v3 offset:21888
    ds_read_b64_tr_b16 v[180:181], v3 offset:20640
    ds_read_b64_tr_b16 v[182:183], v3 offset:21920
    ds_read_b128 v[168:171], v9 offset:18432
    ds_read_b128 v[172:175], v9 offset:22528
    ds_read_b64_tr_b16 v[184:185], v3 offset:25728
    ds_read_b64_tr_b16 v[186:187], v3 offset:27008
    ds_read_b64_tr_b16 v[188:189], v3 offset:25760
    ds_read_b64_tr_b16 v[190:191], v3 offset:27040
    v_mfma_f32_32x32x16_bf16 v[64:79], v[220:223], v[204:207], v[64:79]
    s_waitcnt vmcnt(8)
    v_cmp_ne_u32 s[10:11], s56, v27
    v_cmp_ne_u32 vcc, s56, v31
    s_or_b64 s[10:11], s[10:11], vcc
    v_cmp_ne_u32 vcc, s56, v35
    s_or_b64 s[10:11], s[10:11], vcc
    v_cmp_ne_u32 vcc, s56, v39
    s_or_b64 s[10:11], s[10:11], vcc
    v_cmp_ne_u32 vcc, s55, v59
    s_or_b64 s[10:11], s[10:11], vcc
    s_cmp_lg_u64 s[10:11], 0
    s_cbranch_scc1 RffnB_retry
RffnB_recok:
    v_add_f32 v24, v24, v28
    v_add_f32 v32, v32, v36
    v_add_f32 v25, v25, v29
    v_add_f32 v33, v33, v37
    v_mfma_f32_32x32x16_bf16 v[80:95], v[220:223], v[208:211], v[80:95]
    v_add_f32 v24, v24, v32
    v_add_f32 v25, v25, v33
    v_mfma_f32_32x32x16_bf16 v[96:111], v[224:227], v[204:207], v[96:111]
    v_mov_b32 v28, v24
    v_mov_b32 v29, v25
    s_add_u32 s66, s52, 2
    s_lshl_b32 s66, s66, 10
    s_lshl_b32 s67, s51, 9
    s_add_u32 s67, s67, s66
    s_add_u32 s67, s67, 158592
    v_mfma_f32_32x32x16_bf16 v[112:127], v[224:227], v[208:211], v[112:127]
    v_permlane32_swap_b32 v24, v28
    v_permlane32_swap_b32 v25, v29
    v_and_b32 v40, 31, v1
    v_lshlrev_b32 v40, 4, v40
    v_add_f32 v24, v24, v28
    v_add_f32 v25, v25, v29
    v_add_u32 v41, s67, v40
    v_mfma_f32_32x32x16_bf16 v[64:79], v[228:231], v[212:215], v[64:79]
    ds_write_b128 v41, v[24:27]
    v_lshrrev_b32 v42, 5, v1
    v_lshlrev_b32 v42, 9, v42
    v_add_u32 v42, v42, v40
    s_add_u32 s66, s66, 158592
    v_add_u32 v42, s66, v42
    v_mfma_f32_32x32x16_bf16 v[80:95], v[228:231], v[216:219], v[80:95]
    v_mov_b32 v28, v56
    v_mov_b32 v29, v57
    v_mov_b32 v30, v56
    v_mov_b32 v31, v57
    v_mfma_f32_32x32x16_bf16 v[96:111], v[232:235], v[212:215], v[96:111]
    v_permlane32_swap_b32 v28, v30
    v_permlane32_swap_b32 v29, v31
    v_mfma_f32_32x32x16_bf16 v[112:127], v[232:235], v[216:219], v[112:127]
    s_waitcnt lgkmcnt(0)
    s_barrier
    ds_read_b128 v[24:27], v42
    s_add_u32 m0, s74, 69760
    s_add_u32 s64, s71, 65536
    buffer_load_dwordx4 v14, s[40:43], s64 offen lds
    ds_read_b128 v[204:207], v10 offset:18432
    ds_read_b128 v[208:211], v10 offset:22528
    s_add_u32 m0, s74, 70784
    s_add_u32 s64, s71, 69632
    buffer_load_dwordx4 v14, s[40:43], s64 offen lds
    ds_read_b64_tr_b16 v[220:221], v2 offset:0
    ds_read_b64_tr_b16 v[222:223], v2 offset:1280
    s_add_u32 m0, s74, 86144
    s_add_u32 s64, s71, 81920
    buffer_load_dwordx4 v14, s[40:43], s64 offen lds
    ds_read_b64_tr_b16 v[224:225], v2 offset:32
    ds_read_b64_tr_b16 v[226:227], v2 offset:1312
    s_add_u32 m0, s74, 87168
    s_add_u32 s64, s71, 86016
    buffer_load_dwordx4 v14, s[40:43], s64 offen lds
    ds_read_b128 v[212:215], v11 offset:18432
    ds_read_b128 v[216:219], v11 offset:22528
    ds_read_b64_tr_b16 v[228:229], v2 offset:5120
    ds_read_b64_tr_b16 v[230:231], v2 offset:6400
    ds_read_b64_tr_b16 v[232:233], v2 offset:5152
    ds_read_b64_tr_b16 v[234:235], v2 offset:6432
    v_mfma_f32_32x32x16_bf16 v[64:79], v[176:179], v[160:163], v[64:79]
    v_mfma_f32_32x32x16_bf16 v[80:95], v[176:179], v[164:167], v[80:95]
    v_mfma_f32_32x32x16_bf16 v[96:111], v[180:183], v[160:163], v[96:111]
    v_mfma_f32_32x32x16_bf16 v[112:127], v[180:183], v[164:167], v[112:127]
    v_mfma_f32_32x32x16_bf16 v[64:79], v[184:187], v[168:171], v[64:79]
    v_mfma_f32_32x32x16_bf16 v[80:95], v[184:187], v[172:175], v[80:95]
    v_mfma_f32_32x32x16_bf16 v[96:111], v[188:191], v[168:171], v[96:111]
    v_mfma_f32_32x32x16_bf16 v[112:127], v[188:191], v[172:175], v[112:127]
    s_waitcnt lgkmcnt(0)
    s_barrier
    s_add_u32 m0, s74, 102528
    s_add_u32 s64, s71, 98304
    buffer_load_dwordx4 v14, s[40:43], s64 offen lds
    s_add_u32 m0, s74, 103552
    s_add_u32 s64, s71, 102400
    buffer_load_dwordx4 v14, s[40:43], s64 offen lds
    v_mfma_f32_32x32x16_bf16 v[64:79], v[220:223], v[204:207], v[64:79]
    v_sub_f32 v41, 0, v28
    v_cvt_pk_bf16_f32 v40, v41, v41
    v_and_b32 v40, 0xffff0000, v40
    v_sub_f32 v40, v41, v40
    v_cvt_pk_bf16_f32 v160, v41, v40
    v_mov_b32 v161, v160
    v_mov_b32 v162, 0
    v_mov_b32 v163, 0
    v_mfma_f32_32x32x16_bf16 v[80:95], v[220:223], v[208:211], v[80:95]
    v_sub_f32 v41, 0, v30
    v_cvt_pk_bf16_f32 v40, v41, v41
    v_and_b32 v40, 0xffff0000, v40
    v_sub_f32 v40, v41, v40
    v_cvt_pk_bf16_f32 v164, v41, v40
    v_mov_b32 v165, v164
    v_mov_b32 v166, 0
    v_mov_b32 v167, 0
    v_mfma_f32_32x32x16_bf16 v[96:111], v[224:227], v[204:207], v[96:111]
    v_mfma_f32_32x32x16_bf16 v[112:127], v[224:227], v[208:211], v[112:127]
    v_cvt_pk_bf16_f32 v176, v24, v24
    v_and_b32 v40, 0xffff0000, v176
    v_sub_f32 v40, v24, v40
    v_cvt_pk_bf16_f32 v177, v40, v40
    v_mov_b32 v178, 0
    v_mov_b32 v179, 0
    v_mfma_f32_32x32x16_bf16 v[64:79], v[228:231], v[212:215], v[64:79]
    v_mfma_f32_32x32x16_bf16 v[80:95], v[228:231], v[216:219], v[80:95]
    v_cvt_pk_bf16_f32 v180, v25, v25
    v_and_b32 v40, 0xffff0000, v180
    v_sub_f32 v40, v25, v40
    v_cvt_pk_bf16_f32 v181, v40, v40
    v_mov_b32 v182, 0
    v_mov_b32 v183, 0
    v_mfma_f32_32x32x16_bf16 v[96:111], v[232:235], v[212:215], v[96:111]
    v_mfma_f32_32x32x16_bf16 v[112:127], v[232:235], v[216:219], v[112:127]
    s_setprio 3
    v_mfma_f32_32x32x16_bf16 v[64:79], v[176:179], v[160:163], v[64:79]
    v_mfma_f32_32x32x16_bf16 v[80:95], v[176:179], v[164:167], v[80:95]
    v_mfma_f32_32x32x16_bf16 v[96:111], v[180:183], v[160:163], v[96:111]
    v_mfma_f32_32x32x16_bf16 v[112:127], v[180:183], v[164:167], v[112:127]
    v_lshrrev_b32 v16, 4, v1
    v_bfe_u32 v17, v1, 2, 2
    v_and_b32 v18, 3, v1
    v_lshrrev_b32 v5, 1, v16
    v_lshlrev_b32 v5, 3, v5
    v_add_u32 v5, v5, v17
    v_lshlrev_b32 v5, 7, v5
    v_lshrrev_b32 v17, 1, v17
    v_lshlrev_b32 v17, 6, v17
    v_add_u32 v5, v5, v17
    v_and_b32 v16, 1, v16
    v_lshlrev_b32 v16, 5, v16
    v_add_u32 v5, v5, v16
    v_lshlrev_b32 v18, 3, v18
    v_add_u32 v5, v5, v18
    v_add_u32 v2, s74, v5
    v_lshlrev_b32 v3, 4, v1
    s_lshl_b32 s64, s15, 16
    s_lshl_b32 s65, s70, 7
    s_add_u32 s75, s64, s65
    s_lshl_b32 s64, s15, 12
    s_add_u32 s76, s72, s64
    s_mul_i32 s64, s15, 10240
    s_add_u32 s72, s72, s64
    s_add_u32 s72, s72, 65536
    s_lshl_b32 s77, s69, 10
    s_add_u32 s77, s77, 0x990000
    s_lshl_b32 s64, s15, 7
    s_add_u32 s77, s77, s64
    v_and_b32 v12, 7, v1
    v_lshlrev_b32 v12, 2, v12
    v_bfe_u32 v13, v1, 3, 1
    v_lshlrev_b32 v13, 7, v13
    v_add_u32 v12, v12, v13
    s_lshl_b32 s65, s48, 2
    s_lshl_b32 s66, s51, 1
    s_add_u32 s65, s65, s66
    s_mul_i32 s65, s65, 147456
    s_mul_i32 s66, s49, 10
    s_add_u32 s66, s66, 64
    s_lshl_b32 s67, s52, 1
    s_add_u32 s67, s67, 6
    s_add_u32 s66, s66, s67
    s_lshl_b32 s66, s66, 10
    s_add_u32 s67, s65, s66
    v_mul_f32 v40, v29, v29
    v_mul_f32 v42, v31, v31
    v_lshlrev_b32 v44, 4, v1
    v_pk_mul_f32 v[64:65], v[64:65], v[72:73]
    v_pk_mul_f32 v[66:67], v[66:67], v[74:75]
    v_pk_mul_f32 v[68:69], v[68:69], v[76:77]
    v_pk_mul_f32 v[70:71], v[70:71], v[78:79]
    v_pk_mul_f32 v[64:65], v[64:65], v[40:41] op_sel_hi:[1,0]
    v_pk_mul_f32 v[66:67], v[66:67], v[40:41] op_sel_hi:[1,0]
    v_pk_mul_f32 v[68:69], v[68:69], v[40:41] op_sel_hi:[1,0]
    v_pk_mul_f32 v[70:71], v[70:71], v[40:41] op_sel_hi:[1,0]
    v_cvt_pk_bf16_f32 v72, v64, v65
    v_cvt_pk_bf16_f32 v73, v66, v67
    v_cvt_pk_bf16_f32 v74, v68, v69
    v_cvt_pk_bf16_f32 v75, v70, v71
    s_add_u32 s64, s67, 0
    buffer_store_dwordx4 v[72:75], v44, s[32:35], s64 offen sc1
    v_pk_mul_f32 v[80:81], v[80:81], v[88:89]
    v_pk_mul_f32 v[82:83], v[82:83], v[90:91]
    v_pk_mul_f32 v[84:85], v[84:85], v[92:93]
    v_pk_mul_f32 v[86:87], v[86:87], v[94:95]
    v_pk_mul_f32 v[80:81], v[80:81], v[42:43] op_sel_hi:[1,0]
    v_pk_mul_f32 v[82:83], v[82:83], v[42:43] op_sel_hi:[1,0]
    v_pk_mul_f32 v[84:85], v[84:85], v[42:43] op_sel_hi:[1,0]
    v_pk_mul_f32 v[86:87], v[86:87], v[42:43] op_sel_hi:[1,0]
    v_cvt_pk_bf16_f32 v88, v80, v81
    v_cvt_pk_bf16_f32 v89, v82, v83
    v_cvt_pk_bf16_f32 v90, v84, v85
    v_cvt_pk_bf16_f32 v91, v86, v87
    s_add_u32 s64, s67, 147456
    buffer_store_dwordx4 v[88:91], v44, s[32:35], s64 offen sc1
    v_pk_mul_f32 v[96:97], v[96:97], v[104:105]
    v_pk_mul_f32 v[98:99], v[98:99], v[106:107]
    v_pk_mul_f32 v[100:101], v[100:101], v[108:109]
    v_pk_mul_f32 v[102:103], v[102:103], v[110:111]
    v_pk_mul_f32 v[96:97], v[96:97], v[40:41] op_sel_hi:[1,0]
    v_pk_mul_f32 v[98:99], v[98:99], v[40:41] op_sel_hi:[1,0]
    v_pk_mul_f32 v[100:101], v[100:101], v[40:41] op_sel_hi:[1,0]
    v_pk_mul_f32 v[102:103], v[102:103], v[40:41] op_sel_hi:[1,0]
    v_cvt_pk_bf16_f32 v104, v96, v97
    v_cvt_pk_bf16_f32 v105, v98, v99
    v_cvt_pk_bf16_f32 v106, v100, v101
    v_cvt_pk_bf16_f32 v107, v102, v103
    s_add_u32 s64, s67, 1024
    buffer_store_dwordx4 v[104:107], v44, s[32:35], s64 offen sc1
    v_pk_mul_f32 v[112:113], v[112:113], v[120:121]
    v_pk_mul_f32 v[114:115], v[114:115], v[122:123]
    v_pk_mul_f32 v[116:117], v[116:117], v[124:125]
    v_pk_mul_f32 v[118:119], v[118:119], v[126:127]
    v_pk_mul_f32 v[112:113], v[112:113], v[42:43] op_sel_hi:[1,0]
    v_pk_mul_f32 v[114:115], v[114:115], v[42:43] op_sel_hi:[1,0]
    v_pk_mul_f32 v[116:117], v[116:117], v[42:43] op_sel_hi:[1,0]
    v_pk_mul_f32 v[118:119], v[118:119], v[42:43] op_sel_hi:[1,0]
    v_cvt_pk_bf16_f32 v120, v112, v113
    v_cvt_pk_bf16_f32 v121, v114, v115
    v_cvt_pk_bf16_f32 v122, v116, v117
    v_cvt_pk_bf16_f32 v123, v118, v119
    s_add_u32 s64, s67, 148480
    buffer_store_dwordx4 v[120:123], v44, s[32:35], s64 offen sc1
    s_waitcnt vmcnt(4)
    v_add_u32 v6, 20608, v2
    v_xor_b32 v7, 64, v6
    ds_read_b64_tr_b16 v[80:81], v6 offset:0
    ds_read_b64_tr_b16 v[82:83], v6 offset:512
    ds_read_b64_tr_b16 v[84:85], v7 offset:0
    ds_read_b64_tr_b16 v[86:87], v7 offset:512
    v_add_u32 v6, 139904, v2
    v_xor_b32 v7, 64, v6
    ds_read_b64_tr_b16 v[88:89], v6 offset:0
    ds_read_b64_tr_b16 v[90:91], v6 offset:512
    ds_read_b64_tr_b16 v[92:93], v7 offset:0
    ds_read_b64_tr_b16 v[94:95], v7 offset:512
    v_add_u32 v6, 36992, v2
    v_xor_b32 v7, 64, v6
    ds_read_b64_tr_b16 v[96:97], v6 offset:0
    ds_read_b64_tr_b16 v[98:99], v6 offset:512
    ds_read_b64_tr_b16 v[100:101], v7 offset:0
    ds_read_b64_tr_b16 v[102:103], v7 offset:512
    v_add_u32 v6, 53376, v2
    v_xor_b32 v7, 64, v6
    ds_read_b64_tr_b16 v[104:105], v6 offset:0
    ds_read_b64_tr_b16 v[106:107], v6 offset:512
    ds_read_b64_tr_b16 v[108:109], v7 offset:0
    ds_read_b64_tr_b16 v[110:111], v7 offset:512
    v_add_u32 v6, 69760, v2
    v_xor_b32 v7, 64, v6
    ds_read_b64_tr_b16 v[112:113], v6 offset:0
    ds_read_b64_tr_b16 v[114:115], v6 offset:512
    ds_read_b64_tr_b16 v[116:117], v7 offset:0
    ds_read_b64_tr_b16 v[118:119], v7 offset:512
    v_add_u32 v6, 86144, v2
    v_xor_b32 v7, 64, v6
    ds_read_b64_tr_b16 v[120:121], v6 offset:0
    ds_read_b64_tr_b16 v[122:123], v6 offset:512
    ds_read_b64_tr_b16 v[124:125], v7 offset:0
    ds_read_b64_tr_b16 v[126:127], v7 offset:512
    v_add_u32 v6, 102528, v2
    v_xor_b32 v7, 64, v6
    ds_read_b64_tr_b16 v[128:129], v6 offset:0
    ds_read_b64_tr_b16 v[130:131], v6 offset:512
    ds_read_b64_tr_b16 v[132:133], v7 offset:0
    ds_read_b64_tr_b16 v[134:135], v7 offset:512
    s_waitcnt lgkmcnt(0)
    s_barrier
    v_and_b32 v4, 31, v1
    v_lshlrev_b32 v4, 11, v4
    v_lshrrev_b32 v5, 5, v1
    v_lshlrev_b32 v5, 4, v5
    v_add_u32 v4, v4, v5
    s_lshl_b32 s73, s69, 16
    s_and_b32 s64, s50, 1
    s_lshl_b32 s64, s64, 10
    s_add_u32 s73, s73, s64
    s_lshl_b32 s64, s70, 7
    s_add_u32 s73, s73, s64
    s_lshr_b32 s64, s50, 1
    s_lshl_b32 s64, s64, 5
    s_add_u32 s73, s73, s64
    buffer_load_dwordx4 v[8:11], v4, s[16:19], s73 offen
    v_lshlrev_b32 v0, 11, v1
    v_add_u32 v0, 149488, v0
    s_waitcnt vmcnt(1)
    s_lshl_b32 s64, s48, 1
    s_add_u32 s64, s64, s51
    s_lshl_b32 s64, s64, 3
    s_add_u32 s64, s64, s49
    s_lshl_b32 s64, s64, 5
    s_add_u32 s64, s64, s52
    s_lshl_b32 s64, s64, 2
    s_add_u32 s64, s64, 0x990008
    v_mov_b32 v15, s55
    s_mov_b64 exec, 1
    buffer_store_dword v15, off, s[32:35], s64 sc1
    s_mov_b64 exec, -1
    s_setprio 0
    s_add_u32 m0, s74, 20608
    s_add_u32 s64, s71, 114688
    buffer_load_dwordx4 v14, s[40:43], s64 offen lds
    s_add_u32 m0, s74, 21632
    s_add_u32 s64, s71, 118784
    buffer_load_dwordx4 v14, s[40:43], s64 offen lds
    s_add_u32 m0, s74, 139904
    s_add_u32 s64, s71, 131072
    buffer_load_dwordx4 v14, s[40:43], s64 offen lds
    s_add_u32 m0, s74, 140928
    s_add_u32 s64, s71, 135168
    buffer_load_dwordx4 v14, s[40:43], s64 offen lds
    s_add_u32 m0, s74, 36992
    s_add_u32 s64, s71, 147456
    buffer_load_dwordx4 v14, s[40:43], s64 offen lds
    s_add_u32 m0, s74, 38016
    s_add_u32 s64, s71, 151552
    buffer_load_dwordx4 v14, s[40:43], s64 offen lds
    s_add_u32 m0, s74, 53376
    s_add_u32 s64, s75, 0
    buffer_load_dwordx4 v14, s[40:43], s64 offen lds
    s_add_u32 m0, s74, 54400
    s_add_u32 s64, s75, 4096
    buffer_load_dwordx4 v14, s[40:43], s64 offen lds
    s_add_u32 m0, s74, 69760
    s_add_u32 s64, s75, 16384
    buffer_load_dwordx4 v14, s[40:43], s64 offen lds
    s_add_u32 m0, s74, 70784
    s_add_u32 s64, s75, 20480
    buffer_load_dwordx4 v14, s[40:43], s64 offen lds
    s_add_u32 m0, s74, 86144
    s_add_u32 s64, s75, 32768
    buffer_load_dwordx4 v14, s[40:43], s64 offen lds
    s_add_u32 m0, s74, 87168
    s_add_u32 s64, s75, 36864
    buffer_load_dwordx4 v14, s[40:43], s64 offen lds
    s_add_u32 m0, s74, 102528
    s_add_u32 s64, s75, 49152
    buffer_load_dwordx4 v14, s[40:43], s64 offen lds
    s_add_u32 m0, s74, 103552
    s_add_u32 s64, s75, 53248
    buffer_load_dwordx4 v14, s[40:43], s64 offen lds
    s_mov_b64 exec, 0xff
    buffer_load_dword v13, v12, s[32:35], s77 offen sc1
    s_mov_b64 exec, -1
    s_waitcnt vmcnt(7)
    v_add_u32 v6, 20608, v2
    v_xor_b32 v7, 64, v6
    ds_read_b64_tr_b16 v[136:137], v6 offset:0
    ds_read_b64_tr_b16 v[138:139], v6 offset:512
    ds_read_b64_tr_b16 v[140:141], v7 offset:0
    ds_read_b64_tr_b16 v[142:143], v7 offset:512
    v_add_u32 v6, 139904, v2
    v_xor_b32 v7, 64, v6
    ds_read_b64_tr_b16 v[144:145], v6 offset:0
    ds_read_b64_tr_b16 v[146:147], v6 offset:512
    ds_read_b64_tr_b16 v[148:149], v7 offset:0
    ds_read_b64_tr_b16 v[150:151], v7 offset:512
    v_add_u32 v6, 36992, v2
    v_xor_b32 v7, 64, v6
    ds_read_b64_tr_b16 v[152:153], v6 offset:0
    ds_read_b64_tr_b16 v[154:155], v6 offset:512
    ds_read_b64_tr_b16 v[156:157], v7 offset:0
    ds_read_b64_tr_b16 v[158:159], v7 offset:512
    v_add_u32 v6, 53376, v2
    v_xor_b32 v7, 64, v6
    ds_read_b64_tr_b16 v[160:161], v6 offset:0
    ds_read_b64_tr_b16 v[162:163], v6 offset:512
    ds_read_b64_tr_b16 v[164:165], v7 offset:0
    ds_read_b64_tr_b16 v[166:167], v7 offset:512
    s_waitcnt lgkmcnt(0)
    s_add_u32 m0, s74, 20608
    s_add_u32 s64, s75, 0
    buffer_load_dwordx4 v14, s[36:39], s64 offen lds
    s_add_u32 m0, s74, 21632
    s_add_u32 s64, s75, 4096
    buffer_load_dwordx4 v14, s[36:39], s64 offen lds
    s_add_u32 m0, s74, 139904
    s_add_u32 s64, s75, 16384
    buffer_load_dwordx4 v14, s[36:39], s64 offen lds
    s_add_u32 m0, s74, 140928
    s_add_u32 s64, s75, 20480
    buffer_load_dwordx4 v14, s[36:39], s64 offen lds
    s_add_u32 m0, s74, 36992
    s_add_u32 s64, s75, 32768
    buffer_load_dwordx4 v14, s[36:39], s64 offen lds
    s_add_u32 m0, s74, 38016
    s_add_u32 s64, s75, 36864
    buffer_load_dwordx4 v14, s[36:39], s64 offen lds
    s_add_u32 m0, s74, 53376
    s_add_u32 s64, s75, 49152
    buffer_load_dwordx4 v14, s[36:39], s64 offen lds
    s_add_u32 m0, s74, 54400
    s_add_u32 s64, s75, 53248
    buffer_load_dwordx4 v14, s[36:39], s64 offen lds
    s_waitcnt vmcnt(8)
    v_cmp_eq_u32 vcc, s55, v13
    s_and_b32 s64, vcc_lo, 0xf
    s_cmp_lg_u32 s64, 0xf
    s_cbranch_scc1 RffnB_psp_104
RffnB_pok_103:
    s_add_u32 s64, s72, 0
    buffer_load_dwordx4 v[184:187], v3, s[32:35], s64 offen sc1
    s_add_u32 s64, s72, 147456
    buffer_load_dwordx4 v[188:191], v3, s[32:35], s64 offen sc1
    s_add_u32 s64, s72, 1024
    buffer_load_dwordx4 v[192:195], v3, s[32:35], s64 offen sc1
    s_add_u32 s64, s72, 148480
    buffer_load_dwordx4 v[196:199], v3, s[32:35], s64 offen sc1
    s_add_u32 s64, s72, 2048
    buffer_load_dwordx4 v[200:203], v3, s[32:35], s64 offen sc1
    s_add_u32 s64, s72, 149504
    buffer_load_dwordx4 v[204:207], v3, s[32:35], s64 offen sc1
    s_add_u32 s64, s72, 3072
    buffer_load_dwordx4 v[208:211], v3, s[32:35], s64 offen sc1
    s_add_u32 s64, s72, 150528
    buffer_load_dwordx4 v[212:215], v3, s[32:35], s64 offen sc1
    s_add_u32 s64, s72, 4096
    buffer_load_dwordx4 v[216:219], v3, s[32:35], s64 offen sc1
    s_add_u32 s64, s72, 151552
    buffer_load_dwordx4 v[220:223], v3, s[32:35], s64 offen sc1
    s_mov_b64 exec, 0xff
    buffer_load_dword v13, v12, s[32:35], s77 offen sc1
    s_mov_b64 exec, -1
    s_add_u32 s64, s72, 5120
    buffer_load_dwordx4 v[224:227], v3, s[32:35], s64 offen sc1
    s_add_u32 s64, s72, 152576
    buffer_load_dwordx4 v[228:231], v3, s[32:35], s64 offen sc1
    s_add_u32 s64, s72, 6144
    buffer_load_dwordx4 v[232:235], v3, s[32:35], s64 offen sc1
    s_add_u32 s64, s72, 153600
    buffer_load_dwordx4 v[236:239], v3, s[32:35], s64 offen sc1
    s_add_u32 s64, s72, 7168
    buffer_load_dwordx4 v[240:243], v3, s[32:35], s64 offen sc1
    s_add_u32 s64, s72, 154624
    buffer_load_dwordx4 v[244:247], v3, s[32:35], s64 offen sc1
    s_add_u32 s64, s72, 8192
    buffer_load_dwordx4 v[248:251], v3, s[32:35], s64 offen sc1
    s_add_u32 s64, s72, 155648
    buffer_load_dwordx4 v[252:255], v3, s[32:35], s64 offen sc1
    s_waitcnt vmcnt(18)
    v_mfma_f32_32x32x16_bf16 v[16:31], v[80:83], v[184:187], 0
    v_mfma_f32_32x32x16_bf16 v[32:47], v[84:87], v[184:187], 0
    s_waitcnt vmcnt(17)
    v_mfma_f32_32x32x16_bf16 v[48:63], v[80:83], v[188:191], 0
    v_mfma_f32_32x32x16_bf16 v[64:79], v[84:87], v[188:191], 0
    s_add_u32 s64, s72, 9216
    buffer_load_dwordx4 v[184:187], v3, s[32:35], s64 offen sc1
    s_add_u32 s64, s72, 156672
    buffer_load_dwordx4 v[188:191], v3, s[32:35], s64 offen sc1
    s_waitcnt vmcnt(18)
    v_mfma_f32_32x32x16_bf16 v[16:31], v[88:91], v[192:195], v[16:31]
    v_mfma_f32_32x32x16_bf16 v[32:47], v[92:95], v[192:195], v[32:47]
    s_waitcnt vmcnt(17)
    v_mfma_f32_32x32x16_bf16 v[48:63], v[88:91], v[196:199], v[48:63]
    v_mfma_f32_32x32x16_bf16 v[64:79], v[92:95], v[196:199], v[64:79]
    s_waitcnt vmcnt(16)
    v_mfma_f32_32x32x16_bf16 v[16:31], v[96:99], v[200:203], v[16:31]
    v_mfma_f32_32x32x16_bf16 v[32:47], v[100:103], v[200:203], v[32:47]
    s_waitcnt vmcnt(15)
    v_mfma_f32_32x32x16_bf16 v[48:63], v[96:99], v[204:207], v[48:63]
    v_mfma_f32_32x32x16_bf16 v[64:79], v[100:103], v[204:207], v[64:79]
    s_waitcnt vmcnt(14)
    v_mfma_f32_32x32x16_bf16 v[16:31], v[104:107], v[208:211], v[16:31]
    v_mfma_f32_32x32x16_bf16 v[32:47], v[108:111], v[208:211], v[32:47]
    s_waitcnt vmcnt(13)
    v_mfma_f32_32x32x16_bf16 v[48:63], v[104:107], v[212:215], v[48:63]
    v_mfma_f32_32x32x16_bf16 v[64:79], v[108:111], v[212:215], v[64:79]
    s_waitcnt vmcnt(12)
    v_mfma_f32_32x32x16_bf16 v[16:31], v[112:115], v[216:219], v[16:31]
    v_mfma_f32_32x32x16_bf16 v[32:47], v[116:119], v[216:219], v[32:47]
    s_waitcnt vmcnt(11)
    v_mfma_f32_32x32x16_bf16 v[48:63], v[112:115], v[220:223], v[48:63]
    v_mfma_f32_32x32x16_bf16 v[64:79], v[116:119], v[220:223], v[64:79]
    s_waitcnt vmcnt(10)
    v_cmp_eq_u32 vcc, s55, v13
    s_and_b32 s64, vcc_lo, 0xf0
    s_cmp_lg_u32 s64, 0xf0
    s_cbranch_scc1 RffnB_psp_106
RffnB_pok_105:
    s_add_u32 s64, s76, 32768
    buffer_load_dwordx4 v[192:195], v3, s[32:35], s64 offen sc1
    s_add_u32 s64, s76, 180224
    buffer_load_dwordx4 v[196:199], v3, s[32:35], s64 offen sc1
    s_add_u32 s64, s76, 33792
    buffer_load_dwordx4 v[200:203], v3, s[32:35], s64 offen sc1
    s_add_u32 s64, s76, 181248
    buffer_load_dwordx4 v[204:207], v3, s[32:35], s64 offen sc1
    s_add_u32 s64, s76, 34816
    buffer_load_dwordx4 v[208:211], v3, s[32:35], s64 offen sc1
    s_add_u32 s64, s76, 182272
    buffer_load_dwordx4 v[212:215], v3, s[32:35], s64 offen sc1
    s_add_u32 s64, s76, 35840
    buffer_load_dwordx4 v[216:219], v3, s[32:35], s64 offen sc1
    s_add_u32 s64, s76, 183296
    buffer_load_dwordx4 v[220:223], v3, s[32:35], s64 offen sc1
    s_waitcnt vmcnt(17)
    v_mfma_f32_32x32x16_bf16 v[16:31], v[120:123], v[224:227], v[16:31]
    v_mfma_f32_32x32x16_bf16 v[32:47], v[124:127], v[224:227], v[32:47]
    s_waitcnt vmcnt(16)
    v_mfma_f32_32x32x16_bf16 v[48:63], v[120:123], v[228:231], v[48:63]
    v_mfma_f32_32x32x16_bf16 v[64:79], v[124:127], v[228:231], v[64:79]
    s_waitcnt vmcnt(15)
    v_mfma_f32_32x32x16_bf16 v[16:31], v[128:131], v[232:235], v[16:31]
    v_mfma_f32_32x32x16_bf16 v[32:47], v[132:135], v[232:235], v[32:47]
    s_waitcnt vmcnt(14)
    v_mfma_f32_32x32x16_bf16 v[48:63], v[128:131], v[236:239], v[48:63]
    v_mfma_f32_32x32x16_bf16 v[64:79], v[132:135], v[236:239], v[64:79]
    s_mov_b64 exec, 0x3
    buffer_load_dword v13, v0, s[32:35], s76 offen sc1
    s_mov_b64 exec, -1
    s_waitcnt vmcnt(14)
    v_mfma_f32_32x32x16_bf16 v[16:31], v[136:139], v[240:243], v[16:31]
    v_mfma_f32_32x32x16_bf16 v[32:47], v[140:143], v[240:243], v[32:47]
    s_waitcnt vmcnt(13)
    v_mfma_f32_32x32x16_bf16 v[48:63], v[136:139], v[244:247], v[48:63]
    v_mfma_f32_32x32x16_bf16 v[64:79], v[140:143], v[244:247], v[64:79]
    s_waitcnt vmcnt(12)
    v_mfma_f32_32x32x16_bf16 v[16:31], v[144:147], v[248:251], v[16:31]
    v_mfma_f32_32x32x16_bf16 v[32:47], v[148:151], v[248:251], v[32:47]
    s_waitcnt vmcnt(11)
    v_mfma_f32_32x32x16_bf16 v[48:63], v[144:147], v[252:255], v[48:63]
    v_mfma_f32_32x32x16_bf16 v[64:79], v[148:151], v[252:255], v[64:79]
    s_waitcnt vmcnt(0)
    v_cmp_ne_u32 vcc, -1, v13
    s_and_b32 s64, vcc_lo, 0x3
    s_cmp_lg_u32 s64, 0x3
    s_cbranch_scc1 RffnB_gsp_108
RffnB_gok_107:
    s_add_u32 s64, s76, 0
    buffer_load_dwordx4 v[224:227], v3, s[32:35], s64 offen sc1
    s_add_u32 s64, s76, 147456
    buffer_load_dwordx4 v[228:231], v3, s[32:35], s64 offen sc1
    s_add_u32 s64, s76, 1024
    buffer_load_dwordx4 v[232:235], v3, s[32:35], s64 offen sc1
    s_add_u32 s64, s76, 148480
    buffer_load_dwordx4 v[236:239], v3, s[32:35], s64 offen sc1
    s_add_u32 s64, s76, 2048
    buffer_load_dwordx4 v[240:243], v3, s[32:35], s64 offen sc1
    s_add_u32 s64, s76, 149504
    buffer_load_dwordx4 v[244:247], v3, s[32:35], s64 offen sc1
    s_add_u32 s64, s76, 3072
    buffer_load_dwordx4 v[248:251], v3, s[32:35], s64 offen sc1
    s_add_u32 s64, s76, 150528
    buffer_load_dwordx4 v[252:255], v3, s[32:35], s64 offen sc1
    v_mfma_f32_32x32x16_bf16 v[16:31], v[152:155], v[184:187], v[16:31]
    v_mfma_f32_32x32x16_bf16 v[32:47], v[156:159], v[184:187], v[32:47]
    v_mfma_f32_32x32x16_bf16 v[48:63], v[152:155], v[188:191], v[48:63]
    v_mfma_f32_32x32x16_bf16 v[64:79], v[156:159], v[188:191], v[64:79]
    v_add_u32 v6, 69760, v2
    v_xor_b32 v7, 64, v6
    ds_read_b64_tr_b16 v[176:177], v6 offset:0
    ds_read_b64_tr_b16 v[178:179], v6 offset:512
    ds_read_b64_tr_b16 v[180:181], v7 offset:0
    ds_read_b64_tr_b16 v[182:183], v7 offset:512
    v_mfma_f32_32x32x16_bf16 v[16:31], v[160:163], v[192:195], v[16:31]
    v_mfma_f32_32x32x16_bf16 v[32:47], v[164:167], v[192:195], v[32:47]
    v_mfma_f32_32x32x16_bf16 v[48:63], v[160:163], v[196:199], v[48:63]
    v_mfma_f32_32x32x16_bf16 v[64:79], v[164:167], v[196:199], v[64:79]
    s_waitcnt lgkmcnt(0)
    v_add_u32 v6, 86144, v2
    v_xor_b32 v7, 64, v6
    ds_read_b64_tr_b16 v[168:169], v6 offset:0
    ds_read_b64_tr_b16 v[170:171], v6 offset:512
    ds_read_b64_tr_b16 v[172:173], v7 offset:0
    ds_read_b64_tr_b16 v[174:175], v7 offset:512
    v_mfma_f32_32x32x16_bf16 v[16:31], v[176:179], v[200:203], v[16:31]
    v_mfma_f32_32x32x16_bf16 v[32:47], v[180:183], v[200:203], v[32:47]
    v_mfma_f32_32x32x16_bf16 v[48:63], v[176:179], v[204:207], v[48:63]
    v_mfma_f32_32x32x16_bf16 v[64:79], v[180:183], v[204:207], v[64:79]
    s_waitcnt lgkmcnt(0)
    v_add_u32 v6, 102528, v2
    v_xor_b32 v7, 64, v6
    ds_read_b64_tr_b16 v[176:177], v6 offset:0
    ds_read_b64_tr_b16 v[178:179], v6 offset:512
    ds_read_b64_tr_b16 v[180:181], v7 offset:0
    ds_read_b64_tr_b16 v[182:183], v7 offset:512
    v_mfma_f32_32x32x16_bf16 v[16:31], v[168:171], v[208:211], v[16:31]
    v_mfma_f32_32x32x16_bf16 v[32:47], v[172:175], v[208:211], v[32:47]
    v_mfma_f32_32x32x16_bf16 v[48:63], v[168:171], v[212:215], v[48:63]
    v_mfma_f32_32x32x16_bf16 v[64:79], v[172:175], v[212:215], v[64:79]
    s_waitcnt lgkmcnt(0)
    v_add_u32 v6, 20608, v2
    v_xor_b32 v7, 64, v6
    ds_read_b64_tr_b16 v[168:169], v6 offset:0
    ds_read_b64_tr_b16 v[170:171], v6 offset:512
    ds_read_b64_tr_b16 v[172:173], v7 offset:0
    ds_read_b64_tr_b16 v[174:175], v7 offset:512
    v_mfma_f32_32x32x16_bf16 v[16:31], v[176:179], v[216:219], v[16:31]
    v_mfma_f32_32x32x16_bf16 v[32:47], v[180:183], v[216:219], v[32:47]
    v_mfma_f32_32x32x16_bf16 v[48:63], v[176:179], v[220:223], v[48:63]
    v_mfma_f32_32x32x16_bf16 v[64:79], v[180:183], v[220:223], v[64:79]
    s_waitcnt vmcnt(6) lgkmcnt(0)
    v_max3_u32 v5, v224, v225, v226
    v_max3_u32 v15, v228, v229, v230
    v_max3_u32 v5, v5, v227, v231
    v_max_u32 v5, v5, v15
    v_cmp_eq_u32 vcc, -1, v5
    s_cbranch_vccnz RffnB_asp_110
RffnB_aok_109:
    v_add_u32 v6, 139904, v2
    v_xor_b32 v7, 64, v6
    ds_read_b64_tr_b16 v[176:177], v6 offset:0
    ds_read_b64_tr_b16 v[178:179], v6 offset:512
    ds_read_b64_tr_b16 v[180:181], v7 offset:0
    ds_read_b64_tr_b16 v[182:183], v7 offset:512
    v_mfma_f32_32x32x16_bf16 v[16:31], v[168:171], v[224:227], v[16:31]
    v_mfma_f32_32x32x16_bf16 v[32:47], v[172:175], v[224:227], v[32:47]
    v_mfma_f32_32x32x16_bf16 v[48:63], v[168:171], v[228:231], v[48:63]
    v_mfma_f32_32x32x16_bf16 v[64:79], v[172:175], v[228:231], v[64:79]
    s_waitcnt vmcnt(4) lgkmcnt(0)
    v_max3_u32 v5, v232, v233, v234
    v_max3_u32 v15, v236, v237, v238
    v_max3_u32 v5, v5, v235, v239
    v_max_u32 v5, v5, v15
    v_cmp_eq_u32 vcc, -1, v5
    s_cbranch_vccnz RffnB_asp_112
RffnB_aok_111:
    v_add_u32 v6, 36992, v2
    v_xor_b32 v7, 64, v6
    ds_read_b64_tr_b16 v[168:169], v6 offset:0
    ds_read_b64_tr_b16 v[170:171], v6 offset:512
    ds_read_b64_tr_b16 v[172:173], v7 offset:0
    ds_read_b64_tr_b16 v[174:175], v7 offset:512
    v_mfma_f32_32x32x16_bf16 v[16:31], v[176:179], v[232:235], v[16:31]
    v_mfma_f32_32x32x16_bf16 v[32:47], v[180:183], v[232:235], v[32:47]
    v_mfma_f32_32x32x16_bf16 v[48:63], v[176:179], v[236:239], v[48:63]
    v_mfma_f32_32x32x16_bf16 v[64:79], v[180:183], v[236:239], v[64:79]
    s_waitcnt vmcnt(2) lgkmcnt(0)
    v_max3_u32 v5, v240, v241, v242
    v_max3_u32 v15, v244, v245, v246
    v_max3_u32 v5, v5, v243, v247
    v_max_u32 v5, v5, v15
    v_cmp_eq_u32 vcc, -1, v5
    s_cbranch_vccnz RffnB_asp_114
RffnB_aok_113:
    v_add_u32 v6, 53376, v2
    v_xor_b32 v7, 64, v6
    ds_read_b64_tr_b16 v[176:177], v6 offset:0
    ds_read_b64_tr_b16 v[178:179], v6 offset:512
    ds_read_b64_tr_b16 v[180:181], v7 offset:0
    ds_read_b64_tr_b16 v[182:183], v7 offset:512
    v_mfma_f32_32x32x16_bf16 v[16:31], v[168:171], v[240:243], v[16:31]
    v_mfma_f32_32x32x16_bf16 v[32:47], v[172:175], v[240:243], v[32:47]
    v_mfma_f32_32x32x16_bf16 v[48:63], v[168:171], v[244:247], v[48:63]
    v_mfma_f32_32x32x16_bf16 v[64:79], v[172:175], v[244:247], v[64:79]
    s_waitcnt vmcnt(0) lgkmcnt(0)
    v_max3_u32 v5, v248, v249, v250
    v_max3_u32 v15, v252, v253, v254
    v_max3_u32 v5, v5, v251, v255
    v_max_u32 v5, v5, v15
    v_cmp_eq_u32 vcc, -1, v5
    s_cbranch_vccnz RffnB_asp_116
RffnB_aok_115:
    v_mfma_f32_32x32x16_bf16 v[16:31], v[176:179], v[248:251], v[16:31]
    v_mfma_f32_32x32x16_bf16 v[32:47], v[180:183], v[248:251], v[32:47]
    v_mfma_f32_32x32x16_bf16 v[48:63], v[176:179], v[252:255], v[48:63]
    v_mfma_f32_32x32x16_bf16 v[64:79], v[180:183], v[252:255], v[64:79]
    v_lshlrev_b32 v12, 4, v1
    s_lshl_b32 s64, s50, 11
    v_add_u32 v12, s64, v12
    v_add_u32 v13, 0x10000, v12
    v_add_u32 v14, 0x20000, v12
    s_waitcnt lgkmcnt(0)
    s_nop 2
    ds_write_b128 v12, v[16:19] offset:20608
    ds_write_b128 v12, v[20:23] offset:21632
    ds_write_b128 v14, v[24:27] offset:8832
    ds_write_b128 v14, v[28:31] offset:9856
    ds_write_b128 v12, v[32:35] offset:36992
    ds_write_b128 v12, v[36:39] offset:38016
    ds_write_b128 v12, v[40:43] offset:53376
    ds_write_b128 v12, v[44:47] offset:54400
    ds_write_b128 v13, v[48:51] offset:4224
    ds_write_b128 v13, v[52:55] offset:5248
    ds_write_b128 v13, v[56:59] offset:20608
    ds_write_b128 v13, v[60:63] offset:21632
    ds_write_b128 v13, v[64:67] offset:36992
    ds_write_b128 v13, v[68:71] offset:38016
    ds_write_b128 v12, v[72:75] offset:0
    ds_write_b128 v12, v[76:79] offset:1024
    s_mov_b32 s64, 36992
    s_cmp_eq_u32 s53, 1
    s_cselect_b32 s64, 102528, s64
    s_cmp_eq_u32 s53, 2
    s_cselect_b32 s64, 53376, s64
    s_cmp_eq_u32 s53, 3
    s_cselect_b32 s64, 0, s64
    v_and_b32 v12, 31, v1
    v_lshlrev_b32 v12, 4, v12
    v_lshrrev_b32 v13, 5, v1
    v_lshlrev_b32 v13, 10, v13
    v_add_u32 v12, v12, v13
    v_add_u32 v12, s64, v12
    s_waitcnt lgkmcnt(0)
    s_barrier
    ds_read_b128 v[80:83], v12 offset:0
    ds_read_b128 v[84:87], v12 offset:512
    ds_read_b128 v[88:91], v12 offset:2048
    ds_read_b128 v[92:95], v12 offset:2560
    ds_read_b128 v[96:99], v12 offset:4096
    ds_read_b128 v[100:103], v12 offset:4608
    ds_read_b128 v[104:107], v12 offset:6144
    ds_read_b128 v[108:111], v12 offset:6656
    ds_read_b128 v[112:115], v12 offset:8192
    ds_read_b128 v[116:119], v12 offset:8704
    ds_read_b128 v[120:123], v12 offset:10240
    ds_read_b128 v[124:127], v12 offset:10752
    ds_read_b128 v[128:131], v12 offset:12288
    ds_read_b128 v[132:135], v12 offset:12800
    ds_read_b128 v[136:139], v12 offset:14336
    ds_read_b128 v[140:143], v12 offset:14848
    v_lshlrev_b32 v16, 16, v8
    v_and_b32 v17, 0xffff0000, v8
    v_lshlrev_b32 v18, 16, v9
    v_and_b32 v19, 0xffff0000, v9
    v_lshlrev_b32 v20, 16, v10
    v_and_b32 v21, 0xffff0000, v10
    v_lshlrev_b32 v22, 16, v11
    v_and_b32 v23, 0xffff0000, v11
    s_waitcnt lgkmcnt(14)
    v_pk_add_f32 v[16:17], v[16:17], v[80:81]
    v_pk_add_f32 v[18:19], v[18:19], v[82:83]
    v_pk_add_f32 v[20:21], v[20:21], v[84:85]
    v_pk_add_f32 v[22:23], v[22:23], v[86:87]
    s_waitcnt lgkmcnt(12)
    v_pk_add_f32 v[16:17], v[16:17], v[88:89]
    v_pk_add_f32 v[18:19], v[18:19], v[90:91]
    v_pk_add_f32 v[20:21], v[20:21], v[92:93]
    v_pk_add_f32 v[22:23], v[22:23], v[94:95]
    s_waitcnt lgkmcnt(10)
    v_pk_add_f32 v[16:17], v[16:17], v[96:97]
    v_pk_add_f32 v[18:19], v[18:19], v[98:99]
    v_pk_add_f32 v[20:21], v[20:21], v[100:101]
    v_pk_add_f32 v[22:23], v[22:23], v[102:103]
    s_waitcnt lgkmcnt(8)
    v_pk_add_f32 v[16:17], v[16:17], v[104:105]
    v_pk_add_f32 v[18:19], v[18:19], v[106:107]
    v_pk_add_f32 v[20:21], v[20:21], v[108:109]
    v_pk_add_f32 v[22:23], v[22:23], v[110:111]
    s_waitcnt lgkmcnt(6)
    v_pk_add_f32 v[16:17], v[16:17], v[112:113]
    v_pk_add_f32 v[18:19], v[18:19], v[114:115]
    v_pk_add_f32 v[20:21], v[20:21], v[116:117]
    v_pk_add_f32 v[22:23], v[22:23], v[118:119]
    s_waitcnt lgkmcnt(4)
    v_pk_add_f32 v[16:17], v[16:17], v[120:121]
    v_pk_add_f32 v[18:19], v[18:19], v[122:123]
    v_pk_add_f32 v[20:21], v[20:21], v[124:125]
    v_pk_add_f32 v[22:23], v[22:23], v[126:127]
    s_waitcnt lgkmcnt(2)
    v_pk_add_f32 v[16:17], v[16:17], v[128:129]
    v_pk_add_f32 v[18:19], v[18:19], v[130:131]
    v_pk_add_f32 v[20:21], v[20:21], v[132:133]
    v_pk_add_f32 v[22:23], v[22:23], v[134:135]
    s_waitcnt lgkmcnt(0)
    v_pk_add_f32 v[16:17], v[16:17], v[136:137]
    v_pk_add_f32 v[18:19], v[18:19], v[138:139]
    v_pk_add_f32 v[20:21], v[20:21], v[140:141]
    v_pk_add_f32 v[22:23], v[22:23], v[142:143]
    v_cvt_pk_bf16_f32 v24, v16, v17
    v_cvt_pk_bf16_f32 v25, v18, v19
    v_cvt_pk_bf16_f32 v26, v20, v21
    v_cvt_pk_bf16_f32 v27, v22, v23
    buffer_store_dwordx4 v[24:27], v4, s[44:47], s73 offen
    s_endpgm
RffnB_retry:
    s_mov_b32 s67, 0
RffnB_rl_117:
    buffer_load_dwordx4 v[24:27], v15, s[32:35], s12 offen offset:0 sc1
    buffer_load_dwordx4 v[28:31], v15, s[32:35], s12 offen offset:512 sc1
    buffer_load_dwordx4 v[32:35], v15, s[32:35], s12 offen offset:1024 sc1
    buffer_load_dwordx4 v[36:39], v15, s[32:35], s12 offen offset:1536 sc1
    buffer_load_dwordx4 v[56:59], v60, s[32:35], s14 offen sc1
    s_waitcnt vmcnt(0)
    s_add_u32 s67, s67, 1
    s_cmp_gt_u32 s67, 400000
    s_cbranch_scc1 RffnB_recok
    v_cmp_ne_u32 s[10:11], s56, v27
    v_cmp_ne_u32 vcc, s56, v31
    s_or_b64 s[10:11], s[10:11], vcc
    v_cmp_ne_u32 vcc, s56, v35
    s_or_b64 s[10:11], s[10:11], vcc
    v_cmp_ne_u32 vcc, s56, v39
    s_or_b64 s[10:11], s[10:11], vcc
    v_cmp_ne_u32 vcc, s55, v59
    s_or_b64 s[10:11], s[10:11], vcc
    s_cmp_lg_u64 s[10:11], 0
    s_cbranch_scc1 RffnB_rl_117
RffnB_rok_118:
    s_branch RffnB_recok
RffnB_psp_104:
RffnB_pl_119:
    s_sleep 4
    s_mov_b64 exec, 0xff
    buffer_load_dword v13, v12, s[32:35], s77 offen sc1
    s_mov_b64 exec, -1
    s_waitcnt vmcnt(0)
    v_cmp_eq_u32 vcc, s55, v13
    s_add_u32 s3, s3, 1
    s_cmp_gt_u32 s3, 400000
    s_cbranch_scc1 RffnB_pok_103
    s_and_b32 s64, vcc_lo, 0xf
    s_cmp_lg_u32 s64, 0xf
    s_cbranch_scc1 RffnB_pl_119
    s_branch RffnB_pok_103
RffnB_psp_106:
RffnB_pl_120:
    s_sleep 4
    s_mov_b64 exec, 0xff
    buffer_load_dword v13, v12, s[32:35], s77 offen sc1
    s_mov_b64 exec, -1
    s_waitcnt vmcnt(0)
    v_cmp_eq_u32 vcc, s55, v13
    s_add_u32 s3, s3, 1
    s_cmp_gt_u32 s3, 400000
    s_cbranch_scc1 RffnB_pok_105
    s_and_b32 s64, vcc_lo, 0xf0
    s_cmp_lg_u32 s64, 0xf0
    s_cbranch_scc1 RffnB_pl_120
    s_branch RffnB_pok_105
RffnB_gsp_108:
RffnB_gl_121:
    s_sleep 4
    s_mov_b64 exec, 0x3
    buffer_load_dword v13, v0, s[32:35], s76 offen sc1
    s_mov_b64 exec, -1
    s_waitcnt vmcnt(0)
    v_cmp_ne_u32 vcc, -1, v13
    s_add_u32 s3, s3, 1
    s_cmp_gt_u32 s3, 400000
    s_cbranch_scc1 RffnB_gok_107
    s_and_b32 s64, vcc_lo, 0x3
    s_cmp_lg_u32 s64, 0x3
    s_cbranch_scc1 RffnB_gl_121
    s_branch RffnB_gok_107
RffnB_asp_110:
RffnB_al_122:
    s_add_u32 s64, s76, 0
    buffer_load_dwordx4 v[224:227], v3, s[32:35], s64 offen sc1
    s_add_u32 s64, s76, 147456
    buffer_load_dwordx4 v[228:231], v3, s[32:35], s64 offen sc1
    s_add_u32 s64, s76, 1024
    buffer_load_dwordx4 v[232:235], v3, s[32:35], s64 offen sc1
    s_add_u32 s64, s76, 148480
    buffer_load_dwordx4 v[236:239], v3, s[32:35], s64 offen sc1
    s_add_u32 s64, s76, 2048
    buffer_load_dwordx4 v[240:243], v3, s[32:35], s64 offen sc1
    s_add_u32 s64, s76, 149504
    buffer_load_dwordx4 v[244:247], v3, s[32:35], s64 offen sc1
    s_add_u32 s64, s76, 3072
    buffer_load_dwordx4 v[248:251], v3, s[32:35], s64 offen sc1
    s_add_u32 s64, s76, 150528
    buffer_load_dwordx4 v[252:255], v3, s[32:35], s64 offen sc1
    s_waitcnt vmcnt(0)
    v_max3_u32 v5, v224, v225, v226
    v_max3_u32 v15, v228, v229, v230
    v_max3_u32 v5, v5, v227, v231
    v_max_u32 v5, v5, v15
    v_cmp_eq_u32 vcc, -1, v5
    s_add_u32 s3, s3, 1
    s_cmp_gt_u32 s3, 400000
    s_cbranch_scc1 RffnB_aok_109
    s_cbranch_vccnz RffnB_al_122
    s_branch RffnB_aok_109
RffnB_asp_112:
RffnB_al_123:
    s_add_u32 s64, s76, 1024
    buffer_load_dwordx4 v[232:235], v3, s[32:35], s64 offen sc1
    s_add_u32 s64, s76, 148480
    buffer_load_dwordx4 v[236:239], v3, s[32:35], s64 offen sc1
    s_add_u32 s64, s76, 2048
    buffer_load_dwordx4 v[240:243], v3, s[32:35], s64 offen sc1
    s_add_u32 s64, s76, 149504
    buffer_load_dwordx4 v[244:247], v3, s[32:35], s64 offen sc1
    s_add_u32 s64, s76, 3072
    buffer_load_dwordx4 v[248:251], v3, s[32:35], s64 offen sc1
    s_add_u32 s64, s76, 150528
    buffer_load_dwordx4 v[252:255], v3, s[32:35], s64 offen sc1
    s_waitcnt vmcnt(0)
    v_max3_u32 v5, v232, v233, v234
    v_max3_u32 v15, v236, v237, v238
    v_max3_u32 v5, v5, v235, v239
    v_max_u32 v5, v5, v15
    v_cmp_eq_u32 vcc, -1, v5
    s_add_u32 s3, s3, 1
    s_cmp_gt_u32 s3, 400000
    s_cbranch_scc1 RffnB_aok_111
    s_cbranch_vccnz RffnB_al_123
    s_branch RffnB_aok_111
RffnB_asp_114:
RffnB_al_124:
    s_add_u32 s64, s76, 2048
    buffer_load_dwordx4 v[240:243], v3, s[32:35], s64 offen sc1
    s_add_u32 s64, s76, 149504
    buffer_load_dwordx4 v[244:247], v3, s[32:35], s64 offen sc1
    s_add_u32 s64, s76, 3072
    buffer_load_dwordx4 v[248:251], v3, s[32:35], s64 offen sc1
    s_add_u32 s64, s76, 150528
    buffer_load_dwordx4 v[252:255], v3, s[32:35], s64 offen sc1
    s_waitcnt vmcnt(0)
    v_max3_u32 v5, v240, v241, v242
    v_max3_u32 v15, v244, v245, v246
    v_max3_u32 v5, v5, v243, v247
    v_max_u32 v5, v5, v15
    v_cmp_eq_u32 vcc, -1, v5
    s_add_u32 s3, s3, 1
    s_cmp_gt_u32 s3, 400000
    s_cbranch_scc1 RffnB_aok_113
    s_cbranch_vccnz RffnB_al_124
    s_branch RffnB_aok_113
RffnB_asp_116:
RffnB_al_125:
    s_add_u32 s64, s76, 3072
    buffer_load_dwordx4 v[248:251], v3, s[32:35], s64 offen sc1
    s_add_u32 s64, s76, 150528
    buffer_load_dwordx4 v[252:255], v3, s[32:35], s64 offen sc1
    s_waitcnt vmcnt(0)
    v_max3_u32 v5, v248, v249, v250
    v_max3_u32 v15, v252, v253, v254
    v_max3_u32 v5, v5, v251, v255
    v_max_u32 v5, v5, v15
    v_cmp_eq_u32 vcc, -1, v5
    s_add_u32 s3, s3, 1
    s_cmp_gt_u32 s3, 400000
    s_cbranch_scc1 RffnB_aok_115
    s_cbranch_vccnz RffnB_al_125
    s_branch RffnB_aok_115
K_END:
    s_endpgm
.section .rodata,"a"
.p2align 6
.amdhsa_kernel parallel_sum__sliding_local_dilated__glu_gated_bilinear__prompt_kernel
  .amdhsa_next_free_vgpr 256
  .amdhsa_next_free_sgpr 102
  .amdhsa_accum_offset 256
  .amdhsa_group_segment_fixed_size 0
  .amdhsa_kernarg_size 80
  .amdhsa_user_sgpr_count 2
  .amdhsa_user_sgpr_kernarg_segment_ptr 1
  .amdhsa_system_sgpr_workgroup_id_x 1
.end_amdhsa_kernel
```
